```python
import torch

def _softmax(x, axis=-1):
    return torch.softmax(x, dim=axis)
def _gelu(x):
    return torch.nn.functional.gelu(x, approximate="tanh")
def _silu(x):
    return torch.nn.functional.silu(x)
def _sigmoid(x):
    return torch.sigmoid(x)
def _layernorm(x, axis=-1, eps=1e-5):
    m = x.mean(dim=axis, keepdim=True)
    v = x.var(dim=axis, keepdim=True, unbiased=False)
    return (x - m) / torch.sqrt(v + eps)
def _scatter_add(tgt, idx, src, axis=0):
    return tgt.clone().index_add_(axis, idx, src)
def _segment_sum(src, seg, n):
    out = torch.zeros((n,) + src.shape[1:], dtype=src.dtype)
    return out.index_add_(0, seg, src)
def _pad(x, pw):
    flat = tuple(v for pair in reversed(pw) for v in pair)
    return torch.nn.functional.pad(x, flat)

kernel_name = 'concat_heads__mha_block_cached__gqa_block_cached__near_ridge'

def setup_inputs():

    _w = (lambda a: (lambda t: t.to(torch.bfloat16) if t.is_floating_point() else t)(torch.as_tensor(a)))
    def _A_setup():
        B, Sq, D = 8, 96, 448
        H, Sk, Dh = 16, 512, 256
        return {
            "x": _w((lambda *s: torch.randn(*s, dtype=torch.bfloat16) * 0.8)(B, Sq, D)),
            "k_cache": _w((lambda *s: torch.randn(*s, dtype=torch.bfloat16) * 0.8)(B, H, Sk, Dh)),
            "v_cache": _w((lambda *s: torch.randn(*s, dtype=torch.bfloat16) * 0.05)(B, H, Sk, Dh)),
            "wq": _w((lambda *s: torch.randn(*s, dtype=torch.bfloat16) * 0.8)(D, H * Dh) * (D ** -0.5)),
            "wo": _w((lambda *s: torch.randn(*s, dtype=torch.bfloat16) * 0.05)(H * Dh, D) * ((H * Dh) ** -0.5)),
        }
    _A_in = _A_setup()

    def _B_setup():
        B, Sq, D = 8, 96, 448
        Hq, Hkv, Sk, Dh = 16, 16, 512, 256
        assert Hq % Hkv == 0, (Hq, Hkv)
        return {
            "x": _w((lambda *s: torch.randn(*s, dtype=torch.bfloat16) * 0.8)(B, Sq, D)),
            "k_cache": _w((lambda *s: torch.randn(*s, dtype=torch.bfloat16) * 0.8)(B, Hkv, Sk, Dh)),
            "v_cache": _w((lambda *s: torch.randn(*s, dtype=torch.bfloat16) * 0.05)(B, Hkv, Sk, Dh)),
            "wq": _w((lambda *s: torch.randn(*s, dtype=torch.bfloat16) * 0.8)(D, Hq * Dh) * (D ** -0.5)),
            "wo": _w((lambda *s: torch.randn(*s, dtype=torch.bfloat16) * 0.05)(Hq * Dh, D) * ((Hq * Dh) ** -0.5)),
        }
    _B_in = _B_setup()

    return {
        "A_x": _A_in["x"],
        "A_k_cache": _A_in["k_cache"],
        "A_v_cache": _A_in["v_cache"],
        "A_wq": _A_in["wq"],
        "A_wo": _A_in["wo"],
        "B_x": _B_in["x"],
        "B_k_cache": _B_in["k_cache"],
        "B_v_cache": _B_in["v_cache"],
        "B_wq": _B_in["wq"],
        "B_wo": _B_in["wo"],
    }

def reference(A_x, A_k_cache, A_v_cache, A_wq, A_wo, B_x, B_k_cache, B_v_cache, B_wq, B_wo):
    def _A_ref(x, k_cache, v_cache, wq, wo):
        B, Sq, D = x.shape
        H, Dh = 16, 256
        q = (lambda x, *d: x.permute(*d))((x @ wq).reshape(B, Sq, H, Dh), 0, 2, 1, 3)
        scores = torch.einsum("bhqd,bhkd->bhqk", q, k_cache) * (Dh ** -0.5)
        p = _softmax(scores, axis=-1)
        o = torch.einsum("bhqk,bhkd->bhqd", p, v_cache)
        return (lambda x, *d: x.permute(*d))(o, 0, 2, 1, 3).reshape(B, Sq, H * Dh) @ wo

    def _B_ref(x, k_cache, v_cache, wq, wo):
        B, Sq, D = x.shape
        Hq, Dh = 16, 256
        Hkv = k_cache.shape[1]
        rep = Hq // Hkv
        q = (lambda x, *d: x.permute(*d))((x @ wq).reshape(B, Sq, Hq, Dh), 0, 2, 1, 3)
        k = (lambda x, n, axis: torch.repeat_interleave(x, n, dim=axis))(k_cache, rep, axis=1)
        v = (lambda x, n, axis: torch.repeat_interleave(x, n, dim=axis))(v_cache, rep, axis=1)
        scores = torch.einsum("bhqd,bhkd->bhqk", q, k) * (Dh ** -0.5)
        p = _softmax(scores, axis=-1)
        o = torch.einsum("bhqk,bhkd->bhqd", p, v)
        return (lambda x, *d: x.permute(*d))(o, 0, 2, 1, 3).reshape(B, Sq, Hq * Dh) @ wo

    a = _A_ref(A_x, A_k_cache, A_v_cache, A_wq, A_wo)
    b = _B_ref(B_x, B_k_cache, B_v_cache, B_wq, B_wo)
    return torch.concatenate([a, b], axis=-1)
```

```asm
; @launch grid=(256,1,1) block=(256,1,1) lds=163840
.amdgcn_target "amdgcn-amd-amdhsa--gfx950"
.text
.globl concat_heads__mha_block_cached__gqa_block_cached__near_ridge_kernel
.p2align 8
.type concat_heads__mha_block_cached__gqa_block_cached__near_ridge_kernel,@function
concat_heads__mha_block_cached__gqa_block_cached__near_ridge_kernel:
    s_cmp_ge_u32 s2, 256
    s_cbranch_scc1 L_done
    s_and_b32 s3, s2, 7
    s_lshr_b32 s4, s3, 2
    s_mul_i32 s5, s4, 40
    s_add_u32 s6, s0, s5
    s_addc_u32 s7, s1, 0
    s_load_dwordx8 s[8:15], s[6:7], 0
    s_load_dwordx2 s[16:17], s[6:7], 32
    s_load_dwordx4 s[20:23], s[0:1], 88
    s_load_dwordx2 s[18:19], s[0:1], 80
    s_lshr_b32 s26, s2, 3
    s_and_b32 s27, s3, 3
    s_lshl_b32 s27, s27, 2
    s_and_b32 s28, s26, 3
    s_lshl_b32 s29, s28, 1
    s_add_u32 s27, s27, s28
    s_lshr_b32 s28, s26, 2
    v_lshrrev_b32 v1, 6, v0
    v_and_b32 v0, 63, v0
    v_readfirstlane_b32 s30, v1
    s_add_u32 s29, s29, s28
    s_lshl_b32 s70, s29, 7
    s_sub_u32 s31, s70, 896
    s_cmp_ge_u32 s70, 896
    s_cselect_b32 s70, s31, s70
    s_add_u32 s71, s70, 128
    s_cmp_eq_u32 s71, 896
    s_cselect_b32 s71, 0, s71
    s_add_u32 s72, s71, 128
    s_cmp_eq_u32 s72, 896
    s_cselect_b32 s72, 0, s72
    s_add_u32 s73, s72, 128
    s_cmp_eq_u32 s73, 896
    s_cselect_b32 s73, 0, s73
    s_add_u32 s74, s73, 128
    s_cmp_eq_u32 s74, 896
    s_cselect_b32 s74, 0, s74
    s_add_u32 s75, s74, 128
    s_cmp_eq_u32 s75, 896
    s_cselect_b32 s75, 0, s75
    s_add_u32 s76, s75, 128
    s_cmp_eq_u32 s76, 896
    s_cselect_b32 s76, 0, s76
    s_mov_b32 s68, 0
    s_cmp_lg_u32 s30, 3
    s_cbranch_scc1 L_cons
    v_mov_b32 v44, 159744
    v_lshl_add_u32 v45, v0, 2, v44
    v_mov_b32 v46, 1
    v_mov_b32 v47, 0
    ds_write_b32 v45, v46
    ds_write_b32 v45, v47 offset:256
    v_lshrrev_b32 v6, 3, v0
    v_mul_u32_u24 v5, 896, v6
    v_and_b32 v2, 7, v0
    v_lshrrev_b32 v1, 4, v0
    v_xor_b32 v2, v2, v1
    v_lshlrev_b32 v2, 4, v2
    v_add_u32 v32, v2, v5
    v_xor_b32 v33, 64, v32
    v_add_u32 v33, 6144, v33
    v_add_u32 v34, 12288, v32
    v_add_u32 v35, 12288, v33
    v_and_b32 v4, 7, v0
    v_and_b32 v3, 1, v1
    v_xor_b32 v3, v3, v4
    v_lshlrev_b32 v3, 4, v3
    v_lshl_add_u32 v8, v6, 13, v3
    v_xor_b32 v9, 64, v8
    v_add_u32 v9, 64512, v9
    v_add_u32 v10, 129024, v8
    v_add_u32 v11, 129024, v9
    v_lshlrev_b32 v3, 1, v1
    v_xor_b32 v3, v3, v4
    v_lshlrev_b32 v3, 4, v3
    v_lshl_add_u32 v12, v6, 9, v2
    v_xor_b32 v13, 64, v12
    v_add_u32 v13, 3072, v13
    v_add_u32 v14, 6144, v12
    v_add_u32 v15, 6144, v13
    s_lshl_b32 s77, s70, 12
    s_lshl_b32 s78, s71, 12
    s_lshl_b32 s79, s72, 12
    s_lshl_b32 s80, s73, 12
    s_lshl_b32 s81, s74, 12
    s_lshl_b32 s82, s75, 12
    s_lshl_b32 s83, s76, 12
    s_mov_b32 s61, 0
    s_mul_i32 s29, s28, 86016
    s_lshl_b32 s31, s27, 9
    s_lshl_b32 s60, s28, 4
    s_add_u32 s60, s60, s27
    s_lshl_b32 s60, s60, 18
    s_mov_b32 s34, 86016
    s_mov_b32 s35, 0x20000
    s_sub_u32 s46, 3670016, s31
    s_mov_b32 s47, 0x20000
    s_mov_b32 s38, 262144
    s_mov_b32 s39, 0x20000
    s_mov_b32 s26, 4
    s_mul_i32 s59, s27, 229376
    s_mov_b32 s27, 0x20000
    s_waitcnt lgkmcnt(0)
    s_add_u32 s32, s8, s29
    s_addc_u32 s33, s9, 0
    s_add_u32 s44, s14, s31
    s_addc_u32 s45, s15, 0
    s_add_u32 s36, s10, s60
    s_addc_u32 s37, s11, 0
    s_mov_b32 s24, s20
    s_mov_b32 s25, s21
    s_mov_b32 m0, 147456
    s_add_u32 s31, s70, 0
    buffer_load_dwordx4 v32, s[32:35], s31 offen offset:0  lds
    buffer_load_dwordx4 v33, s[32:35], s31 offen offset:1024  lds
    buffer_load_dwordx4 v34, s[32:35], s31 offen offset:2048  lds
    buffer_load_dwordx4 v35, s[32:35], s31 offen offset:3072  lds
    s_mov_b32 m0, 151552
    s_add_u32 s31, s70, 28672
    buffer_load_dwordx4 v32, s[32:35], s31 offen offset:0  lds
    buffer_load_dwordx4 v33, s[32:35], s31 offen offset:1024  lds
    buffer_load_dwordx4 v34, s[32:35], s31 offen offset:2048  lds
    buffer_load_dwordx4 v35, s[32:35], s31 offen offset:3072  lds
    s_mov_b32 m0, 155648
    s_add_u32 s31, s70, 57344
    buffer_load_dwordx4 v32, s[32:35], s31 offen offset:0  lds
    buffer_load_dwordx4 v33, s[32:35], s31 offen offset:1024  lds
    buffer_load_dwordx4 v34, s[32:35], s31 offen offset:2048  lds
    buffer_load_dwordx4 v35, s[32:35], s31 offen offset:3072  lds
    s_mov_b32 m0, 0
    s_add_u32 s31, s77, 0
    buffer_load_dwordx4 v8, s[44:47], s31 offen offset:0  lds
    buffer_load_dwordx4 v9, s[44:47], s31 offen offset:1024  lds
    buffer_load_dwordx4 v10, s[44:47], s31 offen offset:2048  lds
    buffer_load_dwordx4 v11, s[44:47], s31 offen offset:3072  lds
    s_mov_b32 m0, 4096
    s_add_u32 s31, s77, 262144
    buffer_load_dwordx4 v8, s[44:47], s31 offen offset:0  lds
    buffer_load_dwordx4 v9, s[44:47], s31 offen offset:1024  lds
    buffer_load_dwordx4 v10, s[44:47], s31 offen offset:2048  lds
    buffer_load_dwordx4 v11, s[44:47], s31 offen offset:3072  lds
    s_mov_b32 m0, 135168
    s_add_u32 s31, s71, 0
    buffer_load_dwordx4 v32, s[32:35], s31 offen offset:0  lds
    buffer_load_dwordx4 v33, s[32:35], s31 offen offset:1024  lds
    buffer_load_dwordx4 v34, s[32:35], s31 offen offset:2048  lds
    buffer_load_dwordx4 v35, s[32:35], s31 offen offset:3072  lds
    s_mov_b32 m0, 139264
    s_add_u32 s31, s71, 28672
    buffer_load_dwordx4 v32, s[32:35], s31 offen offset:0  lds
    buffer_load_dwordx4 v33, s[32:35], s31 offen offset:1024  lds
    buffer_load_dwordx4 v34, s[32:35], s31 offen offset:2048  lds
    buffer_load_dwordx4 v35, s[32:35], s31 offen offset:3072  lds
    s_barrier
    s_mov_b32 m0, 143360
    s_add_u32 s31, s71, 57344
    buffer_load_dwordx4 v32, s[32:35], s31 offen offset:0  lds
    buffer_load_dwordx4 v33, s[32:35], s31 offen offset:1024  lds
    buffer_load_dwordx4 v34, s[32:35], s31 offen offset:2048  lds
    buffer_load_dwordx4 v35, s[32:35], s31 offen offset:3072  lds
    s_mov_b32 m0, 8192
    s_add_u32 s31, s78, 0
    buffer_load_dwordx4 v8, s[44:47], s31 offen offset:0  lds
    buffer_load_dwordx4 v9, s[44:47], s31 offen offset:1024  lds
    buffer_load_dwordx4 v10, s[44:47], s31 offen offset:2048  lds
    buffer_load_dwordx4 v11, s[44:47], s31 offen offset:3072  lds
    s_mov_b32 m0, 12288
    s_add_u32 s31, s78, 262144
    buffer_load_dwordx4 v8, s[44:47], s31 offen offset:0  lds
    buffer_load_dwordx4 v9, s[44:47], s31 offen offset:1024  lds
    buffer_load_dwordx4 v10, s[44:47], s31 offen offset:2048  lds
    buffer_load_dwordx4 v11, s[44:47], s31 offen offset:3072  lds
    s_mov_b32 m0, 159744
    s_mov_b64 exec, 1
    buffer_load_dword off, s[24:27], 0 lds
    s_mov_b64 exec, -1
    s_mov_b32 m0, 122880
    s_add_u32 s31, s72, 0
    buffer_load_dwordx4 v32, s[32:35], s31 offen offset:0  lds
    buffer_load_dwordx4 v33, s[32:35], s31 offen offset:1024  lds
    buffer_load_dwordx4 v34, s[32:35], s31 offen offset:2048  lds
    buffer_load_dwordx4 v35, s[32:35], s31 offen offset:3072  lds
    v_lshl_add_u32 v20, v6, 9, v3
    v_add_u32 v21, 3072, v20
    v_add_u32 v22, 6144, v20
    v_add_u32 v23, 9216, v20
    v_add_u32 v24, v5, v3
    v_add_u32 v25, 6144, v24
    v_add_u32 v26, 12288, v24
    v_add_u32 v27, 18432, v24
    s_add_u32 s40, s12, s60
    s_addc_u32 s41, s13, 0
    s_mov_b32 s42, 262144
    s_mov_b32 s43, 0x20000
    s_add_u32 s48, s16, s59
    s_addc_u32 s49, s17, 0
    s_mov_b32 s50, 229376
    s_mov_b32 s51, 0x20000
    s_mov_b32 m0, 126976
    s_add_u32 s31, s72, 28672
    buffer_load_dwordx4 v32, s[32:35], s31 offen offset:0  lds
    buffer_load_dwordx4 v33, s[32:35], s31 offen offset:1024  lds
    buffer_load_dwordx4 v34, s[32:35], s31 offen offset:2048  lds
    buffer_load_dwordx4 v35, s[32:35], s31 offen offset:3072  lds
    s_mov_b32 m0, 131072
    s_add_u32 s31, s72, 57344
    buffer_load_dwordx4 v32, s[32:35], s31 offen offset:0  lds
    buffer_load_dwordx4 v33, s[32:35], s31 offen offset:1024  lds
    buffer_load_dwordx4 v34, s[32:35], s31 offen offset:2048  lds
    buffer_load_dwordx4 v35, s[32:35], s31 offen offset:3072  lds
    s_mov_b32 m0, 16384
    s_add_u32 s31, s79, 0
    buffer_load_dwordx4 v8, s[44:47], s31 offen offset:0  lds
    buffer_load_dwordx4 v9, s[44:47], s31 offen offset:1024  lds
    buffer_load_dwordx4 v10, s[44:47], s31 offen offset:2048  lds
    buffer_load_dwordx4 v11, s[44:47], s31 offen offset:3072  lds
    s_mov_b32 m0, 20480
    s_add_u32 s31, s79, 262144
    buffer_load_dwordx4 v8, s[44:47], s31 offen offset:0  lds
    buffer_load_dwordx4 v9, s[44:47], s31 offen offset:1024  lds
    buffer_load_dwordx4 v10, s[44:47], s31 offen offset:2048  lds
    buffer_load_dwordx4 v11, s[44:47], s31 offen offset:3072  lds
    s_mov_b32 m0, 110592
    s_add_u32 s31, s73, 0
    buffer_load_dwordx4 v32, s[32:35], s31 offen offset:0  lds
    buffer_load_dwordx4 v33, s[32:35], s31 offen offset:1024  lds
    buffer_load_dwordx4 v34, s[32:35], s31 offen offset:2048  lds
    buffer_load_dwordx4 v35, s[32:35], s31 offen offset:3072  lds
    s_mov_b32 m0, 114688
    s_add_u32 s31, s73, 28672
    buffer_load_dwordx4 v32, s[32:35], s31 offen offset:0  lds
    buffer_load_dwordx4 v33, s[32:35], s31 offen offset:1024  lds
    buffer_load_dwordx4 v34, s[32:35], s31 offen offset:2048  lds
    buffer_load_dwordx4 v35, s[32:35], s31 offen offset:3072  lds
    s_mov_b32 m0, 118784
    s_add_u32 s31, s73, 57344
    buffer_load_dwordx4 v32, s[32:35], s31 offen offset:0  lds
    buffer_load_dwordx4 v33, s[32:35], s31 offen offset:1024  lds
    buffer_load_dwordx4 v34, s[32:35], s31 offen offset:2048  lds
    buffer_load_dwordx4 v35, s[32:35], s31 offen offset:3072  lds
    s_mov_b32 m0, 24576
    s_add_u32 s31, s80, 0
    buffer_load_dwordx4 v8, s[44:47], s31 offen offset:0  lds
    buffer_load_dwordx4 v9, s[44:47], s31 offen offset:1024  lds
    buffer_load_dwordx4 v10, s[44:47], s31 offen offset:2048  lds
    buffer_load_dwordx4 v11, s[44:47], s31 offen offset:3072  lds
    s_mov_b32 m0, 28672
    s_add_u32 s31, s80, 262144
    buffer_load_dwordx4 v8, s[44:47], s31 offen offset:0  lds
    buffer_load_dwordx4 v9, s[44:47], s31 offen offset:1024  lds
    buffer_load_dwordx4 v10, s[44:47], s31 offen offset:2048  lds
    buffer_load_dwordx4 v11, s[44:47], s31 offen offset:3072  lds
    s_mov_b32 m0, 159748
    s_mov_b64 exec, 1
    buffer_load_dword off, s[24:27], 0 lds
    s_mov_b64 exec, -1
    s_mov_b32 m0, 98304
    s_add_u32 s31, s74, 0
    buffer_load_dwordx4 v32, s[32:35], s31 offen offset:0  lds
    buffer_load_dwordx4 v33, s[32:35], s31 offen offset:1024  lds
    buffer_load_dwordx4 v34, s[32:35], s31 offen offset:2048  lds
    buffer_load_dwordx4 v35, s[32:35], s31 offen offset:3072  lds
    s_mov_b32 m0, 102400
    s_add_u32 s31, s74, 28672
    buffer_load_dwordx4 v32, s[32:35], s31 offen offset:0  lds
    buffer_load_dwordx4 v33, s[32:35], s31 offen offset:1024  lds
    buffer_load_dwordx4 v34, s[32:35], s31 offen offset:2048  lds
    buffer_load_dwordx4 v35, s[32:35], s31 offen offset:3072  lds
    s_mov_b32 m0, 106496
    s_add_u32 s31, s74, 57344
    buffer_load_dwordx4 v32, s[32:35], s31 offen offset:0  lds
    buffer_load_dwordx4 v33, s[32:35], s31 offen offset:1024  lds
    buffer_load_dwordx4 v34, s[32:35], s31 offen offset:2048  lds
    buffer_load_dwordx4 v35, s[32:35], s31 offen offset:3072  lds
    s_mov_b32 m0, 32768
    s_add_u32 s31, s81, 0
    buffer_load_dwordx4 v8, s[44:47], s31 offen offset:0  lds
    buffer_load_dwordx4 v9, s[44:47], s31 offen offset:1024  lds
    buffer_load_dwordx4 v10, s[44:47], s31 offen offset:2048  lds
    buffer_load_dwordx4 v11, s[44:47], s31 offen offset:3072  lds
    s_mov_b32 m0, 36864
    s_add_u32 s31, s81, 262144
    buffer_load_dwordx4 v8, s[44:47], s31 offen offset:0  lds
    buffer_load_dwordx4 v9, s[44:47], s31 offen offset:1024  lds
    buffer_load_dwordx4 v10, s[44:47], s31 offen offset:2048  lds
    buffer_load_dwordx4 v11, s[44:47], s31 offen offset:3072  lds
    s_mov_b32 m0, 86016
    s_add_u32 s31, s75, 0
    buffer_load_dwordx4 v32, s[32:35], s31 offen offset:0  lds
    buffer_load_dwordx4 v33, s[32:35], s31 offen offset:1024  lds
    buffer_load_dwordx4 v34, s[32:35], s31 offen offset:2048  lds
    buffer_load_dwordx4 v35, s[32:35], s31 offen offset:3072  lds
    s_mov_b32 m0, 90112
    s_add_u32 s31, s75, 28672
    buffer_load_dwordx4 v32, s[32:35], s31 offen offset:0  lds
    buffer_load_dwordx4 v33, s[32:35], s31 offen offset:1024  lds
    buffer_load_dwordx4 v34, s[32:35], s31 offen offset:2048  lds
    buffer_load_dwordx4 v35, s[32:35], s31 offen offset:3072  lds
    s_mov_b32 m0, 94208
    s_add_u32 s31, s75, 57344
    buffer_load_dwordx4 v32, s[32:35], s31 offen offset:0  lds
    buffer_load_dwordx4 v33, s[32:35], s31 offen offset:1024  lds
    buffer_load_dwordx4 v34, s[32:35], s31 offen offset:2048  lds
    buffer_load_dwordx4 v35, s[32:35], s31 offen offset:3072  lds
    s_mov_b32 m0, 40960
    s_add_u32 s31, s82, 0
    buffer_load_dwordx4 v8, s[44:47], s31 offen offset:0  lds
    buffer_load_dwordx4 v9, s[44:47], s31 offen offset:1024  lds
    buffer_load_dwordx4 v10, s[44:47], s31 offen offset:2048  lds
    buffer_load_dwordx4 v11, s[44:47], s31 offen offset:3072  lds
    s_mov_b32 m0, 45056
    s_add_u32 s31, s82, 262144
    buffer_load_dwordx4 v8, s[44:47], s31 offen offset:0  lds
    buffer_load_dwordx4 v9, s[44:47], s31 offen offset:1024  lds
    buffer_load_dwordx4 v10, s[44:47], s31 offen offset:2048  lds
    buffer_load_dwordx4 v11, s[44:47], s31 offen offset:3072  lds
    s_mov_b32 m0, 159752
    s_mov_b64 exec, 1
    buffer_load_dword off, s[24:27], 0 lds
    s_mov_b64 exec, -1
    s_mov_b32 m0, 73728
    s_add_u32 s31, s76, 0
    buffer_load_dwordx4 v32, s[32:35], s31 offen offset:0  lds
    buffer_load_dwordx4 v33, s[32:35], s31 offen offset:1024  lds
    buffer_load_dwordx4 v34, s[32:35], s31 offen offset:2048  lds
    buffer_load_dwordx4 v35, s[32:35], s31 offen offset:3072  lds
    s_mov_b32 m0, 77824
    s_add_u32 s31, s76, 28672
    buffer_load_dwordx4 v32, s[32:35], s31 offen offset:0  lds
    buffer_load_dwordx4 v33, s[32:35], s31 offen offset:1024  lds
    buffer_load_dwordx4 v34, s[32:35], s31 offen offset:2048  lds
    buffer_load_dwordx4 v35, s[32:35], s31 offen offset:3072  lds
    s_mov_b32 m0, 81920
    s_add_u32 s31, s76, 57344
    buffer_load_dwordx4 v32, s[32:35], s31 offen offset:0  lds
    buffer_load_dwordx4 v33, s[32:35], s31 offen offset:1024  lds
    buffer_load_dwordx4 v34, s[32:35], s31 offen offset:2048  lds
    buffer_load_dwordx4 v35, s[32:35], s31 offen offset:3072  lds
    s_mov_b32 m0, 49152
    s_add_u32 s31, s83, 0
    buffer_load_dwordx4 v8, s[44:47], s31 offen offset:0  lds
    buffer_load_dwordx4 v9, s[44:47], s31 offen offset:1024  lds
    buffer_load_dwordx4 v10, s[44:47], s31 offen offset:2048  lds
    buffer_load_dwordx4 v11, s[44:47], s31 offen offset:3072  lds
    s_mov_b32 m0, 53248
    s_add_u32 s31, s83, 262144
    buffer_load_dwordx4 v8, s[44:47], s31 offen offset:0  lds
    buffer_load_dwordx4 v9, s[44:47], s31 offen offset:1024  lds
    buffer_load_dwordx4 v10, s[44:47], s31 offen offset:2048  lds
    buffer_load_dwordx4 v11, s[44:47], s31 offen offset:3072  lds
    s_mov_b32 m0, 57344
    s_add_u32 s31, s77, 128
    buffer_load_dwordx4 v8, s[44:47], s31 offen offset:0  lds
    buffer_load_dwordx4 v9, s[44:47], s31 offen offset:1024  lds
    buffer_load_dwordx4 v10, s[44:47], s31 offen offset:2048  lds
    buffer_load_dwordx4 v11, s[44:47], s31 offen offset:3072  lds
    s_mov_b32 m0, 61440
    s_add_u32 s31, s77, 262272
    buffer_load_dwordx4 v8, s[44:47], s31 offen offset:0  lds
    buffer_load_dwordx4 v9, s[44:47], s31 offen offset:1024  lds
    buffer_load_dwordx4 v10, s[44:47], s31 offen offset:2048  lds
    buffer_load_dwordx4 v11, s[44:47], s31 offen offset:3072  lds
    s_mov_b32 m0, 159756
    s_mov_b64 exec, 1
    buffer_load_dword off, s[24:27], 0 lds
    s_mov_b64 exec, -1
    s_mov_b32 m0, 65536
    s_add_u32 s31, s78, 128
    buffer_load_dwordx4 v8, s[44:47], s31 offen offset:0  lds
    buffer_load_dwordx4 v9, s[44:47], s31 offen offset:1024  lds
    buffer_load_dwordx4 v10, s[44:47], s31 offen offset:2048  lds
    buffer_load_dwordx4 v11, s[44:47], s31 offen offset:3072  lds
    s_mov_b32 m0, 69632
    s_add_u32 s31, s78, 262272
    buffer_load_dwordx4 v8, s[44:47], s31 offen offset:0  lds
    buffer_load_dwordx4 v9, s[44:47], s31 offen offset:1024  lds
    buffer_load_dwordx4 v10, s[44:47], s31 offen offset:2048  lds
    buffer_load_dwordx4 v11, s[44:47], s31 offen offset:3072  lds
    s_getpc_b64 s[62:63]
    s_cmp_lt_u32 s61, 159744
    s_cbranch_scc1 L_lslow
    s_mov_b32 m0, 0
    s_mov_b32 s31, 0
    buffer_load_dwordx4 v12, s[36:39], s31 offen offset:0 nt lds
    buffer_load_dwordx4 v13, s[36:39], s31 offen offset:1024 nt lds
    buffer_load_dwordx4 v14, s[36:39], s31 offen offset:2048 nt lds
    buffer_load_dwordx4 v15, s[36:39], s31 offen offset:3072 nt lds
    s_mov_b32 m0, 4096
    s_mov_b32 s31, 16384
    buffer_load_dwordx4 v12, s[36:39], s31 offen offset:0 nt lds
    buffer_load_dwordx4 v13, s[36:39], s31 offen offset:1024 nt lds
    buffer_load_dwordx4 v14, s[36:39], s31 offen offset:2048 nt lds
    buffer_load_dwordx4 v15, s[36:39], s31 offen offset:3072 nt lds
    s_mov_b32 m0, 159760
    s_mov_b64 exec, 1
    buffer_load_dword off, s[24:27], 0 lds
    s_mov_b64 exec, -1
    s_mov_b32 m0, 8192
    s_mov_b32 s31, 32768
    buffer_load_dwordx4 v12, s[36:39], s31 offen offset:0 nt lds
    buffer_load_dwordx4 v13, s[36:39], s31 offen offset:1024 nt lds
    buffer_load_dwordx4 v14, s[36:39], s31 offen offset:2048 nt lds
    buffer_load_dwordx4 v15, s[36:39], s31 offen offset:3072 nt lds
    s_mov_b32 m0, 12288
    s_mov_b32 s31, 49152
    buffer_load_dwordx4 v12, s[36:39], s31 offen offset:0 nt lds
    buffer_load_dwordx4 v13, s[36:39], s31 offen offset:1024 nt lds
    buffer_load_dwordx4 v14, s[36:39], s31 offen offset:2048 nt lds
    buffer_load_dwordx4 v15, s[36:39], s31 offen offset:3072 nt lds
    s_mov_b32 m0, 139264
    s_add_u32 s31, s79, 128
    buffer_load_dwordx4 v8, s[44:47], s31 offen offset:0  lds
    buffer_load_dwordx4 v9, s[44:47], s31 offen offset:1024  lds
    buffer_load_dwordx4 v10, s[44:47], s31 offen offset:2048  lds
    buffer_load_dwordx4 v11, s[44:47], s31 offen offset:3072  lds
    s_mov_b32 m0, 143360
    s_add_u32 s31, s79, 262272
    buffer_load_dwordx4 v8, s[44:47], s31 offen offset:0  lds
    buffer_load_dwordx4 v9, s[44:47], s31 offen offset:1024  lds
    buffer_load_dwordx4 v10, s[44:47], s31 offen offset:2048  lds
    buffer_load_dwordx4 v11, s[44:47], s31 offen offset:3072  lds
    s_mov_b32 m0, 159764
    s_mov_b64 exec, 1
    buffer_load_dword off, s[24:27], 0 lds
    s_mov_b64 exec, -1
    s_mov_b32 m0, 147456
    s_add_u32 s31, s80, 128
    buffer_load_dwordx4 v8, s[44:47], s31 offen offset:0  lds
    buffer_load_dwordx4 v9, s[44:47], s31 offen offset:1024  lds
    buffer_load_dwordx4 v10, s[44:47], s31 offen offset:2048  lds
    buffer_load_dwordx4 v11, s[44:47], s31 offen offset:3072  lds
    s_mov_b32 m0, 151552
    s_add_u32 s31, s80, 262272
    buffer_load_dwordx4 v8, s[44:47], s31 offen offset:0  lds
    buffer_load_dwordx4 v9, s[44:47], s31 offen offset:1024  lds
    buffer_load_dwordx4 v10, s[44:47], s31 offen offset:2048  lds
    buffer_load_dwordx4 v11, s[44:47], s31 offen offset:3072  lds
    s_getpc_b64 s[62:63]
    s_cmp_lt_u32 s61, 159748
    s_cbranch_scc1 L_lslow
    s_mov_b32 m0, 16384
    s_mov_b32 s31, 65536
    buffer_load_dwordx4 v12, s[36:39], s31 offen offset:0 nt lds
    buffer_load_dwordx4 v13, s[36:39], s31 offen offset:1024 nt lds
    buffer_load_dwordx4 v14, s[36:39], s31 offen offset:2048 nt lds
    buffer_load_dwordx4 v15, s[36:39], s31 offen offset:3072 nt lds
    s_mov_b32 m0, 20480
    s_mov_b32 s31, 81920
    buffer_load_dwordx4 v12, s[36:39], s31 offen offset:0 nt lds
    buffer_load_dwordx4 v13, s[36:39], s31 offen offset:1024 nt lds
    buffer_load_dwordx4 v14, s[36:39], s31 offen offset:2048 nt lds
    buffer_load_dwordx4 v15, s[36:39], s31 offen offset:3072 nt lds
    s_mov_b32 m0, 159768
    s_mov_b64 exec, 1
    buffer_load_dword off, s[24:27], 0 lds
    s_mov_b64 exec, -1
    s_mov_b32 m0, 24576
    s_mov_b32 s31, 98304
    buffer_load_dwordx4 v12, s[36:39], s31 offen offset:0 nt lds
    buffer_load_dwordx4 v13, s[36:39], s31 offen offset:1024 nt lds
    buffer_load_dwordx4 v14, s[36:39], s31 offen offset:2048 nt lds
    buffer_load_dwordx4 v15, s[36:39], s31 offen offset:3072 nt lds
    s_mov_b32 m0, 28672
    s_mov_b32 s31, 114688
    buffer_load_dwordx4 v12, s[36:39], s31 offen offset:0 nt lds
    buffer_load_dwordx4 v13, s[36:39], s31 offen offset:1024 nt lds
    buffer_load_dwordx4 v14, s[36:39], s31 offen offset:2048 nt lds
    buffer_load_dwordx4 v15, s[36:39], s31 offen offset:3072 nt lds
    s_mov_b32 m0, 114688
    s_add_u32 s31, s81, 128
    buffer_load_dwordx4 v8, s[44:47], s31 offen offset:0  lds
    buffer_load_dwordx4 v9, s[44:47], s31 offen offset:1024  lds
    buffer_load_dwordx4 v10, s[44:47], s31 offen offset:2048  lds
    buffer_load_dwordx4 v11, s[44:47], s31 offen offset:3072  lds
    s_mov_b32 m0, 118784
    s_add_u32 s31, s81, 262272
    buffer_load_dwordx4 v8, s[44:47], s31 offen offset:0  lds
    buffer_load_dwordx4 v9, s[44:47], s31 offen offset:1024  lds
    buffer_load_dwordx4 v10, s[44:47], s31 offen offset:2048  lds
    buffer_load_dwordx4 v11, s[44:47], s31 offen offset:3072  lds
    s_mov_b32 m0, 159772
    s_mov_b64 exec, 1
    buffer_load_dword off, s[24:27], 0 lds
    s_mov_b64 exec, -1
    s_mov_b32 m0, 122880
    s_add_u32 s31, s82, 128
    buffer_load_dwordx4 v8, s[44:47], s31 offen offset:0  lds
    buffer_load_dwordx4 v9, s[44:47], s31 offen offset:1024  lds
    buffer_load_dwordx4 v10, s[44:47], s31 offen offset:2048  lds
    buffer_load_dwordx4 v11, s[44:47], s31 offen offset:3072  lds
    s_mov_b32 m0, 126976
    s_add_u32 s31, s82, 262272
    buffer_load_dwordx4 v8, s[44:47], s31 offen offset:0  lds
    buffer_load_dwordx4 v9, s[44:47], s31 offen offset:1024  lds
    buffer_load_dwordx4 v10, s[44:47], s31 offen offset:2048  lds
    buffer_load_dwordx4 v11, s[44:47], s31 offen offset:3072  lds
    s_mov_b32 m0, 131072
    s_mov_b32 s31, 131072
    buffer_load_dwordx4 v12, s[36:39], s31 offen offset:0 nt lds
    buffer_load_dwordx4 v13, s[36:39], s31 offen offset:1024 nt lds
    buffer_load_dwordx4 v14, s[36:39], s31 offen offset:2048 nt lds
    buffer_load_dwordx4 v15, s[36:39], s31 offen offset:3072 nt lds
    s_mov_b32 m0, 135168
    s_mov_b32 s31, 147456
    buffer_load_dwordx4 v12, s[36:39], s31 offen offset:0 nt lds
    buffer_load_dwordx4 v13, s[36:39], s31 offen offset:1024 nt lds
    buffer_load_dwordx4 v14, s[36:39], s31 offen offset:2048 nt lds
    buffer_load_dwordx4 v15, s[36:39], s31 offen offset:3072 nt lds
    s_mov_b32 m0, 159776
    s_mov_b64 exec, 1
    buffer_load_dword off, s[24:27], 0 lds
    s_mov_b64 exec, -1
    s_getpc_b64 s[62:63]
    s_cmp_lt_u32 s61, 159752
    s_cbranch_scc1 L_lslow
    s_mov_b32 m0, 32768
    s_mov_b32 s31, 163840
    buffer_load_dwordx4 v12, s[36:39], s31 offen offset:0 nt lds
    buffer_load_dwordx4 v13, s[36:39], s31 offen offset:1024 nt lds
    buffer_load_dwordx4 v14, s[36:39], s31 offen offset:2048 nt lds
    buffer_load_dwordx4 v15, s[36:39], s31 offen offset:3072 nt lds
    s_mov_b32 m0, 36864
    s_mov_b32 s31, 180224
    buffer_load_dwordx4 v12, s[36:39], s31 offen offset:0 nt lds
    buffer_load_dwordx4 v13, s[36:39], s31 offen offset:1024 nt lds
    buffer_load_dwordx4 v14, s[36:39], s31 offen offset:2048 nt lds
    buffer_load_dwordx4 v15, s[36:39], s31 offen offset:3072 nt lds
    s_mov_b32 m0, 40960
    s_add_u32 s31, s83, 128
    buffer_load_dwordx4 v8, s[44:47], s31 offen offset:0  lds
    buffer_load_dwordx4 v9, s[44:47], s31 offen offset:1024  lds
    buffer_load_dwordx4 v10, s[44:47], s31 offen offset:2048  lds
    buffer_load_dwordx4 v11, s[44:47], s31 offen offset:3072  lds
    s_mov_b32 m0, 45056
    s_add_u32 s31, s83, 262272
    buffer_load_dwordx4 v8, s[44:47], s31 offen offset:0  lds
    buffer_load_dwordx4 v9, s[44:47], s31 offen offset:1024  lds
    buffer_load_dwordx4 v10, s[44:47], s31 offen offset:2048  lds
    buffer_load_dwordx4 v11, s[44:47], s31 offen offset:3072  lds
    s_mov_b32 m0, 159780
    s_mov_b64 exec, 1
    buffer_load_dword off, s[24:27], 0 lds
    s_mov_b64 exec, -1
    s_mov_b32 m0, 90112
    s_add_u32 s31, s77, 256
    buffer_load_dwordx4 v8, s[44:47], s31 offen offset:0  lds
    buffer_load_dwordx4 v9, s[44:47], s31 offen offset:1024  lds
    buffer_load_dwordx4 v10, s[44:47], s31 offen offset:2048  lds
    buffer_load_dwordx4 v11, s[44:47], s31 offen offset:3072  lds
    s_mov_b32 m0, 94208
    s_add_u32 s31, s77, 262400
    buffer_load_dwordx4 v8, s[44:47], s31 offen offset:0  lds
    buffer_load_dwordx4 v9, s[44:47], s31 offen offset:1024  lds
    buffer_load_dwordx4 v10, s[44:47], s31 offen offset:2048  lds
    buffer_load_dwordx4 v11, s[44:47], s31 offen offset:3072  lds
    s_mov_b32 m0, 98304
    s_mov_b32 s31, 196608
    buffer_load_dwordx4 v12, s[36:39], s31 offen offset:0 nt lds
    buffer_load_dwordx4 v13, s[36:39], s31 offen offset:1024 nt lds
    buffer_load_dwordx4 v14, s[36:39], s31 offen offset:2048 nt lds
    buffer_load_dwordx4 v15, s[36:39], s31 offen offset:3072 nt lds
    s_mov_b32 m0, 102400
    s_mov_b32 s31, 212992
    buffer_load_dwordx4 v12, s[36:39], s31 offen offset:0 nt lds
    buffer_load_dwordx4 v13, s[36:39], s31 offen offset:1024 nt lds
    buffer_load_dwordx4 v14, s[36:39], s31 offen offset:2048 nt lds
    buffer_load_dwordx4 v15, s[36:39], s31 offen offset:3072 nt lds
    s_mov_b32 m0, 106496
    s_mov_b32 s31, 229376
    buffer_load_dwordx4 v12, s[36:39], s31 offen offset:0 nt lds
    buffer_load_dwordx4 v13, s[36:39], s31 offen offset:1024 nt lds
    buffer_load_dwordx4 v14, s[36:39], s31 offen offset:2048 nt lds
    buffer_load_dwordx4 v15, s[36:39], s31 offen offset:3072 nt lds
    s_mov_b32 m0, 110592
    s_mov_b32 s31, 245760
    buffer_load_dwordx4 v12, s[36:39], s31 offen offset:0 nt lds
    buffer_load_dwordx4 v13, s[36:39], s31 offen offset:1024 nt lds
    buffer_load_dwordx4 v14, s[36:39], s31 offen offset:2048 nt lds
    buffer_load_dwordx4 v15, s[36:39], s31 offen offset:3072 nt lds
    s_mov_b32 m0, 159784
    s_mov_b64 exec, 1
    buffer_load_dword off, s[24:27], 0 lds
    s_mov_b64 exec, -1
    s_getpc_b64 s[62:63]
    s_cmp_lt_u32 s61, 159756
    s_cbranch_scc1 L_lslow
    s_mov_b32 m0, 49152
    s_add_u32 s31, s78, 256
    buffer_load_dwordx4 v8, s[44:47], s31 offen offset:0  lds
    buffer_load_dwordx4 v9, s[44:47], s31 offen offset:1024  lds
    buffer_load_dwordx4 v10, s[44:47], s31 offen offset:2048  lds
    buffer_load_dwordx4 v11, s[44:47], s31 offen offset:3072  lds
    s_mov_b32 m0, 53248
    s_add_u32 s31, s78, 262400
    buffer_load_dwordx4 v8, s[44:47], s31 offen offset:0  lds
    buffer_load_dwordx4 v9, s[44:47], s31 offen offset:1024  lds
    buffer_load_dwordx4 v10, s[44:47], s31 offen offset:2048  lds
    buffer_load_dwordx4 v11, s[44:47], s31 offen offset:3072  lds
    s_mov_b32 m0, 57344
    s_add_u32 s31, s79, 256
    buffer_load_dwordx4 v8, s[44:47], s31 offen offset:0  lds
    buffer_load_dwordx4 v9, s[44:47], s31 offen offset:1024  lds
    buffer_load_dwordx4 v10, s[44:47], s31 offen offset:2048  lds
    buffer_load_dwordx4 v11, s[44:47], s31 offen offset:3072  lds
    s_mov_b32 m0, 61440
    s_add_u32 s31, s79, 262400
    buffer_load_dwordx4 v8, s[44:47], s31 offen offset:0  lds
    buffer_load_dwordx4 v9, s[44:47], s31 offen offset:1024  lds
    buffer_load_dwordx4 v10, s[44:47], s31 offen offset:2048  lds
    buffer_load_dwordx4 v11, s[44:47], s31 offen offset:3072  lds
    s_mov_b32 m0, 73728
    s_mov_b32 s31, 128
    buffer_load_dwordx4 v12, s[36:39], s31 offen offset:0 nt lds
    buffer_load_dwordx4 v13, s[36:39], s31 offen offset:1024 nt lds
    buffer_load_dwordx4 v14, s[36:39], s31 offen offset:2048 nt lds
    buffer_load_dwordx4 v15, s[36:39], s31 offen offset:3072 nt lds
    s_mov_b32 m0, 77824
    s_mov_b32 s31, 16512
    buffer_load_dwordx4 v12, s[36:39], s31 offen offset:0 nt lds
    buffer_load_dwordx4 v13, s[36:39], s31 offen offset:1024 nt lds
    buffer_load_dwordx4 v14, s[36:39], s31 offen offset:2048 nt lds
    buffer_load_dwordx4 v15, s[36:39], s31 offen offset:3072 nt lds
    s_mov_b32 m0, 159788
    s_mov_b64 exec, 1
    buffer_load_dword off, s[24:27], 0 lds
    s_mov_b64 exec, -1
    s_mov_b32 m0, 81920
    s_mov_b32 s31, 32896
    buffer_load_dwordx4 v12, s[36:39], s31 offen offset:0 nt lds
    buffer_load_dwordx4 v13, s[36:39], s31 offen offset:1024 nt lds
    buffer_load_dwordx4 v14, s[36:39], s31 offen offset:2048 nt lds
    buffer_load_dwordx4 v15, s[36:39], s31 offen offset:3072 nt lds
    s_mov_b32 m0, 86016
    s_mov_b32 s31, 49280
    buffer_load_dwordx4 v12, s[36:39], s31 offen offset:0 nt lds
    buffer_load_dwordx4 v13, s[36:39], s31 offen offset:1024 nt lds
    buffer_load_dwordx4 v14, s[36:39], s31 offen offset:2048 nt lds
    buffer_load_dwordx4 v15, s[36:39], s31 offen offset:3072 nt lds
    s_mov_b32 m0, 159792
    s_mov_b64 exec, 1
    buffer_load_dword off, s[24:27], 0 lds
    s_mov_b64 exec, -1
    s_getpc_b64 s[62:63]
    s_cmp_lt_u32 s61, 159760
    s_cbranch_scc1 L_lslow
    s_mov_b32 m0, 0
    s_add_u32 s31, s80, 256
    buffer_load_dwordx4 v8, s[44:47], s31 offen offset:0  lds
    buffer_load_dwordx4 v9, s[44:47], s31 offen offset:1024  lds
    buffer_load_dwordx4 v10, s[44:47], s31 offen offset:2048  lds
    buffer_load_dwordx4 v11, s[44:47], s31 offen offset:3072  lds
    s_mov_b32 m0, 4096
    s_add_u32 s31, s80, 262400
    buffer_load_dwordx4 v8, s[44:47], s31 offen offset:0  lds
    buffer_load_dwordx4 v9, s[44:47], s31 offen offset:1024  lds
    buffer_load_dwordx4 v10, s[44:47], s31 offen offset:2048  lds
    buffer_load_dwordx4 v11, s[44:47], s31 offen offset:3072  lds
    s_mov_b32 m0, 65536
    s_add_u32 s31, s81, 256
    buffer_load_dwordx4 v8, s[44:47], s31 offen offset:0  lds
    buffer_load_dwordx4 v9, s[44:47], s31 offen offset:1024  lds
    buffer_load_dwordx4 v10, s[44:47], s31 offen offset:2048  lds
    buffer_load_dwordx4 v11, s[44:47], s31 offen offset:3072  lds
    s_mov_b32 m0, 69632
    s_add_u32 s31, s81, 262400
    buffer_load_dwordx4 v8, s[44:47], s31 offen offset:0  lds
    buffer_load_dwordx4 v9, s[44:47], s31 offen offset:1024  lds
    buffer_load_dwordx4 v10, s[44:47], s31 offen offset:2048  lds
    buffer_load_dwordx4 v11, s[44:47], s31 offen offset:3072  lds
    s_getpc_b64 s[62:63]
    s_cmp_lt_u32 s61, 159764
    s_cbranch_scc1 L_lslow
    s_mov_b32 m0, 8192
    s_mov_b32 s31, 65664
    buffer_load_dwordx4 v12, s[36:39], s31 offen offset:0 nt lds
    buffer_load_dwordx4 v13, s[36:39], s31 offen offset:1024 nt lds
    buffer_load_dwordx4 v14, s[36:39], s31 offen offset:2048 nt lds
    buffer_load_dwordx4 v15, s[36:39], s31 offen offset:3072 nt lds
    s_mov_b32 m0, 12288
    s_mov_b32 s31, 82048
    buffer_load_dwordx4 v12, s[36:39], s31 offen offset:0 nt lds
    buffer_load_dwordx4 v13, s[36:39], s31 offen offset:1024 nt lds
    buffer_load_dwordx4 v14, s[36:39], s31 offen offset:2048 nt lds
    buffer_load_dwordx4 v15, s[36:39], s31 offen offset:3072 nt lds
    s_mov_b32 m0, 159796
    s_mov_b64 exec, 1
    buffer_load_dword off, s[24:27], 0 lds
    s_mov_b64 exec, -1
    s_mov_b32 m0, 139264
    s_mov_b32 s31, 98432
    buffer_load_dwordx4 v12, s[36:39], s31 offen offset:0 nt lds
    buffer_load_dwordx4 v13, s[36:39], s31 offen offset:1024 nt lds
    buffer_load_dwordx4 v14, s[36:39], s31 offen offset:2048 nt lds
    buffer_load_dwordx4 v15, s[36:39], s31 offen offset:3072 nt lds
    s_mov_b32 m0, 143360
    s_mov_b32 s31, 114816
    buffer_load_dwordx4 v12, s[36:39], s31 offen offset:0 nt lds
    buffer_load_dwordx4 v13, s[36:39], s31 offen offset:1024 nt lds
    buffer_load_dwordx4 v14, s[36:39], s31 offen offset:2048 nt lds
    buffer_load_dwordx4 v15, s[36:39], s31 offen offset:3072 nt lds
    s_mov_b32 m0, 159800
    s_mov_b64 exec, 1
    buffer_load_dword off, s[24:27], 0 lds
    s_mov_b64 exec, -1
    s_getpc_b64 s[62:63]
    s_cmp_lt_u32 s61, 159768
    s_cbranch_scc1 L_lslow
    s_mov_b32 m0, 16384
    s_add_u32 s31, s82, 256
    buffer_load_dwordx4 v8, s[44:47], s31 offen offset:0  lds
    buffer_load_dwordx4 v9, s[44:47], s31 offen offset:1024  lds
    buffer_load_dwordx4 v10, s[44:47], s31 offen offset:2048  lds
    buffer_load_dwordx4 v11, s[44:47], s31 offen offset:3072  lds
    s_mov_b32 m0, 20480
    s_add_u32 s31, s82, 262400
    buffer_load_dwordx4 v8, s[44:47], s31 offen offset:0  lds
    buffer_load_dwordx4 v9, s[44:47], s31 offen offset:1024  lds
    buffer_load_dwordx4 v10, s[44:47], s31 offen offset:2048  lds
    buffer_load_dwordx4 v11, s[44:47], s31 offen offset:3072  lds
    s_mov_b32 m0, 147456
    s_add_u32 s31, s83, 256
    buffer_load_dwordx4 v8, s[44:47], s31 offen offset:0  lds
    buffer_load_dwordx4 v9, s[44:47], s31 offen offset:1024  lds
    buffer_load_dwordx4 v10, s[44:47], s31 offen offset:2048  lds
    buffer_load_dwordx4 v11, s[44:47], s31 offen offset:3072  lds
    s_mov_b32 m0, 151552
    s_add_u32 s31, s83, 262400
    buffer_load_dwordx4 v8, s[44:47], s31 offen offset:0  lds
    buffer_load_dwordx4 v9, s[44:47], s31 offen offset:1024  lds
    buffer_load_dwordx4 v10, s[44:47], s31 offen offset:2048  lds
    buffer_load_dwordx4 v11, s[44:47], s31 offen offset:3072  lds
    s_getpc_b64 s[62:63]
    s_cmp_lt_u32 s61, 159772
    s_cbranch_scc1 L_lslow
    s_mov_b32 m0, 24576
    s_mov_b32 s31, 131200
    buffer_load_dwordx4 v12, s[36:39], s31 offen offset:0 nt lds
    buffer_load_dwordx4 v13, s[36:39], s31 offen offset:1024 nt lds
    buffer_load_dwordx4 v14, s[36:39], s31 offen offset:2048 nt lds
    buffer_load_dwordx4 v15, s[36:39], s31 offen offset:3072 nt lds
    s_mov_b32 m0, 28672
    s_mov_b32 s31, 147584
    buffer_load_dwordx4 v12, s[36:39], s31 offen offset:0 nt lds
    buffer_load_dwordx4 v13, s[36:39], s31 offen offset:1024 nt lds
    buffer_load_dwordx4 v14, s[36:39], s31 offen offset:2048 nt lds
    buffer_load_dwordx4 v15, s[36:39], s31 offen offset:3072 nt lds
    s_mov_b32 m0, 159804
    s_mov_b64 exec, 1
    buffer_load_dword off, s[24:27], 0 lds
    s_mov_b64 exec, -1
    s_mov_b32 m0, 114688
    s_mov_b32 s31, 163968
    buffer_load_dwordx4 v12, s[36:39], s31 offen offset:0 nt lds
    buffer_load_dwordx4 v13, s[36:39], s31 offen offset:1024 nt lds
    buffer_load_dwordx4 v14, s[36:39], s31 offen offset:2048 nt lds
    buffer_load_dwordx4 v15, s[36:39], s31 offen offset:3072 nt lds
    s_mov_b32 m0, 118784
    s_mov_b32 s31, 180352
    buffer_load_dwordx4 v12, s[36:39], s31 offen offset:0 nt lds
    buffer_load_dwordx4 v13, s[36:39], s31 offen offset:1024 nt lds
    buffer_load_dwordx4 v14, s[36:39], s31 offen offset:2048 nt lds
    buffer_load_dwordx4 v15, s[36:39], s31 offen offset:3072 nt lds
    s_mov_b32 m0, 159808
    s_mov_b64 exec, 1
    buffer_load_dword off, s[24:27], 0 lds
    s_mov_b64 exec, -1
    s_getpc_b64 s[62:63]
    s_cmp_lt_u32 s61, 159776
    s_cbranch_scc1 L_lslow
    s_mov_b32 m0, 122880
    s_add_u32 s31, s77, 384
    buffer_load_dwordx4 v8, s[44:47], s31 offen offset:0  lds
    buffer_load_dwordx4 v9, s[44:47], s31 offen offset:1024  lds
    buffer_load_dwordx4 v10, s[44:47], s31 offen offset:2048  lds
    buffer_load_dwordx4 v11, s[44:47], s31 offen offset:3072  lds
    s_mov_b32 m0, 126976
    s_add_u32 s31, s77, 262528
    buffer_load_dwordx4 v8, s[44:47], s31 offen offset:0  lds
    buffer_load_dwordx4 v9, s[44:47], s31 offen offset:1024  lds
    buffer_load_dwordx4 v10, s[44:47], s31 offen offset:2048  lds
    buffer_load_dwordx4 v11, s[44:47], s31 offen offset:3072  lds
    s_mov_b32 m0, 131072
    s_add_u32 s31, s78, 384
    buffer_load_dwordx4 v8, s[44:47], s31 offen offset:0  lds
    buffer_load_dwordx4 v9, s[44:47], s31 offen offset:1024  lds
    buffer_load_dwordx4 v10, s[44:47], s31 offen offset:2048  lds
    buffer_load_dwordx4 v11, s[44:47], s31 offen offset:3072  lds
    s_mov_b32 m0, 135168
    s_add_u32 s31, s78, 262528
    buffer_load_dwordx4 v8, s[44:47], s31 offen offset:0  lds
    buffer_load_dwordx4 v9, s[44:47], s31 offen offset:1024  lds
    buffer_load_dwordx4 v10, s[44:47], s31 offen offset:2048  lds
    buffer_load_dwordx4 v11, s[44:47], s31 offen offset:3072  lds
    s_getpc_b64 s[62:63]
    s_cmp_lt_u32 s61, 159780
    s_cbranch_scc1 L_lslow
    s_mov_b32 m0, 32768
    s_mov_b32 s31, 196736
    buffer_load_dwordx4 v12, s[36:39], s31 offen offset:0 nt lds
    buffer_load_dwordx4 v13, s[36:39], s31 offen offset:1024 nt lds
    buffer_load_dwordx4 v14, s[36:39], s31 offen offset:2048 nt lds
    buffer_load_dwordx4 v15, s[36:39], s31 offen offset:3072 nt lds
    s_mov_b32 m0, 36864
    s_mov_b32 s31, 213120
    buffer_load_dwordx4 v12, s[36:39], s31 offen offset:0 nt lds
    buffer_load_dwordx4 v13, s[36:39], s31 offen offset:1024 nt lds
    buffer_load_dwordx4 v14, s[36:39], s31 offen offset:2048 nt lds
    buffer_load_dwordx4 v15, s[36:39], s31 offen offset:3072 nt lds
    s_mov_b32 m0, 159812
    s_mov_b64 exec, 1
    buffer_load_dword off, s[24:27], 0 lds
    s_mov_b64 exec, -1
    s_mov_b32 m0, 40960
    s_mov_b32 s31, 229504
    buffer_load_dwordx4 v12, s[36:39], s31 offen offset:0 nt lds
    buffer_load_dwordx4 v13, s[36:39], s31 offen offset:1024 nt lds
    buffer_load_dwordx4 v14, s[36:39], s31 offen offset:2048 nt lds
    buffer_load_dwordx4 v15, s[36:39], s31 offen offset:3072 nt lds
    s_mov_b32 m0, 45056
    s_mov_b32 s31, 245888
    buffer_load_dwordx4 v12, s[36:39], s31 offen offset:0 nt lds
    buffer_load_dwordx4 v13, s[36:39], s31 offen offset:1024 nt lds
    buffer_load_dwordx4 v14, s[36:39], s31 offen offset:2048 nt lds
    buffer_load_dwordx4 v15, s[36:39], s31 offen offset:3072 nt lds
    s_mov_b32 m0, 159816
    s_mov_b64 exec, 1
    buffer_load_dword off, s[24:27], 0 lds
    s_mov_b64 exec, -1
    s_getpc_b64 s[62:63]
    s_cmp_lt_u32 s61, 159784
    s_cbranch_scc1 L_lslow
    s_mov_b32 m0, 98304
    s_add_u32 s31, s79, 384
    buffer_load_dwordx4 v8, s[44:47], s31 offen offset:0  lds
    buffer_load_dwordx4 v9, s[44:47], s31 offen offset:1024  lds
    buffer_load_dwordx4 v10, s[44:47], s31 offen offset:2048  lds
    buffer_load_dwordx4 v11, s[44:47], s31 offen offset:3072  lds
    s_mov_b32 m0, 102400
    s_add_u32 s31, s79, 262528
    buffer_load_dwordx4 v8, s[44:47], s31 offen offset:0  lds
    buffer_load_dwordx4 v9, s[44:47], s31 offen offset:1024  lds
    buffer_load_dwordx4 v10, s[44:47], s31 offen offset:2048  lds
    buffer_load_dwordx4 v11, s[44:47], s31 offen offset:3072  lds
    s_mov_b32 m0, 106496
    s_add_u32 s31, s80, 384
    buffer_load_dwordx4 v8, s[44:47], s31 offen offset:0  lds
    buffer_load_dwordx4 v9, s[44:47], s31 offen offset:1024  lds
    buffer_load_dwordx4 v10, s[44:47], s31 offen offset:2048  lds
    buffer_load_dwordx4 v11, s[44:47], s31 offen offset:3072  lds
    s_mov_b32 m0, 110592
    s_add_u32 s31, s80, 262528
    buffer_load_dwordx4 v8, s[44:47], s31 offen offset:0  lds
    buffer_load_dwordx4 v9, s[44:47], s31 offen offset:1024  lds
    buffer_load_dwordx4 v10, s[44:47], s31 offen offset:2048  lds
    buffer_load_dwordx4 v11, s[44:47], s31 offen offset:3072  lds
    s_getpc_b64 s[62:63]
    s_cmp_lt_u32 s61, 159788
    s_cbranch_scc1 L_lslow
    s_mov_b32 m0, 73728
    s_mov_b32 s31, 256
    buffer_load_dwordx4 v12, s[36:39], s31 offen offset:0 nt lds
    buffer_load_dwordx4 v13, s[36:39], s31 offen offset:1024 nt lds
    buffer_load_dwordx4 v14, s[36:39], s31 offen offset:2048 nt lds
    buffer_load_dwordx4 v15, s[36:39], s31 offen offset:3072 nt lds
    s_mov_b32 m0, 77824
    s_mov_b32 s31, 16640
    buffer_load_dwordx4 v12, s[36:39], s31 offen offset:0 nt lds
    buffer_load_dwordx4 v13, s[36:39], s31 offen offset:1024 nt lds
    buffer_load_dwordx4 v14, s[36:39], s31 offen offset:2048 nt lds
    buffer_load_dwordx4 v15, s[36:39], s31 offen offset:3072 nt lds
    s_mov_b32 m0, 159820
    s_mov_b64 exec, 1
    buffer_load_dword off, s[24:27], 0 lds
    s_mov_b64 exec, -1
    s_mov_b32 m0, 90112
    s_mov_b32 s31, 33024
    buffer_load_dwordx4 v12, s[36:39], s31 offen offset:0 nt lds
    buffer_load_dwordx4 v13, s[36:39], s31 offen offset:1024 nt lds
    buffer_load_dwordx4 v14, s[36:39], s31 offen offset:2048 nt lds
    buffer_load_dwordx4 v15, s[36:39], s31 offen offset:3072 nt lds
    s_mov_b32 m0, 94208
    s_mov_b32 s31, 49408
    buffer_load_dwordx4 v12, s[36:39], s31 offen offset:0 nt lds
    buffer_load_dwordx4 v13, s[36:39], s31 offen offset:1024 nt lds
    buffer_load_dwordx4 v14, s[36:39], s31 offen offset:2048 nt lds
    buffer_load_dwordx4 v15, s[36:39], s31 offen offset:3072 nt lds
    s_mov_b32 m0, 159824
    s_mov_b64 exec, 1
    buffer_load_dword off, s[24:27], 0 lds
    s_mov_b64 exec, -1
    s_getpc_b64 s[62:63]
    s_cmp_lt_u32 s61, 159792
    s_cbranch_scc1 L_lslow
    s_mov_b32 m0, 49152
    s_add_u32 s31, s81, 384
    buffer_load_dwordx4 v8, s[44:47], s31 offen offset:0  lds
    buffer_load_dwordx4 v9, s[44:47], s31 offen offset:1024  lds
    buffer_load_dwordx4 v10, s[44:47], s31 offen offset:2048  lds
    buffer_load_dwordx4 v11, s[44:47], s31 offen offset:3072  lds
    s_mov_b32 m0, 53248
    s_add_u32 s31, s81, 262528
    buffer_load_dwordx4 v8, s[44:47], s31 offen offset:0  lds
    buffer_load_dwordx4 v9, s[44:47], s31 offen offset:1024  lds
    buffer_load_dwordx4 v10, s[44:47], s31 offen offset:2048  lds
    buffer_load_dwordx4 v11, s[44:47], s31 offen offset:3072  lds
    s_mov_b32 m0, 81920
    s_add_u32 s31, s82, 384
    buffer_load_dwordx4 v8, s[44:47], s31 offen offset:0  lds
    buffer_load_dwordx4 v9, s[44:47], s31 offen offset:1024  lds
    buffer_load_dwordx4 v10, s[44:47], s31 offen offset:2048  lds
    buffer_load_dwordx4 v11, s[44:47], s31 offen offset:3072  lds
    s_mov_b32 m0, 86016
    s_add_u32 s31, s82, 262528
    buffer_load_dwordx4 v8, s[44:47], s31 offen offset:0  lds
    buffer_load_dwordx4 v9, s[44:47], s31 offen offset:1024  lds
    buffer_load_dwordx4 v10, s[44:47], s31 offen offset:2048  lds
    buffer_load_dwordx4 v11, s[44:47], s31 offen offset:3072  lds
    s_getpc_b64 s[62:63]
    s_cmp_lt_u32 s61, 159796
    s_cbranch_scc1 L_lslow
    s_mov_b32 m0, 8192
    s_mov_b32 s31, 65792
    buffer_load_dwordx4 v12, s[36:39], s31 offen offset:0 nt lds
    buffer_load_dwordx4 v13, s[36:39], s31 offen offset:1024 nt lds
    buffer_load_dwordx4 v14, s[36:39], s31 offen offset:2048 nt lds
    buffer_load_dwordx4 v15, s[36:39], s31 offen offset:3072 nt lds
    s_mov_b32 m0, 12288
    s_mov_b32 s31, 82176
    buffer_load_dwordx4 v12, s[36:39], s31 offen offset:0 nt lds
    buffer_load_dwordx4 v13, s[36:39], s31 offen offset:1024 nt lds
    buffer_load_dwordx4 v14, s[36:39], s31 offen offset:2048 nt lds
    buffer_load_dwordx4 v15, s[36:39], s31 offen offset:3072 nt lds
    s_mov_b32 m0, 159828
    s_mov_b64 exec, 1
    buffer_load_dword off, s[24:27], 0 lds
    s_mov_b64 exec, -1
    s_mov_b32 m0, 57344
    s_mov_b32 s31, 98560
    buffer_load_dwordx4 v12, s[36:39], s31 offen offset:0 nt lds
    buffer_load_dwordx4 v13, s[36:39], s31 offen offset:1024 nt lds
    buffer_load_dwordx4 v14, s[36:39], s31 offen offset:2048 nt lds
    buffer_load_dwordx4 v15, s[36:39], s31 offen offset:3072 nt lds
    s_mov_b32 m0, 61440
    s_mov_b32 s31, 114944
    buffer_load_dwordx4 v12, s[36:39], s31 offen offset:0 nt lds
    buffer_load_dwordx4 v13, s[36:39], s31 offen offset:1024 nt lds
    buffer_load_dwordx4 v14, s[36:39], s31 offen offset:2048 nt lds
    buffer_load_dwordx4 v15, s[36:39], s31 offen offset:3072 nt lds
    s_mov_b32 m0, 159832
    s_mov_b64 exec, 1
    buffer_load_dword off, s[24:27], 0 lds
    s_mov_b64 exec, -1
    s_getpc_b64 s[62:63]
    s_cmp_lt_u32 s61, 159800
    s_cbranch_scc1 L_lslow
    s_mov_b32 m0, 0
    s_add_u32 s31, s83, 384
    buffer_load_dwordx4 v8, s[44:47], s31 offen offset:0  lds
    buffer_load_dwordx4 v9, s[44:47], s31 offen offset:1024  lds
    buffer_load_dwordx4 v10, s[44:47], s31 offen offset:2048  lds
    buffer_load_dwordx4 v11, s[44:47], s31 offen offset:3072  lds
    s_mov_b32 m0, 4096
    s_add_u32 s31, s83, 262528
    buffer_load_dwordx4 v8, s[44:47], s31 offen offset:0  lds
    buffer_load_dwordx4 v9, s[44:47], s31 offen offset:1024  lds
    buffer_load_dwordx4 v10, s[44:47], s31 offen offset:2048  lds
    buffer_load_dwordx4 v11, s[44:47], s31 offen offset:3072  lds
    s_mov_b32 m0, 139264
    s_mov_b32 s31, 131328
    buffer_load_dwordx4 v12, s[36:39], s31 offen offset:0 nt lds
    buffer_load_dwordx4 v13, s[36:39], s31 offen offset:1024 nt lds
    buffer_load_dwordx4 v14, s[36:39], s31 offen offset:2048 nt lds
    buffer_load_dwordx4 v15, s[36:39], s31 offen offset:3072 nt lds
    s_mov_b32 m0, 143360
    s_mov_b32 s31, 147712
    buffer_load_dwordx4 v12, s[36:39], s31 offen offset:0 nt lds
    buffer_load_dwordx4 v13, s[36:39], s31 offen offset:1024 nt lds
    buffer_load_dwordx4 v14, s[36:39], s31 offen offset:2048 nt lds
    buffer_load_dwordx4 v15, s[36:39], s31 offen offset:3072 nt lds
    s_mov_b32 m0, 159836
    s_mov_b64 exec, 1
    buffer_load_dword off, s[24:27], 0 lds
    s_mov_b64 exec, -1
    s_getpc_b64 s[62:63]
    s_cmp_lt_u32 s61, 159804
    s_cbranch_scc1 L_lslow
    s_mov_b32 m0, 24576
    s_mov_b32 s31, 164096
    buffer_load_dwordx4 v12, s[36:39], s31 offen offset:0 nt lds
    buffer_load_dwordx4 v13, s[36:39], s31 offen offset:1024 nt lds
    buffer_load_dwordx4 v14, s[36:39], s31 offen offset:2048 nt lds
    buffer_load_dwordx4 v15, s[36:39], s31 offen offset:3072 nt lds
    s_mov_b32 m0, 28672
    s_mov_b32 s31, 180480
    buffer_load_dwordx4 v12, s[36:39], s31 offen offset:0 nt lds
    buffer_load_dwordx4 v13, s[36:39], s31 offen offset:1024 nt lds
    buffer_load_dwordx4 v14, s[36:39], s31 offen offset:2048 nt lds
    buffer_load_dwordx4 v15, s[36:39], s31 offen offset:3072 nt lds
    s_mov_b32 m0, 159840
    s_mov_b64 exec, 1
    buffer_load_dword off, s[24:27], 0 lds
    s_mov_b64 exec, -1
    s_mov_b32 m0, 65536
    s_mov_b32 s31, 196864
    buffer_load_dwordx4 v12, s[36:39], s31 offen offset:0 nt lds
    buffer_load_dwordx4 v13, s[36:39], s31 offen offset:1024 nt lds
    buffer_load_dwordx4 v14, s[36:39], s31 offen offset:2048 nt lds
    buffer_load_dwordx4 v15, s[36:39], s31 offen offset:3072 nt lds
    s_mov_b32 m0, 69632
    s_mov_b32 s31, 213248
    buffer_load_dwordx4 v12, s[36:39], s31 offen offset:0 nt lds
    buffer_load_dwordx4 v13, s[36:39], s31 offen offset:1024 nt lds
    buffer_load_dwordx4 v14, s[36:39], s31 offen offset:2048 nt lds
    buffer_load_dwordx4 v15, s[36:39], s31 offen offset:3072 nt lds
    s_getpc_b64 s[62:63]
    s_cmp_lt_u32 s61, 159808
    s_cbranch_scc1 L_lslow
    s_mov_b32 m0, 16384
    s_mov_b32 s31, 229632
    buffer_load_dwordx4 v12, s[36:39], s31 offen offset:0 nt lds
    buffer_load_dwordx4 v13, s[36:39], s31 offen offset:1024 nt lds
    buffer_load_dwordx4 v14, s[36:39], s31 offen offset:2048 nt lds
    buffer_load_dwordx4 v15, s[36:39], s31 offen offset:3072 nt lds
    s_mov_b32 m0, 20480
    s_mov_b32 s31, 246016
    buffer_load_dwordx4 v12, s[36:39], s31 offen offset:0 nt lds
    buffer_load_dwordx4 v13, s[36:39], s31 offen offset:1024 nt lds
    buffer_load_dwordx4 v14, s[36:39], s31 offen offset:2048 nt lds
    buffer_load_dwordx4 v15, s[36:39], s31 offen offset:3072 nt lds
    s_mov_b32 m0, 159844
    s_mov_b64 exec, 1
    buffer_load_dword off, s[24:27], 0 lds
    s_mov_b64 exec, -1
    s_mov_b32 m0, 114688
    s_mov_b32 s31, 384
    buffer_load_dwordx4 v12, s[36:39], s31 offen offset:0 nt lds
    buffer_load_dwordx4 v13, s[36:39], s31 offen offset:1024 nt lds
    buffer_load_dwordx4 v14, s[36:39], s31 offen offset:2048 nt lds
    buffer_load_dwordx4 v15, s[36:39], s31 offen offset:3072 nt lds
    s_mov_b32 m0, 118784
    s_mov_b32 s31, 16768
    buffer_load_dwordx4 v12, s[36:39], s31 offen offset:0 nt lds
    buffer_load_dwordx4 v13, s[36:39], s31 offen offset:1024 nt lds
    buffer_load_dwordx4 v14, s[36:39], s31 offen offset:2048 nt lds
    buffer_load_dwordx4 v15, s[36:39], s31 offen offset:3072 nt lds
    s_getpc_b64 s[62:63]
    s_cmp_lt_u32 s61, 159812
    s_cbranch_scc1 L_lslow
    s_mov_b32 m0, 32768
    s_mov_b32 s31, 33152
    buffer_load_dwordx4 v12, s[36:39], s31 offen offset:0 nt lds
    buffer_load_dwordx4 v13, s[36:39], s31 offen offset:1024 nt lds
    buffer_load_dwordx4 v14, s[36:39], s31 offen offset:2048 nt lds
    buffer_load_dwordx4 v15, s[36:39], s31 offen offset:3072 nt lds
    s_mov_b32 m0, 36864
    s_mov_b32 s31, 49536
    buffer_load_dwordx4 v12, s[36:39], s31 offen offset:0 nt lds
    buffer_load_dwordx4 v13, s[36:39], s31 offen offset:1024 nt lds
    buffer_load_dwordx4 v14, s[36:39], s31 offen offset:2048 nt lds
    buffer_load_dwordx4 v15, s[36:39], s31 offen offset:3072 nt lds
    s_mov_b32 m0, 159848
    s_mov_b64 exec, 1
    buffer_load_dword off, s[24:27], 0 lds
    s_mov_b64 exec, -1
    s_mov_b32 m0, 147456
    s_mov_b32 s31, 65920
    buffer_load_dwordx4 v12, s[36:39], s31 offen offset:0 nt lds
    buffer_load_dwordx4 v13, s[36:39], s31 offen offset:1024 nt lds
    buffer_load_dwordx4 v14, s[36:39], s31 offen offset:2048 nt lds
    buffer_load_dwordx4 v15, s[36:39], s31 offen offset:3072 nt lds
    s_mov_b32 m0, 151552
    s_mov_b32 s31, 82304
    buffer_load_dwordx4 v12, s[36:39], s31 offen offset:0 nt lds
    buffer_load_dwordx4 v13, s[36:39], s31 offen offset:1024 nt lds
    buffer_load_dwordx4 v14, s[36:39], s31 offen offset:2048 nt lds
    buffer_load_dwordx4 v15, s[36:39], s31 offen offset:3072 nt lds
    s_getpc_b64 s[62:63]
    s_cmp_lt_u32 s61, 159816
    s_cbranch_scc1 L_lslow
    s_mov_b32 m0, 40960
    s_mov_b32 s31, 98688
    buffer_load_dwordx4 v12, s[36:39], s31 offen offset:0 nt lds
    buffer_load_dwordx4 v13, s[36:39], s31 offen offset:1024 nt lds
    buffer_load_dwordx4 v14, s[36:39], s31 offen offset:2048 nt lds
    buffer_load_dwordx4 v15, s[36:39], s31 offen offset:3072 nt lds
    s_mov_b32 m0, 45056
    s_mov_b32 s31, 115072
    buffer_load_dwordx4 v12, s[36:39], s31 offen offset:0 nt lds
    buffer_load_dwordx4 v13, s[36:39], s31 offen offset:1024 nt lds
    buffer_load_dwordx4 v14, s[36:39], s31 offen offset:2048 nt lds
    buffer_load_dwordx4 v15, s[36:39], s31 offen offset:3072 nt lds
    s_mov_b32 m0, 159852
    s_mov_b64 exec, 1
    buffer_load_dword off, s[24:27], 0 lds
    s_mov_b64 exec, -1
    s_mov_b32 m0, 122880
    s_mov_b32 s31, 131456
    buffer_load_dwordx4 v12, s[36:39], s31 offen offset:0 nt lds
    buffer_load_dwordx4 v13, s[36:39], s31 offen offset:1024 nt lds
    buffer_load_dwordx4 v14, s[36:39], s31 offen offset:2048 nt lds
    buffer_load_dwordx4 v15, s[36:39], s31 offen offset:3072 nt lds
    s_mov_b32 m0, 126976
    s_mov_b32 s31, 147840
    buffer_load_dwordx4 v12, s[36:39], s31 offen offset:0 nt lds
    buffer_load_dwordx4 v13, s[36:39], s31 offen offset:1024 nt lds
    buffer_load_dwordx4 v14, s[36:39], s31 offen offset:2048 nt lds
    buffer_load_dwordx4 v15, s[36:39], s31 offen offset:3072 nt lds
    s_getpc_b64 s[62:63]
    s_cmp_lt_u32 s61, 159820
    s_cbranch_scc1 L_lslow
    s_mov_b32 m0, 73728
    s_mov_b32 s31, 164224
    buffer_load_dwordx4 v12, s[36:39], s31 offen offset:0 nt lds
    buffer_load_dwordx4 v13, s[36:39], s31 offen offset:1024 nt lds
    buffer_load_dwordx4 v14, s[36:39], s31 offen offset:2048 nt lds
    buffer_load_dwordx4 v15, s[36:39], s31 offen offset:3072 nt lds
    s_mov_b32 m0, 77824
    s_mov_b32 s31, 180608
    buffer_load_dwordx4 v12, s[36:39], s31 offen offset:0 nt lds
    buffer_load_dwordx4 v13, s[36:39], s31 offen offset:1024 nt lds
    buffer_load_dwordx4 v14, s[36:39], s31 offen offset:2048 nt lds
    buffer_load_dwordx4 v15, s[36:39], s31 offen offset:3072 nt lds
    s_mov_b32 m0, 159856
    s_mov_b64 exec, 1
    buffer_load_dword off, s[24:27], 0 lds
    s_mov_b64 exec, -1
    s_mov_b32 m0, 131072
    s_mov_b32 s31, 196992
    buffer_load_dwordx4 v12, s[36:39], s31 offen offset:0 nt lds
    buffer_load_dwordx4 v13, s[36:39], s31 offen offset:1024 nt lds
    buffer_load_dwordx4 v14, s[36:39], s31 offen offset:2048 nt lds
    buffer_load_dwordx4 v15, s[36:39], s31 offen offset:3072 nt lds
    s_mov_b32 m0, 135168
    s_mov_b32 s31, 213376
    buffer_load_dwordx4 v12, s[36:39], s31 offen offset:0 nt lds
    buffer_load_dwordx4 v13, s[36:39], s31 offen offset:1024 nt lds
    buffer_load_dwordx4 v14, s[36:39], s31 offen offset:2048 nt lds
    buffer_load_dwordx4 v15, s[36:39], s31 offen offset:3072 nt lds
    s_getpc_b64 s[62:63]
    s_cmp_lt_u32 s61, 159824
    s_cbranch_scc1 L_lslow
    s_mov_b32 m0, 90112
    s_mov_b32 s31, 229760
    buffer_load_dwordx4 v12, s[36:39], s31 offen offset:0 nt lds
    buffer_load_dwordx4 v13, s[36:39], s31 offen offset:1024 nt lds
    buffer_load_dwordx4 v14, s[36:39], s31 offen offset:2048 nt lds
    buffer_load_dwordx4 v15, s[36:39], s31 offen offset:3072 nt lds
    s_mov_b32 m0, 94208
    s_mov_b32 s31, 246144
    buffer_load_dwordx4 v12, s[36:39], s31 offen offset:0 nt lds
    buffer_load_dwordx4 v13, s[36:39], s31 offen offset:1024 nt lds
    buffer_load_dwordx4 v14, s[36:39], s31 offen offset:2048 nt lds
    buffer_load_dwordx4 v15, s[36:39], s31 offen offset:3072 nt lds
    s_mov_b32 m0, 159860
    s_mov_b64 exec, 1
    buffer_load_dword off, s[24:27], 0 lds
    s_mov_b64 exec, -1
    s_mov_b32 m0, 98304
    s_mov_b32 s31, 0
    buffer_load_dwordx4 v20, s[40:43], s31 offen offset:0 nt lds
    buffer_load_dwordx4 v21, s[40:43], s31 offen offset:1024 nt lds
    buffer_load_dwordx4 v22, s[40:43], s31 offen offset:2048 nt lds
    buffer_load_dwordx4 v23, s[40:43], s31 offen offset:3072 nt lds
    s_mov_b32 m0, 102400
    s_mov_b32 s31, 16384
    buffer_load_dwordx4 v20, s[40:43], s31 offen offset:0 nt lds
    buffer_load_dwordx4 v21, s[40:43], s31 offen offset:1024 nt lds
    buffer_load_dwordx4 v22, s[40:43], s31 offen offset:2048 nt lds
    buffer_load_dwordx4 v23, s[40:43], s31 offen offset:3072 nt lds
    s_getpc_b64 s[62:63]
    s_cmp_lt_u32 s61, 159828
    s_cbranch_scc1 L_lslow
    s_mov_b32 m0, 8192
    s_mov_b32 s31, 32768
    buffer_load_dwordx4 v20, s[40:43], s31 offen offset:0 nt lds
    buffer_load_dwordx4 v21, s[40:43], s31 offen offset:1024 nt lds
    buffer_load_dwordx4 v22, s[40:43], s31 offen offset:2048 nt lds
    buffer_load_dwordx4 v23, s[40:43], s31 offen offset:3072 nt lds
    s_mov_b32 m0, 12288
    s_mov_b32 s31, 49152
    buffer_load_dwordx4 v20, s[40:43], s31 offen offset:0 nt lds
    buffer_load_dwordx4 v21, s[40:43], s31 offen offset:1024 nt lds
    buffer_load_dwordx4 v22, s[40:43], s31 offen offset:2048 nt lds
    buffer_load_dwordx4 v23, s[40:43], s31 offen offset:3072 nt lds
    s_mov_b32 m0, 159864
    s_mov_b64 exec, 1
    buffer_load_dword off, s[24:27], 0 lds
    s_mov_b64 exec, -1
    s_mov_b32 m0, 106496
    s_mov_b32 s31, 65536
    buffer_load_dwordx4 v20, s[40:43], s31 offen offset:0 nt lds
    buffer_load_dwordx4 v21, s[40:43], s31 offen offset:1024 nt lds
    buffer_load_dwordx4 v22, s[40:43], s31 offen offset:2048 nt lds
    buffer_load_dwordx4 v23, s[40:43], s31 offen offset:3072 nt lds
    s_mov_b32 m0, 110592
    s_mov_b32 s31, 81920
    buffer_load_dwordx4 v20, s[40:43], s31 offen offset:0 nt lds
    buffer_load_dwordx4 v21, s[40:43], s31 offen offset:1024 nt lds
    buffer_load_dwordx4 v22, s[40:43], s31 offen offset:2048 nt lds
    buffer_load_dwordx4 v23, s[40:43], s31 offen offset:3072 nt lds
    s_getpc_b64 s[62:63]
    s_cmp_lt_u32 s61, 159832
    s_cbranch_scc1 L_lslow
    s_mov_b32 m0, 49152
    s_mov_b32 s31, 98304
    buffer_load_dwordx4 v20, s[40:43], s31 offen offset:0 nt lds
    buffer_load_dwordx4 v21, s[40:43], s31 offen offset:1024 nt lds
    buffer_load_dwordx4 v22, s[40:43], s31 offen offset:2048 nt lds
    buffer_load_dwordx4 v23, s[40:43], s31 offen offset:3072 nt lds
    s_mov_b32 m0, 53248
    s_mov_b32 s31, 114688
    buffer_load_dwordx4 v20, s[40:43], s31 offen offset:0 nt lds
    buffer_load_dwordx4 v21, s[40:43], s31 offen offset:1024 nt lds
    buffer_load_dwordx4 v22, s[40:43], s31 offen offset:2048 nt lds
    buffer_load_dwordx4 v23, s[40:43], s31 offen offset:3072 nt lds
    s_mov_b32 m0, 159868
    s_mov_b64 exec, 1
    buffer_load_dword off, s[24:27], 0 lds
    s_mov_b64 exec, -1
    s_mov_b32 m0, 57344
    s_mov_b32 s31, 131072
    buffer_load_dwordx4 v20, s[40:43], s31 offen offset:0 nt lds
    buffer_load_dwordx4 v21, s[40:43], s31 offen offset:1024 nt lds
    buffer_load_dwordx4 v22, s[40:43], s31 offen offset:2048 nt lds
    buffer_load_dwordx4 v23, s[40:43], s31 offen offset:3072 nt lds
    s_mov_b32 m0, 61440
    s_mov_b32 s31, 147456
    buffer_load_dwordx4 v20, s[40:43], s31 offen offset:0 nt lds
    buffer_load_dwordx4 v21, s[40:43], s31 offen offset:1024 nt lds
    buffer_load_dwordx4 v22, s[40:43], s31 offen offset:2048 nt lds
    buffer_load_dwordx4 v23, s[40:43], s31 offen offset:3072 nt lds
    s_getpc_b64 s[62:63]
    s_cmp_lt_u32 s61, 159836
    s_cbranch_scc1 L_lslow
    s_mov_b32 m0, 81920
    s_mov_b32 s31, 163840
    buffer_load_dwordx4 v20, s[40:43], s31 offen offset:0 nt lds
    buffer_load_dwordx4 v21, s[40:43], s31 offen offset:1024 nt lds
    buffer_load_dwordx4 v22, s[40:43], s31 offen offset:2048 nt lds
    buffer_load_dwordx4 v23, s[40:43], s31 offen offset:3072 nt lds
    s_mov_b32 m0, 86016
    s_mov_b32 s31, 180224
    buffer_load_dwordx4 v20, s[40:43], s31 offen offset:0 nt lds
    buffer_load_dwordx4 v21, s[40:43], s31 offen offset:1024 nt lds
    buffer_load_dwordx4 v22, s[40:43], s31 offen offset:2048 nt lds
    buffer_load_dwordx4 v23, s[40:43], s31 offen offset:3072 nt lds
    s_mov_b32 m0, 159872
    s_mov_b64 exec, 1
    buffer_load_dword off, s[24:27], 0 lds
    s_mov_b64 exec, -1
    s_mov_b32 m0, 139264
    s_mov_b32 s31, 196608
    buffer_load_dwordx4 v20, s[40:43], s31 offen offset:0 nt lds
    buffer_load_dwordx4 v21, s[40:43], s31 offen offset:1024 nt lds
    buffer_load_dwordx4 v22, s[40:43], s31 offen offset:2048 nt lds
    buffer_load_dwordx4 v23, s[40:43], s31 offen offset:3072 nt lds
    s_mov_b32 m0, 143360
    s_mov_b32 s31, 212992
    buffer_load_dwordx4 v20, s[40:43], s31 offen offset:0 nt lds
    buffer_load_dwordx4 v21, s[40:43], s31 offen offset:1024 nt lds
    buffer_load_dwordx4 v22, s[40:43], s31 offen offset:2048 nt lds
    buffer_load_dwordx4 v23, s[40:43], s31 offen offset:3072 nt lds
    s_getpc_b64 s[62:63]
    s_cmp_lt_u32 s61, 159840
    s_cbranch_scc1 L_lslow
    s_mov_b32 m0, 0
    s_mov_b32 s31, 229376
    buffer_load_dwordx4 v20, s[40:43], s31 offen offset:0 nt lds
    buffer_load_dwordx4 v21, s[40:43], s31 offen offset:1024 nt lds
    buffer_load_dwordx4 v22, s[40:43], s31 offen offset:2048 nt lds
    buffer_load_dwordx4 v23, s[40:43], s31 offen offset:3072 nt lds
    s_mov_b32 m0, 4096
    s_mov_b32 s31, 245760
    buffer_load_dwordx4 v20, s[40:43], s31 offen offset:0 nt lds
    buffer_load_dwordx4 v21, s[40:43], s31 offen offset:1024 nt lds
    buffer_load_dwordx4 v22, s[40:43], s31 offen offset:2048 nt lds
    buffer_load_dwordx4 v23, s[40:43], s31 offen offset:3072 nt lds
    s_mov_b32 m0, 159876
    s_mov_b64 exec, 1
    buffer_load_dword off, s[24:27], 0 lds
    s_mov_b64 exec, -1
    s_mov_b32 m0, 24576
    s_mov_b32 s31, 128
    buffer_load_dwordx4 v20, s[40:43], s31 offen offset:0 nt lds
    buffer_load_dwordx4 v21, s[40:43], s31 offen offset:1024 nt lds
    buffer_load_dwordx4 v22, s[40:43], s31 offen offset:2048 nt lds
    buffer_load_dwordx4 v23, s[40:43], s31 offen offset:3072 nt lds
    s_mov_b32 m0, 28672
    s_mov_b32 s31, 16512
    buffer_load_dwordx4 v20, s[40:43], s31 offen offset:0 nt lds
    buffer_load_dwordx4 v21, s[40:43], s31 offen offset:1024 nt lds
    buffer_load_dwordx4 v22, s[40:43], s31 offen offset:2048 nt lds
    buffer_load_dwordx4 v23, s[40:43], s31 offen offset:3072 nt lds
    s_getpc_b64 s[62:63]
    s_cmp_lt_u32 s61, 159844
    s_cbranch_scc1 L_lslow
    s_mov_b32 m0, 16384
    s_mov_b32 s31, 32896
    buffer_load_dwordx4 v20, s[40:43], s31 offen offset:0 nt lds
    buffer_load_dwordx4 v21, s[40:43], s31 offen offset:1024 nt lds
    buffer_load_dwordx4 v22, s[40:43], s31 offen offset:2048 nt lds
    buffer_load_dwordx4 v23, s[40:43], s31 offen offset:3072 nt lds
    s_mov_b32 m0, 20480
    s_mov_b32 s31, 49280
    buffer_load_dwordx4 v20, s[40:43], s31 offen offset:0 nt lds
    buffer_load_dwordx4 v21, s[40:43], s31 offen offset:1024 nt lds
    buffer_load_dwordx4 v22, s[40:43], s31 offen offset:2048 nt lds
    buffer_load_dwordx4 v23, s[40:43], s31 offen offset:3072 nt lds
    s_mov_b32 m0, 159880
    s_mov_b64 exec, 1
    buffer_load_dword off, s[24:27], 0 lds
    s_mov_b64 exec, -1
    s_mov_b32 m0, 65536
    s_add_u32 s31, s70, 0
    buffer_load_dwordx4 v24, s[48:51], s31 offen offset:0  lds
    buffer_load_dwordx4 v25, s[48:51], s31 offen offset:1024  lds
    buffer_load_dwordx4 v26, s[48:51], s31 offen offset:2048  lds
    buffer_load_dwordx4 v27, s[48:51], s31 offen offset:3072  lds
    s_mov_b32 m0, 69632
    s_add_u32 s31, s70, 28672
    buffer_load_dwordx4 v24, s[48:51], s31 offen offset:0  lds
    buffer_load_dwordx4 v25, s[48:51], s31 offen offset:1024  lds
    buffer_load_dwordx4 v26, s[48:51], s31 offen offset:2048  lds
    buffer_load_dwordx4 v27, s[48:51], s31 offen offset:3072  lds
    s_getpc_b64 s[62:63]
    s_cmp_lt_u32 s61, 159848
    s_cbranch_scc1 L_lslow
    s_mov_b32 m0, 32768
    s_add_u32 s31, s71, 0
    buffer_load_dwordx4 v24, s[48:51], s31 offen offset:0  lds
    buffer_load_dwordx4 v25, s[48:51], s31 offen offset:1024  lds
    buffer_load_dwordx4 v26, s[48:51], s31 offen offset:2048  lds
    buffer_load_dwordx4 v27, s[48:51], s31 offen offset:3072  lds
    s_mov_b32 m0, 36864
    s_add_u32 s31, s71, 28672
    buffer_load_dwordx4 v24, s[48:51], s31 offen offset:0  lds
    buffer_load_dwordx4 v25, s[48:51], s31 offen offset:1024  lds
    buffer_load_dwordx4 v26, s[48:51], s31 offen offset:2048  lds
    buffer_load_dwordx4 v27, s[48:51], s31 offen offset:3072  lds
    s_mov_b32 m0, 114688
    s_mov_b32 s31, 65664
    buffer_load_dwordx4 v20, s[40:43], s31 offen offset:0 nt lds
    buffer_load_dwordx4 v21, s[40:43], s31 offen offset:1024 nt lds
    buffer_load_dwordx4 v22, s[40:43], s31 offen offset:2048 nt lds
    buffer_load_dwordx4 v23, s[40:43], s31 offen offset:3072 nt lds
    s_mov_b32 m0, 118784
    s_mov_b32 s31, 82048
    buffer_load_dwordx4 v20, s[40:43], s31 offen offset:0 nt lds
    buffer_load_dwordx4 v21, s[40:43], s31 offen offset:1024 nt lds
    buffer_load_dwordx4 v22, s[40:43], s31 offen offset:2048 nt lds
    buffer_load_dwordx4 v23, s[40:43], s31 offen offset:3072 nt lds
    s_mov_b32 m0, 159884
    s_mov_b64 exec, 1
    buffer_load_dword off, s[24:27], 0 lds
    s_mov_b64 exec, -1
    s_getpc_b64 s[62:63]
    s_cmp_lt_u32 s61, 159852
    s_cbranch_scc1 L_lslow
    s_mov_b32 m0, 40960
    s_mov_b32 s31, 98432
    buffer_load_dwordx4 v20, s[40:43], s31 offen offset:0 nt lds
    buffer_load_dwordx4 v21, s[40:43], s31 offen offset:1024 nt lds
    buffer_load_dwordx4 v22, s[40:43], s31 offen offset:2048 nt lds
    buffer_load_dwordx4 v23, s[40:43], s31 offen offset:3072 nt lds
    s_mov_b32 m0, 45056
    s_mov_b32 s31, 114816
    buffer_load_dwordx4 v20, s[40:43], s31 offen offset:0 nt lds
    buffer_load_dwordx4 v21, s[40:43], s31 offen offset:1024 nt lds
    buffer_load_dwordx4 v22, s[40:43], s31 offen offset:2048 nt lds
    buffer_load_dwordx4 v23, s[40:43], s31 offen offset:3072 nt lds
    s_mov_b32 m0, 159888
    s_mov_b64 exec, 1
    buffer_load_dword off, s[24:27], 0 lds
    s_mov_b64 exec, -1
    s_mov_b32 m0, 147456
    s_add_u32 s31, s72, 0
    buffer_load_dwordx4 v24, s[48:51], s31 offen offset:0  lds
    buffer_load_dwordx4 v25, s[48:51], s31 offen offset:1024  lds
    buffer_load_dwordx4 v26, s[48:51], s31 offen offset:2048  lds
    buffer_load_dwordx4 v27, s[48:51], s31 offen offset:3072  lds
    s_mov_b32 m0, 151552
    s_add_u32 s31, s72, 28672
    buffer_load_dwordx4 v24, s[48:51], s31 offen offset:0  lds
    buffer_load_dwordx4 v25, s[48:51], s31 offen offset:1024  lds
    buffer_load_dwordx4 v26, s[48:51], s31 offen offset:2048  lds
    buffer_load_dwordx4 v27, s[48:51], s31 offen offset:3072  lds
    s_getpc_b64 s[62:63]
    s_cmp_lt_u32 s61, 159856
    s_cbranch_scc1 L_lslow
    s_mov_b32 m0, 73728
    s_add_u32 s31, s73, 0
    buffer_load_dwordx4 v24, s[48:51], s31 offen offset:0  lds
    buffer_load_dwordx4 v25, s[48:51], s31 offen offset:1024  lds
    buffer_load_dwordx4 v26, s[48:51], s31 offen offset:2048  lds
    buffer_load_dwordx4 v27, s[48:51], s31 offen offset:3072  lds
    s_mov_b32 m0, 77824
    s_add_u32 s31, s73, 28672
    buffer_load_dwordx4 v24, s[48:51], s31 offen offset:0  lds
    buffer_load_dwordx4 v25, s[48:51], s31 offen offset:1024  lds
    buffer_load_dwordx4 v26, s[48:51], s31 offen offset:2048  lds
    buffer_load_dwordx4 v27, s[48:51], s31 offen offset:3072  lds
    s_mov_b32 m0, 122880
    s_mov_b32 s31, 131200
    buffer_load_dwordx4 v20, s[40:43], s31 offen offset:0 nt lds
    buffer_load_dwordx4 v21, s[40:43], s31 offen offset:1024 nt lds
    buffer_load_dwordx4 v22, s[40:43], s31 offen offset:2048 nt lds
    buffer_load_dwordx4 v23, s[40:43], s31 offen offset:3072 nt lds
    s_mov_b32 m0, 126976
    s_mov_b32 s31, 147584
    buffer_load_dwordx4 v20, s[40:43], s31 offen offset:0 nt lds
    buffer_load_dwordx4 v21, s[40:43], s31 offen offset:1024 nt lds
    buffer_load_dwordx4 v22, s[40:43], s31 offen offset:2048 nt lds
    buffer_load_dwordx4 v23, s[40:43], s31 offen offset:3072 nt lds
    s_mov_b32 m0, 159892
    s_mov_b64 exec, 1
    buffer_load_dword off, s[24:27], 0 lds
    s_mov_b64 exec, -1
    s_getpc_b64 s[62:63]
    s_cmp_lt_u32 s61, 159860
    s_cbranch_scc1 L_lslow
    s_mov_b32 m0, 90112
    s_mov_b32 s31, 163968
    buffer_load_dwordx4 v20, s[40:43], s31 offen offset:0 nt lds
    buffer_load_dwordx4 v21, s[40:43], s31 offen offset:1024 nt lds
    buffer_load_dwordx4 v22, s[40:43], s31 offen offset:2048 nt lds
    buffer_load_dwordx4 v23, s[40:43], s31 offen offset:3072 nt lds
    s_mov_b32 m0, 94208
    s_mov_b32 s31, 180352
    buffer_load_dwordx4 v20, s[40:43], s31 offen offset:0 nt lds
    buffer_load_dwordx4 v21, s[40:43], s31 offen offset:1024 nt lds
    buffer_load_dwordx4 v22, s[40:43], s31 offen offset:2048 nt lds
    buffer_load_dwordx4 v23, s[40:43], s31 offen offset:3072 nt lds
    s_mov_b32 m0, 159896
    s_mov_b64 exec, 1
    buffer_load_dword off, s[24:27], 0 lds
    s_mov_b64 exec, -1
    s_mov_b32 m0, 131072
    s_add_u32 s31, s74, 0
    buffer_load_dwordx4 v24, s[48:51], s31 offen offset:0  lds
    buffer_load_dwordx4 v25, s[48:51], s31 offen offset:1024  lds
    buffer_load_dwordx4 v26, s[48:51], s31 offen offset:2048  lds
    buffer_load_dwordx4 v27, s[48:51], s31 offen offset:3072  lds
    s_mov_b32 m0, 135168
    s_add_u32 s31, s74, 28672
    buffer_load_dwordx4 v24, s[48:51], s31 offen offset:0  lds
    buffer_load_dwordx4 v25, s[48:51], s31 offen offset:1024  lds
    buffer_load_dwordx4 v26, s[48:51], s31 offen offset:2048  lds
    buffer_load_dwordx4 v27, s[48:51], s31 offen offset:3072  lds
    s_getpc_b64 s[62:63]
    s_cmp_lt_u32 s61, 159864
    s_cbranch_scc1 L_lslow
    s_mov_b32 m0, 8192
    s_add_u32 s31, s75, 0
    buffer_load_dwordx4 v24, s[48:51], s31 offen offset:0  lds
    buffer_load_dwordx4 v25, s[48:51], s31 offen offset:1024  lds
    buffer_load_dwordx4 v26, s[48:51], s31 offen offset:2048  lds
    buffer_load_dwordx4 v27, s[48:51], s31 offen offset:3072  lds
    s_mov_b32 m0, 12288
    s_add_u32 s31, s75, 28672
    buffer_load_dwordx4 v24, s[48:51], s31 offen offset:0  lds
    buffer_load_dwordx4 v25, s[48:51], s31 offen offset:1024  lds
    buffer_load_dwordx4 v26, s[48:51], s31 offen offset:2048  lds
    buffer_load_dwordx4 v27, s[48:51], s31 offen offset:3072  lds
    s_mov_b32 m0, 98304
    s_mov_b32 s31, 196736
    buffer_load_dwordx4 v20, s[40:43], s31 offen offset:0 nt lds
    buffer_load_dwordx4 v21, s[40:43], s31 offen offset:1024 nt lds
    buffer_load_dwordx4 v22, s[40:43], s31 offen offset:2048 nt lds
    buffer_load_dwordx4 v23, s[40:43], s31 offen offset:3072 nt lds
    s_mov_b32 m0, 102400
    s_mov_b32 s31, 213120
    buffer_load_dwordx4 v20, s[40:43], s31 offen offset:0 nt lds
    buffer_load_dwordx4 v21, s[40:43], s31 offen offset:1024 nt lds
    buffer_load_dwordx4 v22, s[40:43], s31 offen offset:2048 nt lds
    buffer_load_dwordx4 v23, s[40:43], s31 offen offset:3072 nt lds
    s_mov_b32 m0, 159900
    s_mov_b64 exec, 1
    buffer_load_dword off, s[24:27], 0 lds
    s_mov_b64 exec, -1
    s_getpc_b64 s[62:63]
    s_cmp_lt_u32 s61, 159868
    s_cbranch_scc1 L_lslow
    s_mov_b32 m0, 49152
    s_mov_b32 s31, 229504
    buffer_load_dwordx4 v20, s[40:43], s31 offen offset:0 nt lds
    buffer_load_dwordx4 v21, s[40:43], s31 offen offset:1024 nt lds
    buffer_load_dwordx4 v22, s[40:43], s31 offen offset:2048 nt lds
    buffer_load_dwordx4 v23, s[40:43], s31 offen offset:3072 nt lds
    s_mov_b32 m0, 53248
    s_mov_b32 s31, 245888
    buffer_load_dwordx4 v20, s[40:43], s31 offen offset:0 nt lds
    buffer_load_dwordx4 v21, s[40:43], s31 offen offset:1024 nt lds
    buffer_load_dwordx4 v22, s[40:43], s31 offen offset:2048 nt lds
    buffer_load_dwordx4 v23, s[40:43], s31 offen offset:3072 nt lds
    s_mov_b32 m0, 159904
    s_mov_b64 exec, 1
    buffer_load_dword off, s[24:27], 0 lds
    s_mov_b64 exec, -1
    s_mov_b32 m0, 106496
    s_add_u32 s31, s76, 0
    buffer_load_dwordx4 v24, s[48:51], s31 offen offset:0  lds
    buffer_load_dwordx4 v25, s[48:51], s31 offen offset:1024  lds
    buffer_load_dwordx4 v26, s[48:51], s31 offen offset:2048  lds
    buffer_load_dwordx4 v27, s[48:51], s31 offen offset:3072  lds
    s_mov_b32 m0, 110592
    s_add_u32 s31, s76, 28672
    buffer_load_dwordx4 v24, s[48:51], s31 offen offset:0  lds
    buffer_load_dwordx4 v25, s[48:51], s31 offen offset:1024  lds
    buffer_load_dwordx4 v26, s[48:51], s31 offen offset:2048  lds
    buffer_load_dwordx4 v27, s[48:51], s31 offen offset:3072  lds
    s_getpc_b64 s[62:63]
    s_cmp_lt_u32 s61, 159872
    s_cbranch_scc1 L_lslow
    s_mov_b32 m0, 57344
    s_add_u32 s31, s70, 57344
    buffer_load_dwordx4 v24, s[48:51], s31 offen offset:0  lds
    buffer_load_dwordx4 v25, s[48:51], s31 offen offset:1024  lds
    buffer_load_dwordx4 v26, s[48:51], s31 offen offset:2048  lds
    buffer_load_dwordx4 v27, s[48:51], s31 offen offset:3072  lds
    s_mov_b32 m0, 61440
    s_add_u32 s31, s70, 86016
    buffer_load_dwordx4 v24, s[48:51], s31 offen offset:0  lds
    buffer_load_dwordx4 v25, s[48:51], s31 offen offset:1024  lds
    buffer_load_dwordx4 v26, s[48:51], s31 offen offset:2048  lds
    buffer_load_dwordx4 v27, s[48:51], s31 offen offset:3072  lds
    s_mov_b32 m0, 81920
    s_mov_b32 s31, 256
    buffer_load_dwordx4 v20, s[40:43], s31 offen offset:0 nt lds
    buffer_load_dwordx4 v21, s[40:43], s31 offen offset:1024 nt lds
    buffer_load_dwordx4 v22, s[40:43], s31 offen offset:2048 nt lds
    buffer_load_dwordx4 v23, s[40:43], s31 offen offset:3072 nt lds
    s_mov_b32 m0, 86016
    s_mov_b32 s31, 16640
    buffer_load_dwordx4 v20, s[40:43], s31 offen offset:0 nt lds
    buffer_load_dwordx4 v21, s[40:43], s31 offen offset:1024 nt lds
    buffer_load_dwordx4 v22, s[40:43], s31 offen offset:2048 nt lds
    buffer_load_dwordx4 v23, s[40:43], s31 offen offset:3072 nt lds
    s_mov_b32 m0, 159908
    s_mov_b64 exec, 1
    buffer_load_dword off, s[24:27], 0 lds
    s_mov_b64 exec, -1
    s_getpc_b64 s[62:63]
    s_cmp_lt_u32 s61, 159876
    s_cbranch_scc1 L_lslow
    s_mov_b32 m0, 0
    s_mov_b32 s31, 33024
    buffer_load_dwordx4 v20, s[40:43], s31 offen offset:0 nt lds
    buffer_load_dwordx4 v21, s[40:43], s31 offen offset:1024 nt lds
    buffer_load_dwordx4 v22, s[40:43], s31 offen offset:2048 nt lds
    buffer_load_dwordx4 v23, s[40:43], s31 offen offset:3072 nt lds
    s_mov_b32 m0, 4096
    s_mov_b32 s31, 49408
    buffer_load_dwordx4 v20, s[40:43], s31 offen offset:0 nt lds
    buffer_load_dwordx4 v21, s[40:43], s31 offen offset:1024 nt lds
    buffer_load_dwordx4 v22, s[40:43], s31 offen offset:2048 nt lds
    buffer_load_dwordx4 v23, s[40:43], s31 offen offset:3072 nt lds
    s_mov_b32 m0, 159912
    s_mov_b64 exec, 1
    buffer_load_dword off, s[24:27], 0 lds
    s_mov_b64 exec, -1
    s_mov_b32 m0, 139264
    s_add_u32 s31, s71, 57344
    buffer_load_dwordx4 v24, s[48:51], s31 offen offset:0  lds
    buffer_load_dwordx4 v25, s[48:51], s31 offen offset:1024  lds
    buffer_load_dwordx4 v26, s[48:51], s31 offen offset:2048  lds
    buffer_load_dwordx4 v27, s[48:51], s31 offen offset:3072  lds
    s_mov_b32 m0, 143360
    s_add_u32 s31, s71, 86016
    buffer_load_dwordx4 v24, s[48:51], s31 offen offset:0  lds
    buffer_load_dwordx4 v25, s[48:51], s31 offen offset:1024  lds
    buffer_load_dwordx4 v26, s[48:51], s31 offen offset:2048  lds
    buffer_load_dwordx4 v27, s[48:51], s31 offen offset:3072  lds
    s_getpc_b64 s[62:63]
    s_cmp_lt_u32 s61, 159880
    s_cbranch_scc1 L_lslow
    s_mov_b32 m0, 16384
    s_add_u32 s31, s72, 57344
    buffer_load_dwordx4 v24, s[48:51], s31 offen offset:0  lds
    buffer_load_dwordx4 v25, s[48:51], s31 offen offset:1024  lds
    buffer_load_dwordx4 v26, s[48:51], s31 offen offset:2048  lds
    buffer_load_dwordx4 v27, s[48:51], s31 offen offset:3072  lds
    s_mov_b32 m0, 20480
    s_add_u32 s31, s72, 86016
    buffer_load_dwordx4 v24, s[48:51], s31 offen offset:0  lds
    buffer_load_dwordx4 v25, s[48:51], s31 offen offset:1024  lds
    buffer_load_dwordx4 v26, s[48:51], s31 offen offset:2048  lds
    buffer_load_dwordx4 v27, s[48:51], s31 offen offset:3072  lds
    s_mov_b32 m0, 24576
    s_mov_b32 s31, 65792
    buffer_load_dwordx4 v20, s[40:43], s31 offen offset:0 nt lds
    buffer_load_dwordx4 v21, s[40:43], s31 offen offset:1024 nt lds
    buffer_load_dwordx4 v22, s[40:43], s31 offen offset:2048 nt lds
    buffer_load_dwordx4 v23, s[40:43], s31 offen offset:3072 nt lds
    s_mov_b32 m0, 28672
    s_mov_b32 s31, 82176
    buffer_load_dwordx4 v20, s[40:43], s31 offen offset:0 nt lds
    buffer_load_dwordx4 v21, s[40:43], s31 offen offset:1024 nt lds
    buffer_load_dwordx4 v22, s[40:43], s31 offen offset:2048 nt lds
    buffer_load_dwordx4 v23, s[40:43], s31 offen offset:3072 nt lds
    s_mov_b32 m0, 159916
    s_mov_b64 exec, 1
    buffer_load_dword off, s[24:27], 0 lds
    s_mov_b64 exec, -1
    s_getpc_b64 s[62:63]
    s_cmp_lt_u32 s61, 159884
    s_cbranch_scc1 L_lslow
    s_mov_b32 m0, 65536
    s_mov_b32 s31, 98560
    buffer_load_dwordx4 v20, s[40:43], s31 offen offset:0 nt lds
    buffer_load_dwordx4 v21, s[40:43], s31 offen offset:1024 nt lds
    buffer_load_dwordx4 v22, s[40:43], s31 offen offset:2048 nt lds
    buffer_load_dwordx4 v23, s[40:43], s31 offen offset:3072 nt lds
    s_mov_b32 m0, 69632
    s_mov_b32 s31, 114944
    buffer_load_dwordx4 v20, s[40:43], s31 offen offset:0 nt lds
    buffer_load_dwordx4 v21, s[40:43], s31 offen offset:1024 nt lds
    buffer_load_dwordx4 v22, s[40:43], s31 offen offset:2048 nt lds
    buffer_load_dwordx4 v23, s[40:43], s31 offen offset:3072 nt lds
    s_mov_b32 m0, 159920
    s_mov_b64 exec, 1
    buffer_load_dword off, s[24:27], 0 lds
    s_mov_b64 exec, -1
    s_mov_b32 m0, 114688
    s_add_u32 s31, s73, 57344
    buffer_load_dwordx4 v24, s[48:51], s31 offen offset:0  lds
    buffer_load_dwordx4 v25, s[48:51], s31 offen offset:1024  lds
    buffer_load_dwordx4 v26, s[48:51], s31 offen offset:2048  lds
    buffer_load_dwordx4 v27, s[48:51], s31 offen offset:3072  lds
    s_mov_b32 m0, 118784
    s_add_u32 s31, s73, 86016
    buffer_load_dwordx4 v24, s[48:51], s31 offen offset:0  lds
    buffer_load_dwordx4 v25, s[48:51], s31 offen offset:1024  lds
    buffer_load_dwordx4 v26, s[48:51], s31 offen offset:2048  lds
    buffer_load_dwordx4 v27, s[48:51], s31 offen offset:3072  lds
    s_getpc_b64 s[62:63]
    s_cmp_lt_u32 s61, 159888
    s_cbranch_scc1 L_lslow
    s_mov_b32 m0, 32768
    s_add_u32 s31, s74, 57344
    buffer_load_dwordx4 v24, s[48:51], s31 offen offset:0  lds
    buffer_load_dwordx4 v25, s[48:51], s31 offen offset:1024  lds
    buffer_load_dwordx4 v26, s[48:51], s31 offen offset:2048  lds
    buffer_load_dwordx4 v27, s[48:51], s31 offen offset:3072  lds
    s_mov_b32 m0, 36864
    s_add_u32 s31, s74, 86016
    buffer_load_dwordx4 v24, s[48:51], s31 offen offset:0  lds
    buffer_load_dwordx4 v25, s[48:51], s31 offen offset:1024  lds
    buffer_load_dwordx4 v26, s[48:51], s31 offen offset:2048  lds
    buffer_load_dwordx4 v27, s[48:51], s31 offen offset:3072  lds
    s_mov_b32 m0, 40960
    s_mov_b32 s31, 131328
    buffer_load_dwordx4 v20, s[40:43], s31 offen offset:0 nt lds
    buffer_load_dwordx4 v21, s[40:43], s31 offen offset:1024 nt lds
    buffer_load_dwordx4 v22, s[40:43], s31 offen offset:2048 nt lds
    buffer_load_dwordx4 v23, s[40:43], s31 offen offset:3072 nt lds
    s_mov_b32 m0, 45056
    s_mov_b32 s31, 147712
    buffer_load_dwordx4 v20, s[40:43], s31 offen offset:0 nt lds
    buffer_load_dwordx4 v21, s[40:43], s31 offen offset:1024 nt lds
    buffer_load_dwordx4 v22, s[40:43], s31 offen offset:2048 nt lds
    buffer_load_dwordx4 v23, s[40:43], s31 offen offset:3072 nt lds
    s_mov_b32 m0, 159924
    s_mov_b64 exec, 1
    buffer_load_dword off, s[24:27], 0 lds
    s_mov_b64 exec, -1
    s_getpc_b64 s[62:63]
    s_cmp_lt_u32 s61, 159892
    s_cbranch_scc1 L_lslow
    s_mov_b32 m0, 122880
    s_mov_b32 s31, 164096
    buffer_load_dwordx4 v20, s[40:43], s31 offen offset:0 nt lds
    buffer_load_dwordx4 v21, s[40:43], s31 offen offset:1024 nt lds
    buffer_load_dwordx4 v22, s[40:43], s31 offen offset:2048 nt lds
    buffer_load_dwordx4 v23, s[40:43], s31 offen offset:3072 nt lds
    s_mov_b32 m0, 126976
    s_mov_b32 s31, 180480
    buffer_load_dwordx4 v20, s[40:43], s31 offen offset:0 nt lds
    buffer_load_dwordx4 v21, s[40:43], s31 offen offset:1024 nt lds
    buffer_load_dwordx4 v22, s[40:43], s31 offen offset:2048 nt lds
    buffer_load_dwordx4 v23, s[40:43], s31 offen offset:3072 nt lds
    s_mov_b32 m0, 159928
    s_mov_b64 exec, 1
    buffer_load_dword off, s[24:27], 0 lds
    s_mov_b64 exec, -1
    s_mov_b32 m0, 147456
    s_add_u32 s31, s75, 57344
    buffer_load_dwordx4 v24, s[48:51], s31 offen offset:0  lds
    buffer_load_dwordx4 v25, s[48:51], s31 offen offset:1024  lds
    buffer_load_dwordx4 v26, s[48:51], s31 offen offset:2048  lds
    buffer_load_dwordx4 v27, s[48:51], s31 offen offset:3072  lds
    s_mov_b32 m0, 151552
    s_add_u32 s31, s75, 86016
    buffer_load_dwordx4 v24, s[48:51], s31 offen offset:0  lds
    buffer_load_dwordx4 v25, s[48:51], s31 offen offset:1024  lds
    buffer_load_dwordx4 v26, s[48:51], s31 offen offset:2048  lds
    buffer_load_dwordx4 v27, s[48:51], s31 offen offset:3072  lds
    s_getpc_b64 s[62:63]
    s_cmp_lt_u32 s61, 159896
    s_cbranch_scc1 L_lslow
    s_mov_b32 m0, 73728
    s_add_u32 s31, s76, 57344
    buffer_load_dwordx4 v24, s[48:51], s31 offen offset:0  lds
    buffer_load_dwordx4 v25, s[48:51], s31 offen offset:1024  lds
    buffer_load_dwordx4 v26, s[48:51], s31 offen offset:2048  lds
    buffer_load_dwordx4 v27, s[48:51], s31 offen offset:3072  lds
    s_mov_b32 m0, 77824
    s_add_u32 s31, s76, 86016
    buffer_load_dwordx4 v24, s[48:51], s31 offen offset:0  lds
    buffer_load_dwordx4 v25, s[48:51], s31 offen offset:1024  lds
    buffer_load_dwordx4 v26, s[48:51], s31 offen offset:2048  lds
    buffer_load_dwordx4 v27, s[48:51], s31 offen offset:3072  lds
    s_mov_b32 m0, 90112
    s_mov_b32 s31, 196864
    buffer_load_dwordx4 v20, s[40:43], s31 offen offset:0 nt lds
    buffer_load_dwordx4 v21, s[40:43], s31 offen offset:1024 nt lds
    buffer_load_dwordx4 v22, s[40:43], s31 offen offset:2048 nt lds
    buffer_load_dwordx4 v23, s[40:43], s31 offen offset:3072 nt lds
    s_mov_b32 m0, 94208
    s_mov_b32 s31, 213248
    buffer_load_dwordx4 v20, s[40:43], s31 offen offset:0 nt lds
    buffer_load_dwordx4 v21, s[40:43], s31 offen offset:1024 nt lds
    buffer_load_dwordx4 v22, s[40:43], s31 offen offset:2048 nt lds
    buffer_load_dwordx4 v23, s[40:43], s31 offen offset:3072 nt lds
    s_mov_b32 m0, 159932
    s_mov_b64 exec, 1
    buffer_load_dword off, s[24:27], 0 lds
    s_mov_b64 exec, -1
    s_getpc_b64 s[62:63]
    s_cmp_lt_u32 s61, 159900
    s_cbranch_scc1 L_lslow
    s_mov_b32 m0, 98304
    s_mov_b32 s31, 229632
    buffer_load_dwordx4 v20, s[40:43], s31 offen offset:0 nt lds
    buffer_load_dwordx4 v21, s[40:43], s31 offen offset:1024 nt lds
    buffer_load_dwordx4 v22, s[40:43], s31 offen offset:2048 nt lds
    buffer_load_dwordx4 v23, s[40:43], s31 offen offset:3072 nt lds
    s_mov_b32 m0, 102400
    s_mov_b32 s31, 246016
    buffer_load_dwordx4 v20, s[40:43], s31 offen offset:0 nt lds
    buffer_load_dwordx4 v21, s[40:43], s31 offen offset:1024 nt lds
    buffer_load_dwordx4 v22, s[40:43], s31 offen offset:2048 nt lds
    buffer_load_dwordx4 v23, s[40:43], s31 offen offset:3072 nt lds
    s_mov_b32 m0, 159936
    s_mov_b64 exec, 1
    buffer_load_dword off, s[24:27], 0 lds
    s_mov_b64 exec, -1
    s_mov_b32 m0, 131072
    s_mov_b32 s31, 384
    buffer_load_dwordx4 v20, s[40:43], s31 offen offset:0 nt lds
    buffer_load_dwordx4 v21, s[40:43], s31 offen offset:1024 nt lds
    buffer_load_dwordx4 v22, s[40:43], s31 offen offset:2048 nt lds
    buffer_load_dwordx4 v23, s[40:43], s31 offen offset:3072 nt lds
    s_mov_b32 m0, 135168
    s_mov_b32 s31, 16768
    buffer_load_dwordx4 v20, s[40:43], s31 offen offset:0 nt lds
    buffer_load_dwordx4 v21, s[40:43], s31 offen offset:1024 nt lds
    buffer_load_dwordx4 v22, s[40:43], s31 offen offset:2048 nt lds
    buffer_load_dwordx4 v23, s[40:43], s31 offen offset:3072 nt lds
    s_getpc_b64 s[62:63]
    s_cmp_lt_u32 s61, 159904
    s_cbranch_scc1 L_lslow
    s_mov_b32 m0, 8192
    s_mov_b32 s31, 33152
    buffer_load_dwordx4 v20, s[40:43], s31 offen offset:0 nt lds
    buffer_load_dwordx4 v21, s[40:43], s31 offen offset:1024 nt lds
    buffer_load_dwordx4 v22, s[40:43], s31 offen offset:2048 nt lds
    buffer_load_dwordx4 v23, s[40:43], s31 offen offset:3072 nt lds
    s_mov_b32 m0, 12288
    s_mov_b32 s31, 49536
    buffer_load_dwordx4 v20, s[40:43], s31 offen offset:0 nt lds
    buffer_load_dwordx4 v21, s[40:43], s31 offen offset:1024 nt lds
    buffer_load_dwordx4 v22, s[40:43], s31 offen offset:2048 nt lds
    buffer_load_dwordx4 v23, s[40:43], s31 offen offset:3072 nt lds
    s_mov_b32 m0, 159940
    s_mov_b64 exec, 1
    buffer_load_dword off, s[24:27], 0 lds
    s_mov_b64 exec, -1
    s_mov_b32 m0, 49152
    s_mov_b32 s31, 65920
    buffer_load_dwordx4 v20, s[40:43], s31 offen offset:0 nt lds
    buffer_load_dwordx4 v21, s[40:43], s31 offen offset:1024 nt lds
    buffer_load_dwordx4 v22, s[40:43], s31 offen offset:2048 nt lds
    buffer_load_dwordx4 v23, s[40:43], s31 offen offset:3072 nt lds
    s_mov_b32 m0, 53248
    s_mov_b32 s31, 82304
    buffer_load_dwordx4 v20, s[40:43], s31 offen offset:0 nt lds
    buffer_load_dwordx4 v21, s[40:43], s31 offen offset:1024 nt lds
    buffer_load_dwordx4 v22, s[40:43], s31 offen offset:2048 nt lds
    buffer_load_dwordx4 v23, s[40:43], s31 offen offset:3072 nt lds
    s_getpc_b64 s[62:63]
    s_cmp_lt_u32 s61, 159908
    s_cbranch_scc1 L_lslow
    s_mov_b32 m0, 81920
    s_mov_b32 s31, 98688
    buffer_load_dwordx4 v20, s[40:43], s31 offen offset:0 nt lds
    buffer_load_dwordx4 v21, s[40:43], s31 offen offset:1024 nt lds
    buffer_load_dwordx4 v22, s[40:43], s31 offen offset:2048 nt lds
    buffer_load_dwordx4 v23, s[40:43], s31 offen offset:3072 nt lds
    s_mov_b32 m0, 86016
    s_mov_b32 s31, 115072
    buffer_load_dwordx4 v20, s[40:43], s31 offen offset:0 nt lds
    buffer_load_dwordx4 v21, s[40:43], s31 offen offset:1024 nt lds
    buffer_load_dwordx4 v22, s[40:43], s31 offen offset:2048 nt lds
    buffer_load_dwordx4 v23, s[40:43], s31 offen offset:3072 nt lds
    s_mov_b32 m0, 159944
    s_mov_b64 exec, 1
    buffer_load_dword off, s[24:27], 0 lds
    s_mov_b64 exec, -1
    s_mov_b32 m0, 106496
    s_mov_b32 s31, 131456
    buffer_load_dwordx4 v20, s[40:43], s31 offen offset:0 nt lds
    buffer_load_dwordx4 v21, s[40:43], s31 offen offset:1024 nt lds
    buffer_load_dwordx4 v22, s[40:43], s31 offen offset:2048 nt lds
    buffer_load_dwordx4 v23, s[40:43], s31 offen offset:3072 nt lds
    s_mov_b32 m0, 110592
    s_mov_b32 s31, 147840
    buffer_load_dwordx4 v20, s[40:43], s31 offen offset:0 nt lds
    buffer_load_dwordx4 v21, s[40:43], s31 offen offset:1024 nt lds
    buffer_load_dwordx4 v22, s[40:43], s31 offen offset:2048 nt lds
    buffer_load_dwordx4 v23, s[40:43], s31 offen offset:3072 nt lds
    s_getpc_b64 s[62:63]
    s_cmp_lt_u32 s61, 159912
    s_cbranch_scc1 L_lslow
    s_mov_b32 m0, 0
    s_mov_b32 s31, 164224
    buffer_load_dwordx4 v20, s[40:43], s31 offen offset:0 nt lds
    buffer_load_dwordx4 v21, s[40:43], s31 offen offset:1024 nt lds
    buffer_load_dwordx4 v22, s[40:43], s31 offen offset:2048 nt lds
    buffer_load_dwordx4 v23, s[40:43], s31 offen offset:3072 nt lds
    s_mov_b32 m0, 4096
    s_mov_b32 s31, 180608
    buffer_load_dwordx4 v20, s[40:43], s31 offen offset:0 nt lds
    buffer_load_dwordx4 v21, s[40:43], s31 offen offset:1024 nt lds
    buffer_load_dwordx4 v22, s[40:43], s31 offen offset:2048 nt lds
    buffer_load_dwordx4 v23, s[40:43], s31 offen offset:3072 nt lds
    s_mov_b32 m0, 159948
    s_mov_b64 exec, 1
    buffer_load_dword off, s[24:27], 0 lds
    s_mov_b64 exec, -1
    s_mov_b32 m0, 57344
    s_mov_b32 s31, 196992
    buffer_load_dwordx4 v20, s[40:43], s31 offen offset:0 nt lds
    buffer_load_dwordx4 v21, s[40:43], s31 offen offset:1024 nt lds
    buffer_load_dwordx4 v22, s[40:43], s31 offen offset:2048 nt lds
    buffer_load_dwordx4 v23, s[40:43], s31 offen offset:3072 nt lds
    s_mov_b32 m0, 61440
    s_mov_b32 s31, 213376
    buffer_load_dwordx4 v20, s[40:43], s31 offen offset:0 nt lds
    buffer_load_dwordx4 v21, s[40:43], s31 offen offset:1024 nt lds
    buffer_load_dwordx4 v22, s[40:43], s31 offen offset:2048 nt lds
    buffer_load_dwordx4 v23, s[40:43], s31 offen offset:3072 nt lds
    s_getpc_b64 s[62:63]
    s_cmp_lt_u32 s61, 159916
    s_cbranch_scc1 L_lslow
    s_mov_b32 m0, 24576
    s_mov_b32 s31, 229760
    buffer_load_dwordx4 v20, s[40:43], s31 offen offset:0 nt lds
    buffer_load_dwordx4 v21, s[40:43], s31 offen offset:1024 nt lds
    buffer_load_dwordx4 v22, s[40:43], s31 offen offset:2048 nt lds
    buffer_load_dwordx4 v23, s[40:43], s31 offen offset:3072 nt lds
    s_mov_b32 m0, 28672
    s_mov_b32 s31, 246144
    buffer_load_dwordx4 v20, s[40:43], s31 offen offset:0 nt lds
    buffer_load_dwordx4 v21, s[40:43], s31 offen offset:1024 nt lds
    buffer_load_dwordx4 v22, s[40:43], s31 offen offset:2048 nt lds
    buffer_load_dwordx4 v23, s[40:43], s31 offen offset:3072 nt lds
    s_mov_b32 m0, 159952
    s_mov_b64 exec, 1
    buffer_load_dword off, s[24:27], 0 lds
    s_mov_b64 exec, -1
    s_mov_b32 m0, 139264
    s_add_u32 s31, s70, 114688
    buffer_load_dwordx4 v24, s[48:51], s31 offen offset:0  lds
    buffer_load_dwordx4 v25, s[48:51], s31 offen offset:1024  lds
    buffer_load_dwordx4 v26, s[48:51], s31 offen offset:2048  lds
    buffer_load_dwordx4 v27, s[48:51], s31 offen offset:3072  lds
    s_mov_b32 m0, 143360
    s_add_u32 s31, s70, 143360
    buffer_load_dwordx4 v24, s[48:51], s31 offen offset:0  lds
    buffer_load_dwordx4 v25, s[48:51], s31 offen offset:1024  lds
    buffer_load_dwordx4 v26, s[48:51], s31 offen offset:2048  lds
    buffer_load_dwordx4 v27, s[48:51], s31 offen offset:3072  lds
    s_getpc_b64 s[62:63]
    s_cmp_lt_u32 s61, 159920
    s_cbranch_scc1 L_lslow
    s_mov_b32 m0, 16384
    s_add_u32 s31, s70, 172032
    buffer_load_dwordx4 v24, s[48:51], s31 offen offset:0  lds
    buffer_load_dwordx4 v25, s[48:51], s31 offen offset:1024  lds
    buffer_load_dwordx4 v26, s[48:51], s31 offen offset:2048  lds
    buffer_load_dwordx4 v27, s[48:51], s31 offen offset:3072  lds
    s_mov_b32 m0, 20480
    s_add_u32 s31, s70, 200704
    buffer_load_dwordx4 v24, s[48:51], s31 offen offset:0  lds
    buffer_load_dwordx4 v25, s[48:51], s31 offen offset:1024  lds
    buffer_load_dwordx4 v26, s[48:51], s31 offen offset:2048  lds
    buffer_load_dwordx4 v27, s[48:51], s31 offen offset:3072  lds
    s_mov_b32 m0, 65536
    s_add_u32 s31, s71, 114688
    buffer_load_dwordx4 v24, s[48:51], s31 offen offset:0  lds
    buffer_load_dwordx4 v25, s[48:51], s31 offen offset:1024  lds
    buffer_load_dwordx4 v26, s[48:51], s31 offen offset:2048  lds
    buffer_load_dwordx4 v27, s[48:51], s31 offen offset:3072  lds
    s_mov_b32 m0, 69632
    s_add_u32 s31, s71, 143360
    buffer_load_dwordx4 v24, s[48:51], s31 offen offset:0  lds
    buffer_load_dwordx4 v25, s[48:51], s31 offen offset:1024  lds
    buffer_load_dwordx4 v26, s[48:51], s31 offen offset:2048  lds
    buffer_load_dwordx4 v27, s[48:51], s31 offen offset:3072  lds
    s_mov_b32 m0, 159956
    s_mov_b64 exec, 1
    buffer_load_dword off, s[24:27], 0 lds
    s_mov_b64 exec, -1
    s_getpc_b64 s[62:63]
    s_cmp_lt_u32 s61, 159924
    s_cbranch_scc1 L_lslow
    s_mov_b32 m0, 40960
    s_add_u32 s31, s71, 172032
    buffer_load_dwordx4 v24, s[48:51], s31 offen offset:0  lds
    buffer_load_dwordx4 v25, s[48:51], s31 offen offset:1024  lds
    buffer_load_dwordx4 v26, s[48:51], s31 offen offset:2048  lds
    buffer_load_dwordx4 v27, s[48:51], s31 offen offset:3072  lds
    s_mov_b32 m0, 45056
    s_add_u32 s31, s71, 200704
    buffer_load_dwordx4 v24, s[48:51], s31 offen offset:0  lds
    buffer_load_dwordx4 v25, s[48:51], s31 offen offset:1024  lds
    buffer_load_dwordx4 v26, s[48:51], s31 offen offset:2048  lds
    buffer_load_dwordx4 v27, s[48:51], s31 offen offset:3072  lds
    s_mov_b32 m0, 114688
    s_add_u32 s31, s72, 114688
    buffer_load_dwordx4 v24, s[48:51], s31 offen offset:0  lds
    buffer_load_dwordx4 v25, s[48:51], s31 offen offset:1024  lds
    buffer_load_dwordx4 v26, s[48:51], s31 offen offset:2048  lds
    buffer_load_dwordx4 v27, s[48:51], s31 offen offset:3072  lds
    s_mov_b32 m0, 118784
    s_add_u32 s31, s72, 143360
    buffer_load_dwordx4 v24, s[48:51], s31 offen offset:0  lds
    buffer_load_dwordx4 v25, s[48:51], s31 offen offset:1024  lds
    buffer_load_dwordx4 v26, s[48:51], s31 offen offset:2048  lds
    buffer_load_dwordx4 v27, s[48:51], s31 offen offset:3072  lds
    s_mov_b32 m0, 159960
    s_mov_b64 exec, 1
    buffer_load_dword off, s[24:27], 0 lds
    s_mov_b64 exec, -1
    s_getpc_b64 s[62:63]
    s_cmp_lt_u32 s61, 159928
    s_cbranch_scc1 L_lslow
    s_mov_b32 m0, 32768
    s_add_u32 s31, s72, 172032
    buffer_load_dwordx4 v24, s[48:51], s31 offen offset:0  lds
    buffer_load_dwordx4 v25, s[48:51], s31 offen offset:1024  lds
    buffer_load_dwordx4 v26, s[48:51], s31 offen offset:2048  lds
    buffer_load_dwordx4 v27, s[48:51], s31 offen offset:3072  lds
    s_mov_b32 m0, 36864
    s_add_u32 s31, s72, 200704
    buffer_load_dwordx4 v24, s[48:51], s31 offen offset:0  lds
    buffer_load_dwordx4 v25, s[48:51], s31 offen offset:1024  lds
    buffer_load_dwordx4 v26, s[48:51], s31 offen offset:2048  lds
    buffer_load_dwordx4 v27, s[48:51], s31 offen offset:3072  lds
    s_mov_b32 m0, 122880
    s_add_u32 s31, s73, 114688
    buffer_load_dwordx4 v24, s[48:51], s31 offen offset:0  lds
    buffer_load_dwordx4 v25, s[48:51], s31 offen offset:1024  lds
    buffer_load_dwordx4 v26, s[48:51], s31 offen offset:2048  lds
    buffer_load_dwordx4 v27, s[48:51], s31 offen offset:3072  lds
    s_mov_b32 m0, 126976
    s_add_u32 s31, s73, 143360
    buffer_load_dwordx4 v24, s[48:51], s31 offen offset:0  lds
    buffer_load_dwordx4 v25, s[48:51], s31 offen offset:1024  lds
    buffer_load_dwordx4 v26, s[48:51], s31 offen offset:2048  lds
    buffer_load_dwordx4 v27, s[48:51], s31 offen offset:3072  lds
    s_mov_b32 m0, 159964
    s_mov_b64 exec, 1
    buffer_load_dword off, s[24:27], 0 lds
    s_mov_b64 exec, -1
    s_getpc_b64 s[62:63]
    s_cmp_lt_u32 s61, 159932
    s_cbranch_scc1 L_lslow
    s_mov_b32 m0, 90112
    s_add_u32 s31, s73, 172032
    buffer_load_dwordx4 v24, s[48:51], s31 offen offset:0  lds
    buffer_load_dwordx4 v25, s[48:51], s31 offen offset:1024  lds
    buffer_load_dwordx4 v26, s[48:51], s31 offen offset:2048  lds
    buffer_load_dwordx4 v27, s[48:51], s31 offen offset:3072  lds
    s_mov_b32 m0, 94208
    s_add_u32 s31, s73, 200704
    buffer_load_dwordx4 v24, s[48:51], s31 offen offset:0  lds
    buffer_load_dwordx4 v25, s[48:51], s31 offen offset:1024  lds
    buffer_load_dwordx4 v26, s[48:51], s31 offen offset:2048  lds
    buffer_load_dwordx4 v27, s[48:51], s31 offen offset:3072  lds
    s_mov_b32 m0, 147456
    s_add_u32 s31, s74, 114688
    buffer_load_dwordx4 v24, s[48:51], s31 offen offset:0  lds
    buffer_load_dwordx4 v25, s[48:51], s31 offen offset:1024  lds
    buffer_load_dwordx4 v26, s[48:51], s31 offen offset:2048  lds
    buffer_load_dwordx4 v27, s[48:51], s31 offen offset:3072  lds
    s_mov_b32 m0, 151552
    s_add_u32 s31, s74, 143360
    buffer_load_dwordx4 v24, s[48:51], s31 offen offset:0  lds
    buffer_load_dwordx4 v25, s[48:51], s31 offen offset:1024  lds
    buffer_load_dwordx4 v26, s[48:51], s31 offen offset:2048  lds
    buffer_load_dwordx4 v27, s[48:51], s31 offen offset:3072  lds
    s_mov_b32 m0, 159968
    s_mov_b64 exec, 1
    buffer_load_dword off, s[24:27], 0 lds
    s_mov_b64 exec, -1
    s_getpc_b64 s[62:63]
    s_cmp_lt_u32 s61, 159936
    s_cbranch_scc1 L_lslow
    s_mov_b32 m0, 73728
    s_add_u32 s31, s74, 172032
    buffer_load_dwordx4 v24, s[48:51], s31 offen offset:0  lds
    buffer_load_dwordx4 v25, s[48:51], s31 offen offset:1024  lds
    buffer_load_dwordx4 v26, s[48:51], s31 offen offset:2048  lds
    buffer_load_dwordx4 v27, s[48:51], s31 offen offset:3072  lds
    s_mov_b32 m0, 77824
    s_add_u32 s31, s74, 200704
    buffer_load_dwordx4 v24, s[48:51], s31 offen offset:0  lds
    buffer_load_dwordx4 v25, s[48:51], s31 offen offset:1024  lds
    buffer_load_dwordx4 v26, s[48:51], s31 offen offset:2048  lds
    buffer_load_dwordx4 v27, s[48:51], s31 offen offset:3072  lds
    s_mov_b32 m0, 98304
    s_add_u32 s31, s75, 114688
    buffer_load_dwordx4 v24, s[48:51], s31 offen offset:0  lds
    buffer_load_dwordx4 v25, s[48:51], s31 offen offset:1024  lds
    buffer_load_dwordx4 v26, s[48:51], s31 offen offset:2048  lds
    buffer_load_dwordx4 v27, s[48:51], s31 offen offset:3072  lds
    s_mov_b32 m0, 102400
    s_add_u32 s31, s75, 143360
    buffer_load_dwordx4 v24, s[48:51], s31 offen offset:0  lds
    buffer_load_dwordx4 v25, s[48:51], s31 offen offset:1024  lds
    buffer_load_dwordx4 v26, s[48:51], s31 offen offset:2048  lds
    buffer_load_dwordx4 v27, s[48:51], s31 offen offset:3072  lds
    s_mov_b32 m0, 159972
    s_mov_b64 exec, 1
    buffer_load_dword off, s[24:27], 0 lds
    s_mov_b64 exec, -1
    s_getpc_b64 s[62:63]
    s_cmp_lt_u32 s61, 159940
    s_cbranch_scc1 L_lslow
    s_mov_b32 m0, 8192
    s_add_u32 s31, s75, 172032
    buffer_load_dwordx4 v24, s[48:51], s31 offen offset:0  lds
    buffer_load_dwordx4 v25, s[48:51], s31 offen offset:1024  lds
    buffer_load_dwordx4 v26, s[48:51], s31 offen offset:2048  lds
    buffer_load_dwordx4 v27, s[48:51], s31 offen offset:3072  lds
    s_mov_b32 m0, 12288
    s_add_u32 s31, s75, 200704
    buffer_load_dwordx4 v24, s[48:51], s31 offen offset:0  lds
    buffer_load_dwordx4 v25, s[48:51], s31 offen offset:1024  lds
    buffer_load_dwordx4 v26, s[48:51], s31 offen offset:2048  lds
    buffer_load_dwordx4 v27, s[48:51], s31 offen offset:3072  lds
    s_lshl_b32 s3, s4, 3
    s_add_u32 s3, s3, s28
    s_mul_i32 s69, s3, 1380352
    s_add_u32 s8, s22, s69
    s_addc_u32 s9, s23, 0
    s_mov_b32 s10, 1380352
    s_mov_b32 s11, 0x20000
    s_bfe_u32 s58, s60, 0x40012
    s_mov_b32 s5, 1376256
    s_mov_b32 s6, 1376256
    v_lshlrev_b32 v48, 2, v0
    v_lshrrev_b32 v49, 2, v0
    v_and_b32 v50, 12, v48
    v_mul_u32_u24 v49, 256, v49
    v_add_u32 v49, v49, v50
    buffer_load_dword v53, v49, s[8:11], s5 offen sc1
    s_mov_b32 m0, 131072
    s_add_u32 s31, s76, 114688
    buffer_load_dwordx4 v24, s[48:51], s31 offen offset:0  lds
    buffer_load_dwordx4 v25, s[48:51], s31 offen offset:1024  lds
    buffer_load_dwordx4 v26, s[48:51], s31 offen offset:2048  lds
    buffer_load_dwordx4 v27, s[48:51], s31 offen offset:3072  lds
    s_mov_b32 m0, 135168
    s_add_u32 s31, s76, 143360
    buffer_load_dwordx4 v24, s[48:51], s31 offen offset:0  lds
    buffer_load_dwordx4 v25, s[48:51], s31 offen offset:1024  lds
    buffer_load_dwordx4 v26, s[48:51], s31 offen offset:2048  lds
    buffer_load_dwordx4 v27, s[48:51], s31 offen offset:3072  lds
    s_mov_b32 m0, 159976
    s_mov_b64 exec, 1
    buffer_load_dword off, s[24:27], 0 lds
    s_mov_b64 exec, -1
    s_getpc_b64 s[62:63]
    s_cmp_lt_u32 s61, 159944
    s_cbranch_scc1 L_lslow
    s_mov_b32 m0, 49152
    s_add_u32 s31, s76, 172032
    buffer_load_dwordx4 v24, s[48:51], s31 offen offset:0  lds
    buffer_load_dwordx4 v25, s[48:51], s31 offen offset:1024  lds
    buffer_load_dwordx4 v26, s[48:51], s31 offen offset:2048  lds
    buffer_load_dwordx4 v27, s[48:51], s31 offen offset:3072  lds
    s_mov_b32 m0, 53248
    s_add_u32 s31, s76, 200704
    buffer_load_dwordx4 v24, s[48:51], s31 offen offset:0  lds
    buffer_load_dwordx4 v25, s[48:51], s31 offen offset:1024  lds
    buffer_load_dwordx4 v26, s[48:51], s31 offen offset:2048  lds
    buffer_load_dwordx4 v27, s[48:51], s31 offen offset:3072  lds
    s_mov_b32 m0, 159980
    s_mov_b64 exec, 1
    buffer_load_dword off, s[24:27], 0 lds
    s_mov_b64 exec, -1
    s_lshl_b32 s3, s3, 3
    s_mov_b64 s[16:17], 0
    s_mov_b32 s59, 0
    v_mov_b32 v2, 160012
    ds_read2st64_b32 v[50:51], v45 offset0:9 offset1:8
    s_waitcnt lgkmcnt(0)
    v_add_u32 v51, -1, v51
    s_waitcnt vmcnt(0)
    s_mov_b32 s26, 256
    v_cmp_ne_u32 vcc, v53, v50
    s_and_b32 s7, vcc_lo, vcc_hi
    s_or_b32 s7, s7, 0x77777777
    s_call_b64 s[46:47], L_setup
    s_mov_b32 s10, 0
    s_mov_b32 s14, 0
    s_mov_b32 s38, 0
    s_mov_b32 s39, 0
    v_mov_b32 v229, 0
    v_mov_b32 v239, 0
    v_mov_b32 v54, -1
    v_bfrev_b32 v55, -2
    v_mov_b32 v231, 159752
    ds_write_b64 v44, v[54:55] offset:280
    s_mov_b32 s36, 0
    s_call_b64 s[46:47], L_red
    s_mov_b32 s10, 1380352
    s_mov_b32 s68, 0
    s_mov_b32 s78, 0
L_poll:
    ds_read_b96 v[28:30], v44 offset:256
    s_add_u32 s68, s68, 1
    s_waitcnt lgkmcnt(0)
    buffer_load_dword v53, v49, s[8:11], s5 offen sc1
    v_min3_u32 v28, v28, v29, v30
    s_cmp_gt_u32 s68, 24
    v_readfirstlane_b32 s61, v28
    s_cbranch_scc1 L_pslow
L_p2:
    s_waitcnt vmcnt(0)
    v_cmp_ne_u32 vcc, v53, v50
    s_or_b64 vcc, vcc, s[16:17]
    s_and_b32 s31, vcc_hi, 0x7fffffff
    v_mov_b32 v54, vcc_lo
    v_mov_b32 v55, s31
    ds_write_b64 v44, v[54:55] offset:272
    s_and_b32 s31, vcc_lo, vcc_hi
    s_or_b32 s31, s31, 0x88888888
    s_cmp_eq_u32 s31, -1
    s_cbranch_scc0 L_nxt
    s_cmp_eq_u32 s61, 159984
    s_cbranch_scc0 L_nxt
    s_cmp_eq_u32 s7, -1
    s_cbranch_scc0 L_careful
    v_sub_u32 v54, v53, v50
    v_and_b32 v54, 2, v54
    v_cmp_ne_u32 vcc, 0, v54
    s_or_b64 vcc, vcc, s[16:17]
    s_and_b32 s56, vcc_lo, 0x88888888
    s_and_b32 s57, vcc_hi, 0x88888888
    s_lshl_b32 s31, s58, 2
    s_add_u32 s31, s31, 3
    s_bitset0_b64 s[56:57], s31
    s_or_b32 s31, s56, s57
    s_cbranch_scc1 L_fix
L_lend:
    s_waitcnt vmcnt(0) lgkmcnt(0)
L_done:
    s_endpgm
L_nxt:
    s_getpc_b64 s[62:63]
    s_cmp_lt_u32 s61, 159980
    s_cbranch_scc1 L_lslo2
    s_cmp_lt_u32 s68, 256
    s_cbranch_scc1 L_poll
    s_cmp_lg_u32 s59, 0
    s_cbranch_scc1 L_abort
    s_getpc_b64 s[62:63]
    s_cmp_lt_u32 s61, 159984
    s_cbranch_scc1 L_lslow
    s_mov_b32 s59, 1
    s_mov_b32 s7, 0
    s_max_u32 s68, s68, 24
    s_lshl_b32 s31, s58, 2
    s_lshl_b64 s[56:57], 15, s31
    v_mov_b32 v54, s56
    v_mov_b32 v55, s57
    v_add_u32 v52, 3, v51
    s_mov_b64 exec, 1
    buffer_atomic_or_x2 v[54:55], off, s[24:27], s3 offset:128 sc1
    s_lshl_b32 s31, s58, 2
    s_lshl_b64 exec, 8, s31
    buffer_store_dword v52, v49, s[8:11], s6 offen sc1
    s_mov_b64 exec, -1
    s_waitcnt vmcnt(0)
    s_branch L_poll
L_pslow:
    buffer_load_dwordx2 v[54:55], off, s[24:27], s3 offset:128 sc1
    s_waitcnt vmcnt(0)
    v_readfirstlane_b32 s16, v54
    v_readfirstlane_b32 s17, v55
    s_branch L_p2
L_careful:
    v_add_u32 v52, 2, v51
    s_lshl_b32 s31, s58, 2
    s_lshl_b64 exec, 7, s31
    buffer_store_dword v52, v49, s[8:11], s6 offen sc1
    s_mov_b64 exec, -1
    s_mov_b32 s7, -1
    s_waitcnt vmcnt(0)
    s_branch L_poll
L_abort:
    v_bfrev_b32 v55, 1
    ds_write_b64 v44, v[54:55] offset:272
    s_branch L_lend
L_fix:
    s_call_b64 s[46:47], L_setup
    s_mov_b32 s68, 0
L_fix0:
    s_ff1_i32_b64 s31, s[56:57]
    s_bitset0_b64 s[56:57], s31
    s_lshr_b32 s31, s31, 2
    s_mul_i32 s36, s31, 6
    s_add_u32 s60, s36, 6
L_fix1:
    s_call_b64 s[46:47], L_red
    s_waitcnt vmcnt(0)
    s_add_u32 s36, s36, 2
    s_cmp_lt_u32 s36, s60
    s_cbranch_scc1 L_fix1
    s_or_b32 s31, s56, s57
    s_cbranch_scc1 L_fix0
    s_branch L_lend
L_cslow:
    ds_read_b32 v1, v31 offset:4
    s_add_u32 s68, s68, 1
    s_cmp_gt_u32 s68, 4194304
    s_cbranch_scc1 L_done
    s_waitcnt lgkmcnt(0)
    v_cmp_ne_u32 vcc, 0, v1
    s_cbranch_vccnz L_cslow
    s_setpc_b64 s[62:63]
L_lslow:
    ds_read_b96 v[28:30], v44 offset:256
    s_add_u32 s68, s68, 1
    s_cmp_gt_u32 s68, 4194304
    s_cbranch_scc1 L_done
    s_waitcnt lgkmcnt(0)
    v_min3_u32 v28, v28, v29, v30
    s_nop 0
    v_readfirstlane_b32 s61, v28
    s_setpc_b64 s[62:63]
L_lslo2:
    ds_read_b96 v[28:30], v44 offset:256
    s_add_u32 s78, s78, 1
    s_cmp_gt_u32 s78, 4194304
    s_cbranch_scc1 L_done
    s_waitcnt lgkmcnt(0)
    v_min3_u32 v28, v28, v29, v30
    s_nop 0
    v_readfirstlane_b32 s61, v28
    s_setpc_b64 s[62:63]
L_cons:
    s_getpc_b64 s[96:97]
L_pc:
    s_sub_u32 s96, s96, L_pc-concat_heads__mha_block_cached__gqa_block_cached__near_ridge_kernel
    s_subb_u32 s97, s97, 0
    s_mov_b32 s98, L_end-concat_heads__mha_block_cached__gqa_block_cached__near_ridge_kernel
    s_mov_b32 s99, 0x20000
    s_lshr_b32 s100, s2, 3
    s_mul_i32 s100, s100, 3
    s_add_u32 s100, s100, s30
    s_mul_i32 s100, s100, 768
    v_lshlrev_b32 v154, 7, v0
    s_mov_b64 exec, 63
    buffer_load_dword v155, v154, s[96:99], s100 offen
    s_mov_b64 exec, -1
    v_and_b32 v1, 15, v0
    v_lshrrev_b32 v2, 4, v0
    v_bfe_u32 v3, v0, 1, 3
    v_xor_b32 v3, v3, v2
    v_lshlrev_b32 v3, 4, v3
    v_lshl_add_u32 v8, v1, 7, v3
    s_lshl_b32 s31, s30, 12
    v_add_u32 v96, s31, v8
    v_xor_b32 v97, 64, v96
    v_add_u32 v98, 0x10000, v96
    v_add_u32 v99, 0x10000, v97
    v_add_u32 v100, 0x20000, v96
    v_add_u32 v101, 0x20000, v97
    v_xor_b32 v9, 64, v8
    v_add_u32 v10, 0x10000, v8
    v_add_u32 v11, 0x10000, v9
    v_add_u32 v12, 0x20000, v8
    v_add_u32 v13, 0x20000, v9
    v_bfe_u32 v4, v0, 2, 2
    v_lshlrev_b32 v4, 7, v4
    v_lshl_add_u32 v4, v2, 10, v4
    v_and_b32 v5, 1, v0
    v_lshl_add_u32 v4, v5, 3, v4
    v_and_b32 v5, 2, v0
    v_lshl_add_u32 v4, v5, 4, v4
    v_and_b32 v5, 8, v0
    v_lshl_add_u32 v4, v5, 1, v4
    v_and_b32 v5, 16, v0
    v_lshl_add_u32 v14, v5, 2, v4
    v_xor_b32 v15, 16, v14
    v_xor_b32 v16, 64, v14
    v_xor_b32 v17, 0x50, v14
    v_add_u32 v18, 0x10000, v14
    v_add_u32 v19, 0x10000, v15
    v_add_u32 v20, 0x10000, v16
    v_add_u32 v21, 0x10000, v17
    v_add_u32 v22, 0x20000, v14
    v_add_u32 v23, 0x20000, v15
    v_add_u32 v24, 0x20000, v16
    v_add_u32 v25, 0x20000, v17
    v_lshrrev_b32 v3, 2, v0
    v_and_b32 v5, 3, v0
    v_lshlrev_b32 v5, 3, v5
    v_lshl_add_u32 v3, v3, 7, v5
    v_and_b32 v5, 24, v0
    v_lshl_add_u32 v3, v5, 2, v3
    v_accvgpr_write_b32 a96, v3
    v_lshlrev_b32 v30, 4, v0
    v_mov_b32 v3, 0x3f803f80
    v_accvgpr_write_b32 a108, v3
    v_accvgpr_write_b32 a109, v3
    v_accvgpr_write_b32 a110, v3
    v_accvgpr_write_b32 a111, v3
    s_lshl_b32 s31, s30, 2
    s_add_u32 s31, s31, 160000
    v_mov_b32 v2, s31
    v_mov_b32 v31, 159740
    s_mov_b64 vcc, -1
    s_lshl_b32 s69, s4, 3
    s_add_u32 s69, s69, s28
    s_mul_i32 s69, s69, 1380352
    s_mul_i32 s36, s27, 3
    s_add_u32 s36, s36, s30
    s_mul_i32 s29, s36, 28672
    s_add_u32 s29, s29, s69
    s_mov_b32 s56, 0x3db8aa3b
    s_mov_b32 s57, 0x800080
    s_lshl_b32 s70, s70, 4
    s_lshl_b32 s71, s71, 4
    s_lshl_b32 s72, s72, 4
    s_lshl_b32 s73, s73, 4
    s_lshl_b32 s74, s74, 4
    s_lshl_b32 s75, s75, 4
    s_lshl_b32 s76, s76, 4
    s_waitcnt lgkmcnt(0)
    s_add_u32 s52, s22, s29
    s_addc_u32 s53, s23, 0
    s_mov_b32 s54, 28672
    s_mov_b32 s55, 0x20000
    s_barrier
    s_add_u32 s8, s22, s69
    s_addc_u32 s9, s23, 0
    s_mov_b32 s10, 1380352
    s_mov_b32 s11, 0x20000
    s_mov_b32 s58, s27
    s_mov_b32 s5, 1376256
    s_mov_b32 s6, 1376256
    v_lshlrev_b32 v148, 2, v0
    v_lshrrev_b32 v149, 2, v0
    v_and_b32 v150, 12, v148
    v_mul_u32_u24 v149, 256, v149
    v_add_u32 v149, v149, v150
    s_lshl_b32 s7, s30, 9
    s_cbranch_scc1 L_nosnap
    buffer_load_dword v150, v149, s[8:11], s5 offen sc1
L_nosnap:
    s_add_u32 s7, s7, 159744
    s_getpc_b64 s[62:63]
    s_cbranch_vccnz L_cslow
    ds_read_b128 a[112:115], v100 offset:16384
    ds_read_b128 a[116:119], v100 offset:18432
    ds_read_b64_tr_b16 a[224:225], v14 offset:0
    ds_read_b64_tr_b16 a[226:227], v14 offset:512
    ds_read_b128 a[120:123], v101 offset:16384
    ds_read_b64_tr_b16 a[228:229], v15 offset:0
    ds_read_b64_tr_b16 a[230:231], v15 offset:512
    v_add_u32 v31, 4, v31
    ds_read_b128 a[124:127], v101 offset:18432
    ds_read_b64_tr_b16 a[232:233], v16 offset:0
    ds_read_b64_tr_b16 a[234:235], v16 offset:512
    ds_read_b64_tr_b16 a[236:237], v17 offset:0
    ds_read_b64_tr_b16 a[238:239], v17 offset:512
    ds_read_b64_tr_b16 a[240:241], v14 offset:4096
    ds_read_b64_tr_b16 a[242:243], v14 offset:4608
    ds_read_b64_tr_b16 a[244:245], v15 offset:4096
    s_waitcnt lgkmcnt(13)
    ds_read_b64_tr_b16 a[246:247], v15 offset:4608
    s_waitcnt lgkmcnt(9)
    v_mfma_f32_16x16x32_bf16 v[112:115], a[224:227], a[112:115], 0
    ds_read_b64_tr_b16 a[248:249], v16 offset:4096
    v_mfma_f32_16x16x32_bf16 v[120:123], a[224:227], a[116:119], 0
    ds_read_b64_tr_b16 a[250:251], v16 offset:4608
    v_mfma_f32_16x16x32_bf16 v[116:119], a[228:231], a[112:115], 0
    ds_read_b64_tr_b16 a[252:253], v17 offset:4096
    v_mfma_f32_16x16x32_bf16 v[124:127], a[228:231], a[116:119], 0
    ds_read_b64_tr_b16 a[254:255], v17 offset:4608
    s_waitcnt lgkmcnt(8)
    v_mfma_f32_16x16x32_bf16 v[128:131], a[232:235], a[112:115], 0
    ds_read_b128 a[128:131], v100 offset:4096
    ds_read_b128 a[132:135], v100 offset:6144
    v_mfma_f32_16x16x32_bf16 v[136:139], a[232:235], a[116:119], 0
    ds_read_b64_tr_b16 a[224:225], v14 offset:8192
    ds_read_b64_tr_b16 a[226:227], v14 offset:8704
    v_mfma_f32_16x16x32_bf16 v[132:135], a[236:239], a[112:115], 0
    ds_read_b128 a[136:139], v101 offset:4096
    ds_read_b64_tr_b16 a[228:229], v15 offset:8192
    v_mfma_f32_16x16x32_bf16 v[140:143], a[236:239], a[116:119], 0
    ds_read_b64_tr_b16 a[230:231], v15 offset:8704
    s_waitcnt lgkmcnt(11)
    v_mfma_f32_16x16x32_bf16 v[112:115], a[240:243], a[120:123], v[112:115]
    ds_read_b128 a[140:143], v101 offset:6144
    v_mfma_f32_16x16x32_bf16 v[120:123], a[240:243], a[124:127], v[120:123]
    ds_read_b64_tr_b16 a[232:233], v16 offset:8192
    ds_read_b64_tr_b16 a[234:235], v16 offset:8704
    v_mfma_f32_16x16x32_bf16 v[116:119], a[244:247], a[120:123], v[116:119]
    ds_read_b64_tr_b16 a[236:237], v17 offset:8192
    s_waitcnt lgkmcnt(13)
    ds_read_b64_tr_b16 a[238:239], v17 offset:8704
    v_mfma_f32_16x16x32_bf16 v[124:127], a[244:247], a[124:127], v[124:127]
    ds_read_b32 v1, v31 offset:4
    s_waitcnt lgkmcnt(13)
    v_mfma_f32_16x16x32_bf16 v[128:131], a[248:251], a[120:123], v[128:131]
    ds_read_b64_tr_b16 a[240:241], v14 offset:12288
    v_mfma_f32_16x16x32_bf16 v[136:139], a[248:251], a[124:127], v[136:139]
    ds_read_b64_tr_b16 a[242:243], v14 offset:12800
    v_mfma_f32_16x16x32_bf16 v[132:135], a[252:255], a[120:123], v[132:135]
    s_waitcnt lgkmcnt(13)
    ds_read_b64_tr_b16 a[244:245], v15 offset:12288
    v_mfma_f32_16x16x32_bf16 v[140:143], a[252:255], a[124:127], v[140:143]
    ds_read_b64_tr_b16 a[246:247], v15 offset:12800
    s_waitcnt lgkmcnt(10)
    v_mfma_f32_16x16x32_bf16 v[112:115], a[224:227], a[128:131], v[112:115]
    ds_read_b64_tr_b16 a[248:249], v16 offset:12288
    v_mfma_f32_16x16x32_bf16 v[120:123], a[224:227], a[132:135], v[120:123]
    ds_read_b64_tr_b16 a[250:251], v16 offset:12800
    s_waitcnt lgkmcnt(6)
    v_cmp_ne_u32 vcc, 0, v1
    v_mfma_f32_16x16x32_bf16 v[116:119], a[228:231], a[128:131], v[116:119]
    ds_read_b64_tr_b16 a[252:253], v17 offset:12288
    ds_read_b64_tr_b16 a[254:255], v17 offset:12800
    v_mfma_f32_16x16x32_bf16 v[124:127], a[228:231], a[132:135], v[124:127]
    ds_write_b32 v2, v31
    v_mfma_f32_16x16x32_bf16 v[128:131], a[232:235], a[128:131], v[128:131]
    s_getpc_b64 s[62:63]
    s_cbranch_vccnz L_cslow
    ds_read_b128 a[144:147], v98 offset:57344
    v_mfma_f32_16x16x32_bf16 v[136:139], a[232:235], a[132:135], v[136:139]
    ds_read_b128 a[148:151], v98 offset:59392
    ds_read_b64_tr_b16 a[224:225], v14 offset:16384
    ds_read_b64_tr_b16 a[226:227], v14 offset:16896
    v_mfma_f32_16x16x32_bf16 v[132:135], a[236:239], a[128:131], v[132:135]
    ds_read_b128 a[152:155], v99 offset:57344
    ds_read_b64_tr_b16 a[228:229], v15 offset:16384
    v_mfma_f32_16x16x32_bf16 v[140:143], a[236:239], a[132:135], v[140:143]
    s_waitcnt lgkmcnt(13)
    ds_read_b64_tr_b16 a[230:231], v15 offset:16896
    v_add_u32 v31, 4, v31
    s_waitcnt lgkmcnt(12)
    v_mfma_f32_16x16x32_bf16 v[112:115], a[240:243], a[136:139], v[112:115]
    ds_read_b128 a[156:159], v99 offset:59392
    v_mfma_f32_16x16x32_bf16 v[120:123], a[240:243], a[140:143], v[120:123]
    ds_read_b64_tr_b16 a[232:233], v16 offset:16384
    ds_read_b64_tr_b16 a[234:235], v16 offset:16896
    v_mfma_f32_16x16x32_bf16 v[116:119], a[244:247], a[136:139], v[116:119]
    s_waitcnt lgkmcnt(13)
    ds_read_b64_tr_b16 a[236:237], v17 offset:16384
    v_mfma_f32_16x16x32_bf16 v[124:127], a[244:247], a[140:143], v[124:127]
    ds_read_b64_tr_b16 a[238:239], v17 offset:16896
    s_waitcnt lgkmcnt(13)
    v_mfma_f32_16x16x32_bf16 v[128:131], a[248:251], a[136:139], v[128:131]
    ds_read_b64_tr_b16 a[240:241], v14 offset:20480
    v_mfma_f32_16x16x32_bf16 v[136:139], a[248:251], a[140:143], v[136:139]
    ds_read_b64_tr_b16 a[242:243], v14 offset:20992
    v_mfma_f32_16x16x32_bf16 v[132:135], a[252:255], a[136:139], v[132:135]
    s_waitcnt lgkmcnt(13)
    ds_read_b64_tr_b16 a[244:245], v15 offset:20480
    v_mfma_f32_16x16x32_bf16 v[140:143], a[252:255], a[140:143], v[140:143]
    ds_read_b64_tr_b16 a[246:247], v15 offset:20992
    s_waitcnt lgkmcnt(9)
    v_mfma_f32_16x16x32_bf16 v[112:115], a[224:227], a[144:147], v[112:115]
    ds_read_b64_tr_b16 a[248:249], v16 offset:20480
    v_mfma_f32_16x16x32_bf16 v[120:123], a[224:227], a[148:151], v[120:123]
    ds_read_b64_tr_b16 a[250:251], v16 offset:20992
    v_mfma_f32_16x16x32_bf16 v[116:119], a[228:231], a[144:147], v[116:119]
    ds_read_b64_tr_b16 a[252:253], v17 offset:20480
    v_mfma_f32_16x16x32_bf16 v[124:127], a[228:231], a[148:151], v[124:127]
    ds_read_b64_tr_b16 a[254:255], v17 offset:20992
    s_waitcnt lgkmcnt(8)
    v_mfma_f32_16x16x32_bf16 v[128:131], a[232:235], a[144:147], v[128:131]
    ds_read_b128 a[160:163], v98 offset:45056
    ds_read_b128 a[164:167], v98 offset:47104
    v_mfma_f32_16x16x32_bf16 v[136:139], a[232:235], a[148:151], v[136:139]
    ds_read_b64_tr_b16 a[224:225], v14 offset:24576
    ds_read_b64_tr_b16 a[226:227], v14 offset:25088
    v_mfma_f32_16x16x32_bf16 v[132:135], a[236:239], a[144:147], v[132:135]
    ds_read_b128 a[168:171], v99 offset:45056
    ds_read_b64_tr_b16 a[228:229], v15 offset:24576
    v_mfma_f32_16x16x32_bf16 v[140:143], a[236:239], a[148:151], v[140:143]
    ds_read_b64_tr_b16 a[230:231], v15 offset:25088
    s_waitcnt lgkmcnt(11)
    v_mfma_f32_16x16x32_bf16 v[112:115], a[240:243], a[152:155], v[112:115]
    ds_read_b128 a[172:175], v99 offset:47104
    v_mfma_f32_16x16x32_bf16 v[120:123], a[240:243], a[156:159], v[120:123]
    ds_read_b64_tr_b16 a[232:233], v16 offset:24576
    ds_read_b64_tr_b16 a[234:235], v16 offset:25088
    v_mfma_f32_16x16x32_bf16 v[116:119], a[244:247], a[152:155], v[116:119]
    ds_read_b64_tr_b16 a[236:237], v17 offset:24576
    s_waitcnt lgkmcnt(13)
    ds_read_b64_tr_b16 a[238:239], v17 offset:25088
    v_mfma_f32_16x16x32_bf16 v[124:127], a[244:247], a[156:159], v[124:127]
    ds_read_b32 v1, v31 offset:4
    s_waitcnt lgkmcnt(13)
    v_mfma_f32_16x16x32_bf16 v[128:131], a[248:251], a[152:155], v[128:131]
    ds_read_b64_tr_b16 a[240:241], v14 offset:28672
    v_mfma_f32_16x16x32_bf16 v[136:139], a[248:251], a[156:159], v[136:139]
    ds_read_b64_tr_b16 a[242:243], v14 offset:29184
    v_mfma_f32_16x16x32_bf16 v[132:135], a[252:255], a[152:155], v[132:135]
    s_waitcnt lgkmcnt(13)
    ds_read_b64_tr_b16 a[244:245], v15 offset:28672
    v_mfma_f32_16x16x32_bf16 v[140:143], a[252:255], a[156:159], v[140:143]
    ds_read_b64_tr_b16 a[246:247], v15 offset:29184
    s_waitcnt lgkmcnt(10)
    v_mfma_f32_16x16x32_bf16 v[112:115], a[224:227], a[160:163], v[112:115]
    ds_read_b64_tr_b16 a[248:249], v16 offset:28672
    v_mfma_f32_16x16x32_bf16 v[120:123], a[224:227], a[164:167], v[120:123]
    ds_read_b64_tr_b16 a[250:251], v16 offset:29184
    s_waitcnt lgkmcnt(6)
    v_cmp_ne_u32 vcc, 0, v1
    v_mfma_f32_16x16x32_bf16 v[116:119], a[228:231], a[160:163], v[116:119]
    ds_read_b64_tr_b16 a[252:253], v17 offset:28672
    ds_read_b64_tr_b16 a[254:255], v17 offset:29184
    v_mfma_f32_16x16x32_bf16 v[124:127], a[228:231], a[164:167], v[124:127]
    ds_write_b32 v2, v31
    v_mfma_f32_16x16x32_bf16 v[128:131], a[232:235], a[160:163], v[128:131]
    s_getpc_b64 s[62:63]
    s_cbranch_vccnz L_cslow
    ds_read_b128 a[176:179], v98 offset:32768
    v_mfma_f32_16x16x32_bf16 v[136:139], a[232:235], a[164:167], v[136:139]
    ds_read_b128 a[180:183], v98 offset:34816
    ds_read_b64_tr_b16 a[224:225], v14 offset:32768
    ds_read_b64_tr_b16 a[226:227], v14 offset:33280
    v_mfma_f32_16x16x32_bf16 v[132:135], a[236:239], a[160:163], v[132:135]
    ds_read_b128 a[184:187], v99 offset:32768
    ds_read_b64_tr_b16 a[228:229], v15 offset:32768
    v_mfma_f32_16x16x32_bf16 v[140:143], a[236:239], a[164:167], v[140:143]
    s_waitcnt lgkmcnt(13)
    ds_read_b64_tr_b16 a[230:231], v15 offset:33280
    v_add_u32 v31, 4, v31
    s_waitcnt lgkmcnt(12)
    v_mfma_f32_16x16x32_bf16 v[112:115], a[240:243], a[168:171], v[112:115]
    ds_read_b128 a[188:191], v99 offset:34816
    v_mfma_f32_16x16x32_bf16 v[120:123], a[240:243], a[172:175], v[120:123]
    ds_read_b64_tr_b16 a[232:233], v16 offset:32768
    ds_read_b64_tr_b16 a[234:235], v16 offset:33280
    v_mfma_f32_16x16x32_bf16 v[116:119], a[244:247], a[168:171], v[116:119]
    s_waitcnt lgkmcnt(13)
    ds_read_b64_tr_b16 a[236:237], v17 offset:32768
    v_mfma_f32_16x16x32_bf16 v[124:127], a[244:247], a[172:175], v[124:127]
    ds_read_b64_tr_b16 a[238:239], v17 offset:33280
    s_waitcnt lgkmcnt(13)
    v_mfma_f32_16x16x32_bf16 v[128:131], a[248:251], a[168:171], v[128:131]
    ds_read_b64_tr_b16 a[240:241], v14 offset:36864
    v_mfma_f32_16x16x32_bf16 v[136:139], a[248:251], a[172:175], v[136:139]
    ds_read_b64_tr_b16 a[242:243], v14 offset:37376
    v_mfma_f32_16x16x32_bf16 v[132:135], a[252:255], a[168:171], v[132:135]
    s_waitcnt lgkmcnt(13)
    ds_read_b64_tr_b16 a[244:245], v15 offset:36864
    v_mfma_f32_16x16x32_bf16 v[140:143], a[252:255], a[172:175], v[140:143]
    ds_read_b64_tr_b16 a[246:247], v15 offset:37376
    s_waitcnt lgkmcnt(9)
    v_mfma_f32_16x16x32_bf16 v[112:115], a[224:227], a[176:179], v[112:115]
    ds_read_b64_tr_b16 a[248:249], v16 offset:36864
    v_mfma_f32_16x16x32_bf16 v[120:123], a[224:227], a[180:183], v[120:123]
    ds_read_b64_tr_b16 a[250:251], v16 offset:37376
    v_mfma_f32_16x16x32_bf16 v[116:119], a[228:231], a[176:179], v[116:119]
    ds_read_b64_tr_b16 a[252:253], v17 offset:36864
    v_mfma_f32_16x16x32_bf16 v[124:127], a[228:231], a[180:183], v[124:127]
    ds_read_b64_tr_b16 a[254:255], v17 offset:37376
    s_waitcnt lgkmcnt(8)
    v_mfma_f32_16x16x32_bf16 v[128:131], a[232:235], a[176:179], v[128:131]
    ds_read_b128 a[192:195], v98 offset:20480
    ds_read_b128 a[196:199], v98 offset:22528
    v_mfma_f32_16x16x32_bf16 v[136:139], a[232:235], a[180:183], v[136:139]
    ds_read_b64_tr_b16 a[224:225], v14 offset:40960
    ds_read_b64_tr_b16 a[226:227], v14 offset:41472
    v_mfma_f32_16x16x32_bf16 v[132:135], a[236:239], a[176:179], v[132:135]
    ds_read_b128 a[200:203], v99 offset:20480
    ds_read_b64_tr_b16 a[228:229], v15 offset:40960
    v_mfma_f32_16x16x32_bf16 v[140:143], a[236:239], a[180:183], v[140:143]
    ds_read_b64_tr_b16 a[230:231], v15 offset:41472
    s_waitcnt lgkmcnt(11)
    v_mfma_f32_16x16x32_bf16 v[112:115], a[240:243], a[184:187], v[112:115]
    ds_read_b128 a[204:207], v99 offset:22528
    v_mfma_f32_16x16x32_bf16 v[120:123], a[240:243], a[188:191], v[120:123]
    ds_read_b64_tr_b16 a[232:233], v16 offset:40960
    ds_read_b64_tr_b16 a[234:235], v16 offset:41472
    v_mfma_f32_16x16x32_bf16 v[116:119], a[244:247], a[184:187], v[116:119]
    ds_read_b64_tr_b16 a[236:237], v17 offset:40960
    s_waitcnt lgkmcnt(13)
    ds_read_b64_tr_b16 a[238:239], v17 offset:41472
    v_mfma_f32_16x16x32_bf16 v[124:127], a[244:247], a[188:191], v[124:127]
    ds_read_b32 v1, v31 offset:4
    s_waitcnt lgkmcnt(13)
    v_mfma_f32_16x16x32_bf16 v[128:131], a[248:251], a[184:187], v[128:131]
    ds_read_b64_tr_b16 a[240:241], v14 offset:45056
    v_mfma_f32_16x16x32_bf16 v[136:139], a[248:251], a[188:191], v[136:139]
    ds_read_b64_tr_b16 a[242:243], v14 offset:45568
    v_mfma_f32_16x16x32_bf16 v[132:135], a[252:255], a[184:187], v[132:135]
    s_waitcnt lgkmcnt(13)
    ds_read_b64_tr_b16 a[244:245], v15 offset:45056
    v_mfma_f32_16x16x32_bf16 v[140:143], a[252:255], a[188:191], v[140:143]
    ds_read_b64_tr_b16 a[246:247], v15 offset:45568
    s_waitcnt lgkmcnt(10)
    v_mfma_f32_16x16x32_bf16 v[112:115], a[224:227], a[192:195], v[112:115]
    ds_read_b64_tr_b16 a[248:249], v16 offset:45056
    v_mfma_f32_16x16x32_bf16 v[120:123], a[224:227], a[196:199], v[120:123]
    ds_read_b64_tr_b16 a[250:251], v16 offset:45568
    s_waitcnt lgkmcnt(6)
    v_cmp_ne_u32 vcc, 0, v1
    v_mfma_f32_16x16x32_bf16 v[116:119], a[228:231], a[192:195], v[116:119]
    ds_read_b64_tr_b16 a[252:253], v17 offset:45056
    ds_read_b64_tr_b16 a[254:255], v17 offset:45568
    v_mfma_f32_16x16x32_bf16 v[124:127], a[228:231], a[196:199], v[124:127]
    ds_write_b32 v2, v31
    v_mfma_f32_16x16x32_bf16 v[128:131], a[232:235], a[192:195], v[128:131]
    s_getpc_b64 s[62:63]
    s_cbranch_vccnz L_cslow
    ds_read_b128 a[208:211], v98 offset:8192
    v_mfma_f32_16x16x32_bf16 v[136:139], a[232:235], a[196:199], v[136:139]
    ds_read_b128 a[212:215], v98 offset:10240
    ds_read_b64_tr_b16 a[224:225], v14 offset:49152
    ds_read_b64_tr_b16 a[226:227], v14 offset:49664
    v_mfma_f32_16x16x32_bf16 v[132:135], a[236:239], a[192:195], v[132:135]
    ds_read_b128 a[216:219], v99 offset:8192
    ds_read_b128 a[220:223], v99 offset:10240
    s_waitcnt lgkmcnt(13)
    ds_read_b64_tr_b16 a[228:229], v15 offset:49152
    v_mfma_f32_16x16x32_bf16 v[140:143], a[236:239], a[196:199], v[140:143]
    ds_read_b64_tr_b16 a[230:231], v15 offset:49664
    v_add_u32 v31, 4, v31
    s_waitcnt lgkmcnt(13)
    v_mfma_f32_16x16x32_bf16 v[112:115], a[240:243], a[200:203], v[112:115]
    ds_read_b64_tr_b16 a[232:233], v14 offset:53248
    v_mfma_f32_16x16x32_bf16 v[120:123], a[240:243], a[204:207], v[120:123]
    ds_read_b64_tr_b16 a[234:235], v14 offset:53760
    v_mfma_f32_16x16x32_bf16 v[116:119], a[244:247], a[200:203], v[116:119]
    s_waitcnt lgkmcnt(13)
    ds_read_b64_tr_b16 a[236:237], v15 offset:53248
    v_mfma_f32_16x16x32_bf16 v[124:127], a[244:247], a[204:207], v[124:127]
    ds_read_b64_tr_b16 a[238:239], v15 offset:53760
    s_waitcnt lgkmcnt(13)
    v_mfma_f32_16x16x32_bf16 v[128:131], a[248:251], a[200:203], v[128:131]
    ds_read_b64_tr_b16 a[240:241], v16 offset:49152
    v_mfma_f32_16x16x32_bf16 v[136:139], a[248:251], a[204:207], v[136:139]
    ds_read_b64_tr_b16 a[242:243], v16 offset:49664
    v_mfma_f32_16x16x32_bf16 v[132:135], a[252:255], a[200:203], v[132:135]
    s_waitcnt lgkmcnt(13)
    ds_read_b64_tr_b16 a[244:245], v17 offset:49152
    v_mfma_f32_16x16x32_bf16 v[140:143], a[252:255], a[204:207], v[140:143]
    ds_read_b64_tr_b16 a[246:247], v17 offset:49664
    s_waitcnt lgkmcnt(8)
    v_mfma_f32_16x16x32_bf16 v[112:115], a[224:227], a[208:211], v[112:115]
    ds_read_b64_tr_b16 a[248:249], v16 offset:53248
    v_mfma_f32_16x16x32_bf16 v[120:123], a[224:227], a[212:215], v[120:123]
    ds_read_b64_tr_b16 a[250:251], v16 offset:53760
    v_mfma_f32_16x16x32_bf16 v[116:119], a[228:231], a[208:211], v[116:119]
    ds_read_b64_tr_b16 a[252:253], v17 offset:53248
    v_mfma_f32_16x16x32_bf16 v[124:127], a[228:231], a[212:215], v[124:127]
    ds_read_b64_tr_b16 a[254:255], v17 offset:53760
    s_waitcnt lgkmcnt(8)
    v_mfma_f32_16x16x32_bf16 v[112:115], a[232:235], a[216:219], v[112:115]
    ds_read_b64_tr_b16 a[224:225], v14 offset:57344
    v_mfma_f32_16x16x32_bf16 v[120:123], a[232:235], a[220:223], v[120:123]
    ds_read_b64_tr_b16 a[226:227], v14 offset:57856
    v_mfma_f32_16x16x32_bf16 v[116:119], a[236:239], a[216:219], v[116:119]
    ds_read_b64_tr_b16 a[228:229], v15 offset:57344
    v_mfma_f32_16x16x32_bf16 v[124:127], a[236:239], a[220:223], v[124:127]
    ds_read_b64_tr_b16 a[230:231], v15 offset:57856
    s_waitcnt lgkmcnt(8)
    v_mfma_f32_16x16x32_bf16 v[128:131], a[240:243], a[208:211], v[128:131]
    ds_read_b64_tr_b16 a[232:233], v16 offset:57344
    v_mfma_f32_16x16x32_bf16 v[136:139], a[240:243], a[212:215], v[136:139]
    ds_read_b64_tr_b16 a[234:235], v16 offset:57856
    v_mfma_f32_16x16x32_bf16 v[132:135], a[244:247], a[208:211], v[132:135]
    ds_read_b64_tr_b16 a[236:237], v17 offset:57344
    ds_read_b64_tr_b16 a[238:239], v17 offset:57856
    v_cvt_pk_bf16_f32 v112, v112, v113
    v_mfma_f32_16x16x32_bf16 v[140:143], a[244:247], a[212:215], v[140:143]
    ds_read_b32 v1, v31 offset:4
    v_cvt_pk_bf16_f32 v116, v116, v117
    s_waitcnt lgkmcnt(9)
    v_mfma_f32_16x16x32_bf16 v[128:131], a[248:251], a[216:219], v[128:131]
    ds_read_b64_tr_b16 a[240:241], v14 offset:61440
    v_cvt_pk_bf16_f32 v114, v114, v115
    v_cvt_pk_bf16_f32 v118, v118, v119
    v_mfma_f32_16x16x32_bf16 v[136:139], a[248:251], a[220:223], v[136:139]
    ds_read_b64_tr_b16 a[242:243], v14 offset:61952
    v_permlane16_swap_b32 v112, v116
    v_permlane16_swap_b32 v114, v118
    v_mfma_f32_16x16x32_bf16 v[132:135], a[252:255], a[216:219], v[132:135]
    ds_read_b64_tr_b16 a[244:245], v15 offset:61440
    v_accvgpr_write_b32 a0, v112
    v_accvgpr_write_b32 a2, v116
    v_mfma_f32_16x16x32_bf16 v[140:143], a[252:255], a[220:223], v[140:143]
    ds_read_b64_tr_b16 a[246:247], v15 offset:61952
    v_accvgpr_write_b32 a1, v114
    s_waitcnt lgkmcnt(9)
    v_mfma_f32_16x16x32_bf16 a[32:35], a[224:227], a[112:115], 0
    ds_read_b64_tr_b16 a[248:249], v16 offset:61440
    v_accvgpr_write_b32 a3, v118
    v_cvt_pk_bf16_f32 v120, v120, v121
    v_mfma_f32_16x16x32_bf16 a[40:43], a[224:227], a[116:119], 0
    ds_read_b64_tr_b16 a[250:251], v16 offset:61952
    s_waitcnt lgkmcnt(6)
    v_cmp_ne_u32 vcc, 0, v1
    v_cvt_pk_bf16_f32 v124, v124, v125
    v_mfma_f32_16x16x32_bf16 a[36:39], a[228:231], a[112:115], 0
    ds_read_b64_tr_b16 a[252:253], v17 offset:61440
    ds_read_b64_tr_b16 a[254:255], v17 offset:61952
    v_cvt_pk_bf16_f32 v122, v122, v123
    v_mfma_f32_16x16x32_bf16 a[44:47], a[228:231], a[116:119], 0
    ds_write_b32 v2, v31
    v_cvt_pk_bf16_f32 v126, v126, v127
    v_mfma_f32_16x16x32_bf16 a[48:51], a[232:235], a[112:115], 0
    s_getpc_b64 s[62:63]
    s_cbranch_vccnz L_cslow
    v_permlane16_swap_b32 v120, v124
    v_mfma_f32_16x16x32_bf16 a[56:59], a[232:235], a[116:119], 0
    ds_read_b128 a[224:227], v8 offset:0
    v_permlane16_swap_b32 v122, v126
    v_accvgpr_write_b32 a4, v120
    v_mfma_f32_16x16x32_bf16 a[52:55], a[236:239], a[112:115], 0
    ds_read_b128 a[228:231], v9 offset:0
    v_accvgpr_write_b32 a6, v124
    v_accvgpr_write_b32 a5, v122
    v_mfma_f32_16x16x32_bf16 a[60:63], a[236:239], a[116:119], 0
    v_add_u32 v31, 4, v31
    v_accvgpr_write_b32 a7, v126
    s_waitcnt lgkmcnt(7)
    v_mfma_f32_16x16x32_bf16 a[32:35], a[240:243], a[120:123], a[32:35]
    ds_read_b128 a[232:235], v8 offset:2048
    v_cvt_pk_bf16_f32 v128, v128, v129
    v_cvt_pk_bf16_f32 v132, v132, v133
    v_mfma_f32_16x16x32_bf16 a[40:43], a[240:243], a[124:127], a[40:43]
    v_cvt_pk_bf16_f32 v130, v130, v131
    v_cvt_pk_bf16_f32 v134, v134, v135
    v_mfma_f32_16x16x32_bf16 a[36:39], a[244:247], a[120:123], a[36:39]
    ds_read_b128 a[236:239], v9 offset:2048
    v_permlane16_swap_b32 v128, v132
    v_permlane16_swap_b32 v130, v134
    v_mfma_f32_16x16x32_bf16 a[44:47], a[244:247], a[124:127], a[44:47]
    v_accvgpr_write_b32 a8, v128
    v_accvgpr_write_b32 a10, v132
    s_waitcnt lgkmcnt(5)
    v_mfma_f32_16x16x32_bf16 a[48:51], a[248:251], a[120:123], a[48:51]
    ds_read_b128 a[240:243], v8 offset:4096
    v_accvgpr_write_b32 a9, v130
    v_accvgpr_write_b32 a11, v134
    v_mfma_f32_16x16x32_bf16 a[56:59], a[248:251], a[124:127], a[56:59]
    v_cvt_pk_bf16_f32 v136, v136, v137
    v_cvt_pk_bf16_f32 v140, v140, v141
    v_mfma_f32_16x16x32_bf16 a[52:55], a[252:255], a[120:123], a[52:55]
    ds_read_b128 a[244:247], v9 offset:4096
    v_cvt_pk_bf16_f32 v138, v138, v139
    v_cvt_pk_bf16_f32 v142, v142, v143
    v_mfma_f32_16x16x32_bf16 a[60:63], a[252:255], a[124:127], a[60:63]
    v_permlane16_swap_b32 v136, v140
    v_permlane16_swap_b32 v138, v142
    s_waitcnt lgkmcnt(4)
    v_mfma_f32_16x16x32_bf16 v[32:35], a[224:227], a[0:3], 0
    ds_read_b128 a[248:251], v8 offset:6144
    v_accvgpr_write_b32 a12, v136
    v_accvgpr_write_b32 a14, v140
    v_mfma_f32_16x16x32_bf16 v[40:43], a[224:227], a[4:7], 0
    v_accvgpr_write_b32 a13, v138
    v_accvgpr_write_b32 a15, v142
    v_mfma_f32_16x16x32_bf16 v[32:35], a[228:231], a[8:11], v[32:35]
    ds_read_b128 a[252:255], v9 offset:6144
    v_mfma_f32_16x16x32_bf16 v[40:43], a[228:231], a[12:15], v[40:43]
    s_waitcnt lgkmcnt(4)
    v_mfma_f32_16x16x32_bf16 v[36:39], a[232:235], a[0:3], 0
    ds_read_b64_tr_b16 a[224:225], v18 offset:0
    v_mfma_f32_16x16x32_bf16 v[44:47], a[232:235], a[4:7], 0
    ds_read_b64_tr_b16 a[226:227], v18 offset:512
    v_mfma_f32_16x16x32_bf16 v[36:39], a[236:239], a[8:11], v[36:39]
    ds_read_b64_tr_b16 a[228:229], v19 offset:0
    v_mfma_f32_16x16x32_bf16 v[44:47], a[236:239], a[12:15], v[44:47]
    ds_read_b64_tr_b16 a[230:231], v19 offset:512
    s_waitcnt lgkmcnt(6)
    v_mfma_f32_16x16x32_bf16 v[160:163], a[240:243], a[0:3], 0
    ds_read_b64_tr_b16 a[232:233], v20 offset:0
    v_mfma_f32_16x16x32_bf16 v[168:171], a[240:243], a[4:7], 0
    ds_read_b64_tr_b16 a[234:235], v20 offset:512
    v_mfma_f32_16x16x32_bf16 v[160:163], a[244:247], a[8:11], v[160:163]
    ds_read_b64_tr_b16 a[236:237], v21 offset:0
    ds_read_b64_tr_b16 a[238:239], v21 offset:512
    v_mfma_f32_16x16x32_bf16 v[168:171], a[244:247], a[12:15], v[168:171]
    ds_read_b32 v1, v31 offset:4
    s_waitcnt lgkmcnt(9)
    v_mfma_f32_16x16x32_bf16 v[164:167], a[248:251], a[0:3], 0
    ds_read_b64_tr_b16 a[240:241], v18 offset:4096
    v_mfma_f32_16x16x32_bf16 v[172:175], a[248:251], a[4:7], 0
    ds_read_b64_tr_b16 a[242:243], v18 offset:4608
    v_mfma_f32_16x16x32_bf16 v[164:167], a[252:255], a[8:11], v[164:167]
    ds_read_b64_tr_b16 a[244:245], v19 offset:4096
    v_mfma_f32_16x16x32_bf16 v[172:175], a[252:255], a[12:15], v[172:175]
    ds_read_b64_tr_b16 a[246:247], v19 offset:4608
    s_waitcnt lgkmcnt(9)
    v_mfma_f32_16x16x32_bf16 a[32:35], a[224:227], a[128:131], a[32:35]
    ds_read_b64_tr_b16 a[248:249], v20 offset:4096
    v_mfma_f32_16x16x32_bf16 a[40:43], a[224:227], a[132:135], a[40:43]
    ds_read_b64_tr_b16 a[250:251], v20 offset:4608
    s_waitcnt lgkmcnt(6)
    v_cmp_ne_u32 vcc, 0, v1
    v_mfma_f32_16x16x32_bf16 a[36:39], a[228:231], a[128:131], a[36:39]
    ds_read_b64_tr_b16 a[252:253], v21 offset:4096
    ds_read_b64_tr_b16 a[254:255], v21 offset:4608
    v_mfma_f32_16x16x32_bf16 a[44:47], a[228:231], a[132:135], a[44:47]
    ds_write_b32 v2, v31
    v_mfma_f32_16x16x32_bf16 a[48:51], a[232:235], a[128:131], a[48:51]
    s_getpc_b64 s[62:63]
    s_cbranch_vccnz L_cslow
    v_mfma_f32_16x16x32_bf16 a[56:59], a[232:235], a[132:135], a[56:59]
    ds_read_b128 a[224:227], v8 offset:8192
    v_mfma_f32_16x16x32_bf16 a[52:55], a[236:239], a[128:131], a[52:55]
    ds_read_b128 a[228:231], v9 offset:8192
    v_mfma_f32_16x16x32_bf16 a[60:63], a[236:239], a[132:135], a[60:63]
    v_add_u32 v31, 4, v31
    s_waitcnt lgkmcnt(7)
    v_mfma_f32_16x16x32_bf16 a[32:35], a[240:243], a[136:139], a[32:35]
    ds_read_b128 a[232:235], v8 offset:10240
    v_mfma_f32_16x16x32_bf16 a[40:43], a[240:243], a[140:143], a[40:43]
    v_mfma_f32_16x16x32_bf16 a[36:39], a[244:247], a[136:139], a[36:39]
    ds_read_b128 a[236:239], v9 offset:10240
    v_mfma_f32_16x16x32_bf16 a[44:47], a[244:247], a[140:143], a[44:47]
    s_waitcnt lgkmcnt(5)
    v_mfma_f32_16x16x32_bf16 a[48:51], a[248:251], a[136:139], a[48:51]
    ds_read_b128 a[240:243], v8 offset:12288
    v_mfma_f32_16x16x32_bf16 a[56:59], a[248:251], a[140:143], a[56:59]
    v_mfma_f32_16x16x32_bf16 a[52:55], a[252:255], a[136:139], a[52:55]
    ds_read_b128 a[244:247], v9 offset:12288
    v_mfma_f32_16x16x32_bf16 a[60:63], a[252:255], a[140:143], a[60:63]
    s_waitcnt lgkmcnt(4)
    v_mfma_f32_16x16x32_bf16 v[48:51], a[224:227], a[0:3], 0
    ds_read_b128 a[248:251], v8 offset:14336
    v_mfma_f32_16x16x32_bf16 v[56:59], a[224:227], a[4:7], 0
    v_mfma_f32_16x16x32_bf16 v[48:51], a[228:231], a[8:11], v[48:51]
    ds_read_b128 a[252:255], v9 offset:14336
    v_mfma_f32_16x16x32_bf16 v[56:59], a[228:231], a[12:15], v[56:59]
    s_waitcnt lgkmcnt(4)
    v_mfma_f32_16x16x32_bf16 v[52:55], a[232:235], a[0:3], 0
    ds_read_b64_tr_b16 a[224:225], v22 offset:8192
    v_mfma_f32_16x16x32_bf16 v[60:63], a[232:235], a[4:7], 0
    ds_read_b64_tr_b16 a[226:227], v22 offset:8704
    v_mfma_f32_16x16x32_bf16 v[52:55], a[236:239], a[8:11], v[52:55]
    ds_read_b64_tr_b16 a[228:229], v23 offset:8192
    v_mfma_f32_16x16x32_bf16 v[60:63], a[236:239], a[12:15], v[60:63]
    ds_read_b64_tr_b16 a[230:231], v23 offset:8704
    s_waitcnt lgkmcnt(6)
    v_mfma_f32_16x16x32_bf16 v[176:179], a[240:243], a[0:3], 0
    ds_read_b64_tr_b16 a[232:233], v24 offset:8192
    v_mfma_f32_16x16x32_bf16 v[184:187], a[240:243], a[4:7], 0
    ds_read_b64_tr_b16 a[234:235], v24 offset:8704
    v_mfma_f32_16x16x32_bf16 v[176:179], a[244:247], a[8:11], v[176:179]
    ds_read_b64_tr_b16 a[236:237], v25 offset:8192
    ds_read_b64_tr_b16 a[238:239], v25 offset:8704
    v_mfma_f32_16x16x32_bf16 v[184:187], a[244:247], a[12:15], v[184:187]
    ds_read_b32 v1, v31 offset:4
    s_waitcnt lgkmcnt(9)
    v_mfma_f32_16x16x32_bf16 v[180:183], a[248:251], a[0:3], 0
    ds_read_b64_tr_b16 a[240:241], v22 offset:12288
    v_mfma_f32_16x16x32_bf16 v[188:191], a[248:251], a[4:7], 0
    ds_read_b64_tr_b16 a[242:243], v22 offset:12800
    v_mfma_f32_16x16x32_bf16 v[180:183], a[252:255], a[8:11], v[180:183]
    ds_read_b64_tr_b16 a[244:245], v23 offset:12288
    v_mfma_f32_16x16x32_bf16 v[188:191], a[252:255], a[12:15], v[188:191]
    ds_read_b64_tr_b16 a[246:247], v23 offset:12800
    s_waitcnt lgkmcnt(9)
    v_mfma_f32_16x16x32_bf16 a[32:35], a[224:227], a[144:147], a[32:35]
    ds_read_b64_tr_b16 a[248:249], v24 offset:12288
    v_mfma_f32_16x16x32_bf16 a[40:43], a[224:227], a[148:151], a[40:43]
    ds_read_b64_tr_b16 a[250:251], v24 offset:12800
    s_waitcnt lgkmcnt(6)
    v_cmp_ne_u32 vcc, 0, v1
    v_mfma_f32_16x16x32_bf16 a[36:39], a[228:231], a[144:147], a[36:39]
    ds_read_b64_tr_b16 a[252:253], v25 offset:12288
    ds_read_b64_tr_b16 a[254:255], v25 offset:12800
    v_mfma_f32_16x16x32_bf16 a[44:47], a[228:231], a[148:151], a[44:47]
    ds_write_b32 v2, v31
    v_mfma_f32_16x16x32_bf16 a[48:51], a[232:235], a[144:147], a[48:51]
    s_waitcnt vmcnt(0)
    v_add_u32 v152, 1, v150
    v_add_u32 v148, s7, v148
    s_cmp_lg_u32 s30, 0
    s_cbranch_scc1 L_nohello
    s_lshl_b32 s31, s58, 2
    s_lshl_b64 exec, 8, s31
    buffer_store_dword v152, v149, s[8:11], s6 offen sc1
    s_mov_b64 exec, -1
L_nohello:
    ds_write2st64_b32 v148, v152, v150 offset0:8 offset1:9
    v_mfma_f32_16x16x32_bf16 a[56:59], a[232:235], a[148:151], a[56:59]
    s_getpc_b64 s[62:63]
    s_cbranch_vccnz L_cslow
    ds_read_b128 a[224:227], v8 offset:16384
    v_mfma_f32_16x16x32_bf16 a[52:55], a[236:239], a[144:147], a[52:55]
    ds_read_b128 a[228:231], v9 offset:16384
    v_mfma_f32_16x16x32_bf16 a[60:63], a[236:239], a[148:151], a[60:63]
    v_add_u32 v31, 4, v31
    s_waitcnt lgkmcnt(8)
    v_mfma_f32_16x16x32_bf16 a[32:35], a[240:243], a[152:155], a[32:35]
    ds_read_b128 a[232:235], v8 offset:18432
    v_mfma_f32_16x16x32_bf16 a[40:43], a[240:243], a[156:159], a[40:43]
    v_mfma_f32_16x16x32_bf16 a[36:39], a[244:247], a[152:155], a[36:39]
    ds_read_b128 a[236:239], v9 offset:18432
    v_mfma_f32_16x16x32_bf16 a[44:47], a[244:247], a[156:159], a[44:47]
    s_waitcnt lgkmcnt(6)
    v_mfma_f32_16x16x32_bf16 a[48:51], a[248:251], a[152:155], a[48:51]
    ds_read_b128 a[240:243], v8 offset:20480
    v_mfma_f32_16x16x32_bf16 a[56:59], a[248:251], a[156:159], a[56:59]
    v_mfma_f32_16x16x32_bf16 a[52:55], a[252:255], a[152:155], a[52:55]
    ds_read_b128 a[244:247], v9 offset:20480
    v_mfma_f32_16x16x32_bf16 a[60:63], a[252:255], a[156:159], a[60:63]
    s_waitcnt lgkmcnt(4)
    v_mfma_f32_16x16x32_bf16 v[64:67], a[224:227], a[0:3], 0
    ds_read_b128 a[248:251], v8 offset:22528
    v_mfma_f32_16x16x32_bf16 v[72:75], a[224:227], a[4:7], 0
    v_mfma_f32_16x16x32_bf16 v[64:67], a[228:231], a[8:11], v[64:67]
    ds_read_b128 a[252:255], v9 offset:22528
    v_mfma_f32_16x16x32_bf16 v[72:75], a[228:231], a[12:15], v[72:75]
    s_waitcnt lgkmcnt(4)
    v_mfma_f32_16x16x32_bf16 v[68:71], a[232:235], a[0:3], 0
    ds_read_b64_tr_b16 a[224:225], v22 offset:16384
    v_mfma_f32_16x16x32_bf16 v[76:79], a[232:235], a[4:7], 0
    ds_read_b64_tr_b16 a[226:227], v22 offset:16896
    v_mfma_f32_16x16x32_bf16 v[68:71], a[236:239], a[8:11], v[68:71]
    ds_read_b64_tr_b16 a[228:229], v23 offset:16384
    v_mfma_f32_16x16x32_bf16 v[76:79], a[236:239], a[12:15], v[76:79]
    ds_read_b64_tr_b16 a[230:231], v23 offset:16896
    s_waitcnt lgkmcnt(6)
    v_mfma_f32_16x16x32_bf16 v[192:195], a[240:243], a[0:3], 0
    ds_read_b64_tr_b16 a[232:233], v24 offset:16384
    v_mfma_f32_16x16x32_bf16 v[200:203], a[240:243], a[4:7], 0
    ds_read_b64_tr_b16 a[234:235], v24 offset:16896
    v_mfma_f32_16x16x32_bf16 v[192:195], a[244:247], a[8:11], v[192:195]
    ds_read_b64_tr_b16 a[236:237], v25 offset:16384
    ds_read_b64_tr_b16 a[238:239], v25 offset:16896
    v_mfma_f32_16x16x32_bf16 v[200:203], a[244:247], a[12:15], v[200:203]
    ds_read_b32 v1, v31 offset:4
    s_waitcnt lgkmcnt(9)
    v_mfma_f32_16x16x32_bf16 v[196:199], a[248:251], a[0:3], 0
    ds_read_b64_tr_b16 a[240:241], v22 offset:20480
    v_mfma_f32_16x16x32_bf16 v[204:207], a[248:251], a[4:7], 0
    ds_read_b64_tr_b16 a[242:243], v22 offset:20992
    v_mfma_f32_16x16x32_bf16 v[196:199], a[252:255], a[8:11], v[196:199]
    ds_read_b64_tr_b16 a[244:245], v23 offset:20480
    v_mfma_f32_16x16x32_bf16 v[204:207], a[252:255], a[12:15], v[204:207]
    ds_read_b64_tr_b16 a[246:247], v23 offset:20992
    s_waitcnt lgkmcnt(9)
    v_mfma_f32_16x16x32_bf16 a[32:35], a[224:227], a[160:163], a[32:35]
    ds_read_b64_tr_b16 a[248:249], v24 offset:20480
    v_mfma_f32_16x16x32_bf16 a[40:43], a[224:227], a[164:167], a[40:43]
    ds_read_b64_tr_b16 a[250:251], v24 offset:20992
    s_waitcnt lgkmcnt(6)
    v_cmp_ne_u32 vcc, 0, v1
    v_mfma_f32_16x16x32_bf16 a[36:39], a[228:231], a[160:163], a[36:39]
    ds_read_b64_tr_b16 a[252:253], v25 offset:20480
    ds_read_b64_tr_b16 a[254:255], v25 offset:20992
    v_mfma_f32_16x16x32_bf16 a[44:47], a[228:231], a[164:167], a[44:47]
    ds_write_b32 v2, v31
    v_mfma_f32_16x16x32_bf16 a[48:51], a[232:235], a[160:163], a[48:51]
    s_getpc_b64 s[62:63]
    s_cbranch_vccnz L_cslow
    v_mfma_f32_16x16x32_bf16 a[56:59], a[232:235], a[164:167], a[56:59]
    ds_read_b128 a[224:227], v8 offset:24576
    v_mfma_f32_16x16x32_bf16 a[52:55], a[236:239], a[160:163], a[52:55]
    ds_read_b128 a[228:231], v9 offset:24576
    v_mfma_f32_16x16x32_bf16 a[60:63], a[236:239], a[164:167], a[60:63]
    v_add_u32 v31, 4, v31
    s_waitcnt lgkmcnt(7)
    v_mfma_f32_16x16x32_bf16 a[32:35], a[240:243], a[168:171], a[32:35]
    ds_read_b128 a[232:235], v8 offset:26624
    v_mfma_f32_16x16x32_bf16 a[40:43], a[240:243], a[172:175], a[40:43]
    v_mfma_f32_16x16x32_bf16 a[36:39], a[244:247], a[168:171], a[36:39]
    ds_read_b128 a[236:239], v9 offset:26624
    v_mfma_f32_16x16x32_bf16 a[44:47], a[244:247], a[172:175], a[44:47]
    s_waitcnt lgkmcnt(5)
    v_mfma_f32_16x16x32_bf16 a[48:51], a[248:251], a[168:171], a[48:51]
    ds_read_b128 a[240:243], v8 offset:28672
    v_mfma_f32_16x16x32_bf16 a[56:59], a[248:251], a[172:175], a[56:59]
    v_mfma_f32_16x16x32_bf16 a[52:55], a[252:255], a[168:171], a[52:55]
    ds_read_b128 a[244:247], v9 offset:28672
    v_mfma_f32_16x16x32_bf16 a[60:63], a[252:255], a[172:175], a[60:63]
    s_waitcnt lgkmcnt(4)
    v_mfma_f32_16x16x32_bf16 v[80:83], a[224:227], a[0:3], 0
    ds_read_b128 a[248:251], v8 offset:30720
    v_mfma_f32_16x16x32_bf16 v[88:91], a[224:227], a[4:7], 0
    v_mfma_f32_16x16x32_bf16 v[80:83], a[228:231], a[8:11], v[80:83]
    ds_read_b128 a[252:255], v9 offset:30720
    v_mfma_f32_16x16x32_bf16 v[88:91], a[228:231], a[12:15], v[88:91]
    s_waitcnt lgkmcnt(4)
    v_mfma_f32_16x16x32_bf16 v[84:87], a[232:235], a[0:3], 0
    ds_read_b64_tr_b16 a[224:225], v18 offset:49152
    v_mfma_f32_16x16x32_bf16 v[92:95], a[232:235], a[4:7], 0
    ds_read_b64_tr_b16 a[226:227], v18 offset:49664
    v_mfma_f32_16x16x32_bf16 v[84:87], a[236:239], a[8:11], v[84:87]
    ds_read_b64_tr_b16 a[228:229], v19 offset:49152
    v_mfma_f32_16x16x32_bf16 v[92:95], a[236:239], a[12:15], v[92:95]
    ds_read_b64_tr_b16 a[230:231], v19 offset:49664
    s_waitcnt lgkmcnt(6)
    v_mfma_f32_16x16x32_bf16 v[208:211], a[240:243], a[0:3], 0
    ds_read_b64_tr_b16 a[232:233], v20 offset:49152
    v_mfma_f32_16x16x32_bf16 v[216:219], a[240:243], a[4:7], 0
    ds_read_b64_tr_b16 a[234:235], v20 offset:49664
    v_mfma_f32_16x16x32_bf16 v[208:211], a[244:247], a[8:11], v[208:211]
    ds_read_b64_tr_b16 a[236:237], v21 offset:49152
    ds_read_b64_tr_b16 a[238:239], v21 offset:49664
    v_mfma_f32_16x16x32_bf16 v[216:219], a[244:247], a[12:15], v[216:219]
    ds_read_b32 v1, v31 offset:4
    s_waitcnt lgkmcnt(9)
    v_mfma_f32_16x16x32_bf16 v[212:215], a[248:251], a[0:3], 0
    ds_read_b64_tr_b16 a[240:241], v18 offset:53248
    v_mfma_f32_16x16x32_bf16 v[220:223], a[248:251], a[4:7], 0
    ds_read_b64_tr_b16 a[242:243], v18 offset:53760
    v_mfma_f32_16x16x32_bf16 v[212:215], a[252:255], a[8:11], v[212:215]
    ds_read_b64_tr_b16 a[244:245], v19 offset:53248
    v_mfma_f32_16x16x32_bf16 v[220:223], a[252:255], a[12:15], v[220:223]
    ds_read_b64_tr_b16 a[246:247], v19 offset:53760
    s_waitcnt lgkmcnt(9)
    v_mfma_f32_16x16x32_bf16 a[32:35], a[224:227], a[176:179], a[32:35]
    ds_read_b64_tr_b16 a[248:249], v20 offset:53248
    v_mfma_f32_16x16x32_bf16 a[40:43], a[224:227], a[180:183], a[40:43]
    ds_read_b64_tr_b16 a[250:251], v20 offset:53760
    s_waitcnt lgkmcnt(6)
    v_cmp_ne_u32 vcc, 0, v1
    v_mfma_f32_16x16x32_bf16 a[36:39], a[228:231], a[176:179], a[36:39]
    ds_read_b64_tr_b16 a[252:253], v21 offset:53248
    ds_read_b64_tr_b16 a[254:255], v21 offset:53760
    v_mfma_f32_16x16x32_bf16 a[44:47], a[228:231], a[180:183], a[44:47]
    ds_write_b32 v2, v31
    v_mfma_f32_16x16x32_bf16 a[48:51], a[232:235], a[176:179], a[48:51]
    s_getpc_b64 s[62:63]
    s_cbranch_vccnz L_cslow
    v_mfma_f32_16x16x32_bf16 a[56:59], a[232:235], a[180:183], a[56:59]
    ds_read_b128 a[224:227], v12 offset:0
    v_mfma_f32_16x16x32_bf16 a[52:55], a[236:239], a[176:179], a[52:55]
    ds_read_b128 a[228:231], v13 offset:0
    v_mfma_f32_16x16x32_bf16 a[60:63], a[236:239], a[180:183], a[60:63]
    v_add_u32 v31, 4, v31
    s_waitcnt lgkmcnt(7)
    v_mfma_f32_16x16x32_bf16 a[32:35], a[240:243], a[184:187], a[32:35]
    ds_read_b128 a[232:235], v12 offset:2048
    v_mfma_f32_16x16x32_bf16 a[40:43], a[240:243], a[188:191], a[40:43]
    v_mfma_f32_16x16x32_bf16 a[36:39], a[244:247], a[184:187], a[36:39]
    ds_read_b128 a[236:239], v13 offset:2048
    v_mfma_f32_16x16x32_bf16 a[44:47], a[244:247], a[188:191], a[44:47]
    s_waitcnt lgkmcnt(5)
    v_mfma_f32_16x16x32_bf16 a[48:51], a[248:251], a[184:187], a[48:51]
    ds_read_b128 a[240:243], v12 offset:4096
    v_mfma_f32_16x16x32_bf16 a[56:59], a[248:251], a[188:191], a[56:59]
    v_mfma_f32_16x16x32_bf16 a[52:55], a[252:255], a[184:187], a[52:55]
    ds_read_b128 a[244:247], v13 offset:4096
    v_mfma_f32_16x16x32_bf16 a[60:63], a[252:255], a[188:191], a[60:63]
    s_waitcnt lgkmcnt(4)
    v_mfma_f32_16x16x32_bf16 v[96:99], a[224:227], a[0:3], 0
    ds_read_b128 a[248:251], v12 offset:6144
    v_mfma_f32_16x16x32_bf16 v[104:107], a[224:227], a[4:7], 0
    v_mfma_f32_16x16x32_bf16 v[96:99], a[228:231], a[8:11], v[96:99]
    ds_read_b128 a[252:255], v13 offset:6144
    v_mfma_f32_16x16x32_bf16 v[104:107], a[228:231], a[12:15], v[104:107]
    s_waitcnt lgkmcnt(4)
    v_mfma_f32_16x16x32_bf16 v[100:103], a[232:235], a[0:3], 0
    ds_read_b64_tr_b16 a[224:225], v18 offset:57344
    v_mfma_f32_16x16x32_bf16 v[108:111], a[232:235], a[4:7], 0
    ds_read_b64_tr_b16 a[226:227], v18 offset:57856
    v_mfma_f32_16x16x32_bf16 v[100:103], a[236:239], a[8:11], v[100:103]
    ds_read_b64_tr_b16 a[228:229], v19 offset:57344
    v_mfma_f32_16x16x32_bf16 v[108:111], a[236:239], a[12:15], v[108:111]
    ds_read_b64_tr_b16 a[230:231], v19 offset:57856
    s_waitcnt lgkmcnt(6)
    v_mfma_f32_16x16x32_bf16 v[224:227], a[240:243], a[0:3], 0
    ds_read_b64_tr_b16 a[232:233], v20 offset:57344
    v_mfma_f32_16x16x32_bf16 v[232:235], a[240:243], a[4:7], 0
    ds_read_b64_tr_b16 a[234:235], v20 offset:57856
    v_mfma_f32_16x16x32_bf16 v[224:227], a[244:247], a[8:11], v[224:227]
    ds_read_b64_tr_b16 a[236:237], v21 offset:57344
    ds_read_b64_tr_b16 a[238:239], v21 offset:57856
    v_mfma_f32_16x16x32_bf16 v[232:235], a[244:247], a[12:15], v[232:235]
    ds_read_b32 v1, v31 offset:4
    s_waitcnt lgkmcnt(9)
    v_mfma_f32_16x16x32_bf16 v[228:231], a[248:251], a[0:3], 0
    ds_read_b64_tr_b16 a[240:241], v18 offset:61440
    v_mfma_f32_16x16x32_bf16 v[236:239], a[248:251], a[4:7], 0
    ds_read_b64_tr_b16 a[242:243], v18 offset:61952
    v_mfma_f32_16x16x32_bf16 v[228:231], a[252:255], a[8:11], v[228:231]
    ds_read_b64_tr_b16 a[244:245], v19 offset:61440
    v_mfma_f32_16x16x32_bf16 v[236:239], a[252:255], a[12:15], v[236:239]
    ds_read_b64_tr_b16 a[246:247], v19 offset:61952
    s_waitcnt lgkmcnt(9)
    v_mfma_f32_16x16x32_bf16 a[32:35], a[224:227], a[192:195], a[32:35]
    ds_read_b64_tr_b16 a[248:249], v20 offset:61440
    v_mfma_f32_16x16x32_bf16 a[40:43], a[224:227], a[196:199], a[40:43]
    ds_read_b64_tr_b16 a[250:251], v20 offset:61952
    s_waitcnt lgkmcnt(6)
    v_cmp_ne_u32 vcc, 0, v1
    v_mfma_f32_16x16x32_bf16 a[36:39], a[228:231], a[192:195], a[36:39]
    ds_read_b64_tr_b16 a[252:253], v21 offset:61440
    ds_read_b64_tr_b16 a[254:255], v21 offset:61952
    v_mfma_f32_16x16x32_bf16 a[44:47], a[228:231], a[196:199], a[44:47]
    ds_write_b32 v2, v31
    v_mfma_f32_16x16x32_bf16 a[48:51], a[232:235], a[192:195], a[48:51]
    s_getpc_b64 s[62:63]
    s_cbranch_vccnz L_cslow
    v_mfma_f32_16x16x32_bf16 a[56:59], a[232:235], a[196:199], a[56:59]
    ds_read_b128 a[224:227], v8 offset:32768
    v_mfma_f32_16x16x32_bf16 a[52:55], a[236:239], a[192:195], a[52:55]
    ds_read_b128 a[228:231], v9 offset:32768
    v_mfma_f32_16x16x32_bf16 a[60:63], a[236:239], a[196:199], a[60:63]
    v_add_u32 v31, 4, v31
    s_waitcnt lgkmcnt(7)
    v_mfma_f32_16x16x32_bf16 a[32:35], a[240:243], a[200:203], a[32:35]
    ds_read_b128 a[232:235], v8 offset:34816
    v_mfma_f32_16x16x32_bf16 a[40:43], a[240:243], a[204:207], a[40:43]
    v_mfma_f32_16x16x32_bf16 a[36:39], a[244:247], a[200:203], a[36:39]
    ds_read_b128 a[236:239], v9 offset:34816
    v_mfma_f32_16x16x32_bf16 a[44:47], a[244:247], a[204:207], a[44:47]
    s_waitcnt lgkmcnt(5)
    v_mfma_f32_16x16x32_bf16 a[48:51], a[248:251], a[200:203], a[48:51]
    ds_read_b128 a[240:243], v8 offset:36864
    v_mfma_f32_16x16x32_bf16 a[56:59], a[248:251], a[204:207], a[56:59]
    v_mfma_f32_16x16x32_bf16 a[52:55], a[252:255], a[200:203], a[52:55]
    ds_read_b128 a[244:247], v9 offset:36864
    v_mfma_f32_16x16x32_bf16 a[60:63], a[252:255], a[204:207], a[60:63]
    s_waitcnt lgkmcnt(4)
    v_mfma_f32_16x16x32_bf16 v[112:115], a[224:227], a[0:3], 0
    ds_read_b128 a[248:251], v8 offset:38912
    v_mfma_f32_16x16x32_bf16 v[120:123], a[224:227], a[4:7], 0
    v_mfma_f32_16x16x32_bf16 v[112:115], a[228:231], a[8:11], v[112:115]
    ds_read_b128 a[252:255], v9 offset:38912
    v_mfma_f32_16x16x32_bf16 v[120:123], a[228:231], a[12:15], v[120:123]
    s_waitcnt lgkmcnt(4)
    v_mfma_f32_16x16x32_bf16 v[116:119], a[232:235], a[0:3], 0
    ds_read_b64_tr_b16 a[224:225], v14 offset:40960
    v_mfma_f32_16x16x32_bf16 v[124:127], a[232:235], a[4:7], 0
    ds_read_b64_tr_b16 a[226:227], v14 offset:41472
    v_mfma_f32_16x16x32_bf16 v[116:119], a[236:239], a[8:11], v[116:119]
    ds_read_b64_tr_b16 a[228:229], v15 offset:40960
    v_mfma_f32_16x16x32_bf16 v[124:127], a[236:239], a[12:15], v[124:127]
    ds_read_b64_tr_b16 a[230:231], v15 offset:41472
    s_waitcnt lgkmcnt(6)
    v_mfma_f32_16x16x32_bf16 v[240:243], a[240:243], a[0:3], 0
    ds_read_b64_tr_b16 a[232:233], v14 offset:45056
    v_mfma_f32_16x16x32_bf16 v[248:251], a[240:243], a[4:7], 0
    ds_read_b64_tr_b16 a[234:235], v14 offset:45568
    v_mfma_f32_16x16x32_bf16 v[240:243], a[244:247], a[8:11], v[240:243]
    ds_read_b64_tr_b16 a[236:237], v15 offset:45056
    ds_read_b64_tr_b16 a[238:239], v15 offset:45568
    v_mfma_f32_16x16x32_bf16 v[248:251], a[244:247], a[12:15], v[248:251]
    ds_read_b32 v1, v31 offset:4
    s_waitcnt lgkmcnt(9)
    v_mfma_f32_16x16x32_bf16 v[244:247], a[248:251], a[0:3], 0
    ds_read_b64_tr_b16 a[240:241], v16 offset:40960
    v_mfma_f32_16x16x32_bf16 v[252:255], a[248:251], a[4:7], 0
    ds_read_b64_tr_b16 a[242:243], v16 offset:41472
    v_mfma_f32_16x16x32_bf16 v[244:247], a[252:255], a[8:11], v[244:247]
    ds_read_b64_tr_b16 a[244:245], v17 offset:40960
    v_mfma_f32_16x16x32_bf16 v[252:255], a[252:255], a[12:15], v[252:255]
    ds_read_b64_tr_b16 a[246:247], v17 offset:41472
    s_waitcnt lgkmcnt(9)
    v_mfma_f32_16x16x32_bf16 a[32:35], a[224:227], a[208:211], a[32:35]
    ds_read_b64_tr_b16 a[248:249], v16 offset:45056
    v_mfma_f32_16x16x32_bf16 a[40:43], a[224:227], a[212:215], a[40:43]
    ds_read_b64_tr_b16 a[250:251], v16 offset:45568
    s_waitcnt lgkmcnt(6)
    v_cmp_ne_u32 vcc, 0, v1
    v_mfma_f32_16x16x32_bf16 a[36:39], a[228:231], a[208:211], a[36:39]
    ds_read_b64_tr_b16 a[252:253], v17 offset:45056
    ds_read_b64_tr_b16 a[254:255], v17 offset:45568
    v_mfma_f32_16x16x32_bf16 a[44:47], a[228:231], a[212:215], a[44:47]
    ds_write_b32 v2, v31
    v_mfma_f32_16x16x32_bf16 a[32:35], a[232:235], a[216:219], a[32:35]
    s_getpc_b64 s[62:63]
    s_cbranch_vccnz L_cslow
    v_mfma_f32_16x16x32_bf16 a[40:43], a[232:235], a[220:223], a[40:43]
    ds_read_b128 a[224:227], v10 offset:32768
    v_mfma_f32_16x16x32_bf16 a[36:39], a[236:239], a[216:219], a[36:39]
    ds_read_b128 a[228:231], v11 offset:32768
    v_mfma_f32_16x16x32_bf16 a[44:47], a[236:239], a[220:223], a[44:47]
    v_add_u32 v31, 4, v31
    s_waitcnt lgkmcnt(7)
    v_mfma_f32_16x16x32_bf16 a[48:51], a[240:243], a[208:211], a[48:51]
    ds_read_b128 a[232:235], v10 offset:34816
    v_mfma_f32_16x16x32_bf16 a[56:59], a[240:243], a[212:215], a[56:59]
    v_mfma_f32_16x16x32_bf16 a[52:55], a[244:247], a[208:211], a[52:55]
    ds_read_b128 a[236:239], v11 offset:34816
    v_accvgpr_read_b32 v3, a32
    v_accvgpr_read_b32 v4, a33
    v_mfma_f32_16x16x32_bf16 a[60:63], a[244:247], a[212:215], a[60:63]
    v_accvgpr_read_b32 v5, a34
    v_accvgpr_read_b32 v6, a35
    s_waitcnt lgkmcnt(5)
    v_mfma_f32_16x16x32_bf16 a[48:51], a[248:251], a[216:219], a[48:51]
    ds_read_b128 a[240:243], v10 offset:36864
    v_accvgpr_read_b32 v7, a36
    v_accvgpr_read_b32 v26, a37
    v_mfma_f32_16x16x32_bf16 a[56:59], a[248:251], a[220:223], a[56:59]
    v_accvgpr_read_b32 v27, a38
    v_accvgpr_read_b32 v28, a39
    v_mfma_f32_16x16x32_bf16 a[52:55], a[252:255], a[216:219], a[52:55]
    ds_read_b128 a[244:247], v11 offset:36864
    v_cvt_pk_bf16_f32 v3, v3, v4
    v_cvt_pk_bf16_f32 v7, v7, v26
    v_mfma_f32_16x16x32_bf16 a[60:63], a[252:255], a[220:223], a[60:63]
    v_cvt_pk_bf16_f32 v5, v5, v6
    v_cvt_pk_bf16_f32 v27, v27, v28
    s_waitcnt lgkmcnt(4)
    v_mfma_f32_16x16x32_bf16 v[128:131], a[224:227], a[0:3], 0
    ds_read_b128 a[248:251], v10 offset:38912
    v_permlane16_swap_b32 v3, v7
    v_permlane16_swap_b32 v5, v27
    v_mfma_f32_16x16x32_bf16 v[136:139], a[224:227], a[4:7], 0
    v_accvgpr_write_b32 a32, v3
    v_accvgpr_write_b32 a34, v7
    v_mfma_f32_16x16x32_bf16 v[128:131], a[228:231], a[8:11], v[128:131]
    ds_read_b128 a[252:255], v11 offset:38912
    v_accvgpr_write_b32 a33, v5
    v_accvgpr_write_b32 a35, v27
    v_mfma_f32_16x16x32_bf16 v[136:139], a[228:231], a[12:15], v[136:139]
    v_accvgpr_read_b32 v3, a40
    v_accvgpr_read_b32 v4, a41
    s_waitcnt lgkmcnt(4)
    v_mfma_f32_16x16x32_bf16 v[132:135], a[232:235], a[0:3], 0
    ds_read_b128 a[224:227], v10 offset:40960
    v_accvgpr_read_b32 v5, a42
    v_accvgpr_read_b32 v6, a43
    v_mfma_f32_16x16x32_bf16 v[140:143], a[232:235], a[4:7], 0
    v_accvgpr_read_b32 v7, a44
    v_accvgpr_read_b32 v26, a45
    v_mfma_f32_16x16x32_bf16 v[132:135], a[236:239], a[8:11], v[132:135]
    ds_read_b128 a[228:231], v11 offset:40960
    v_accvgpr_read_b32 v27, a46
    v_accvgpr_read_b32 v28, a47
    v_mfma_f32_16x16x32_bf16 v[140:143], a[236:239], a[12:15], v[140:143]
    v_cvt_pk_bf16_f32 v3, v3, v4
    v_cvt_pk_bf16_f32 v7, v7, v26
    s_waitcnt lgkmcnt(4)
    v_mfma_f32_16x16x32_bf16 a[64:67], a[240:243], a[0:3], 0
    ds_read_b128 a[232:235], v10 offset:43008
    v_cvt_pk_bf16_f32 v5, v5, v6
    v_cvt_pk_bf16_f32 v27, v27, v28
    v_mfma_f32_16x16x32_bf16 a[72:75], a[240:243], a[4:7], 0
    v_permlane16_swap_b32 v3, v7
    v_permlane16_swap_b32 v5, v27
    v_mfma_f32_16x16x32_bf16 a[64:67], a[244:247], a[8:11], a[64:67]
    ds_read_b128 a[236:239], v11 offset:43008
    v_accvgpr_write_b32 a36, v3
    v_accvgpr_write_b32 a38, v7
    v_mfma_f32_16x16x32_bf16 a[72:75], a[244:247], a[12:15], a[72:75]
    ds_read_b32 v1, v31 offset:4
    v_accvgpr_write_b32 a37, v5
    s_waitcnt lgkmcnt(5)
    v_mfma_f32_16x16x32_bf16 a[68:71], a[248:251], a[0:3], 0
    ds_read_b128 a[240:243], v10 offset:45056
    v_accvgpr_write_b32 a39, v27
    v_accvgpr_read_b32 v3, a48
    v_mfma_f32_16x16x32_bf16 a[76:79], a[248:251], a[4:7], 0
    v_accvgpr_read_b32 v4, a49
    v_accvgpr_read_b32 v5, a50
    v_mfma_f32_16x16x32_bf16 a[68:71], a[252:255], a[8:11], a[68:71]
    ds_read_b128 a[244:247], v11 offset:45056
    v_accvgpr_read_b32 v6, a51
    v_accvgpr_read_b32 v7, a52
    v_mfma_f32_16x16x32_bf16 a[76:79], a[252:255], a[12:15], a[76:79]
    v_accvgpr_read_b32 v26, a53
    v_accvgpr_read_b32 v27, a54
    s_waitcnt lgkmcnt(5)
    v_mfma_f32_16x16x32_bf16 v[144:147], a[224:227], a[0:3], 0
    ds_read_b128 a[248:251], v10 offset:47104
    v_accvgpr_read_b32 v28, a55
    v_cvt_pk_bf16_f32 v3, v3, v4
    v_mfma_f32_16x16x32_bf16 v[152:155], a[224:227], a[4:7], 0
    s_waitcnt lgkmcnt(3)
    v_cmp_ne_u32 vcc, 0, v1
    v_cvt_pk_bf16_f32 v7, v7, v26
    v_mfma_f32_16x16x32_bf16 v[144:147], a[228:231], a[8:11], v[144:147]
    ds_read_b128 a[252:255], v11 offset:47104
    v_cvt_pk_bf16_f32 v5, v5, v6
    v_cvt_pk_bf16_f32 v27, v27, v28
    v_mfma_f32_16x16x32_bf16 v[152:155], a[228:231], a[12:15], v[152:155]
    ds_write_b32 v2, v31
    v_permlane16_swap_b32 v3, v7
    v_mfma_f32_16x16x32_bf16 v[148:151], a[232:235], a[0:3], 0
    s_getpc_b64 s[62:63]
    s_cbranch_vccnz L_cslow
    v_permlane16_swap_b32 v5, v27
    v_mfma_f32_16x16x32_bf16 v[156:159], a[232:235], a[4:7], 0
    ds_read_b64_tr_b16 a[224:225], v18 offset:24576
    ds_read_b64_tr_b16 a[226:227], v18 offset:25088
    v_accvgpr_write_b32 a40, v3
    v_mfma_f32_16x16x32_bf16 v[148:151], a[236:239], a[8:11], v[148:151]
    ds_read_b64_tr_b16 a[228:229], v19 offset:24576
    ds_read_b64_tr_b16 a[230:231], v19 offset:25088
    v_accvgpr_write_b32 a42, v7
    v_mfma_f32_16x16x32_bf16 v[156:159], a[236:239], a[12:15], v[156:159]
    v_add_u32 v31, 4, v31
    v_accvgpr_write_b32 a41, v5
    s_waitcnt lgkmcnt(7)
    v_mfma_f32_16x16x32_bf16 a[80:83], a[240:243], a[0:3], 0
    ds_read_b64_tr_b16 a[232:233], v20 offset:24576
    v_accvgpr_write_b32 a43, v27
    v_accvgpr_read_b32 v3, a56
    v_mfma_f32_16x16x32_bf16 a[88:91], a[240:243], a[4:7], 0
    ds_read_b64_tr_b16 a[234:235], v20 offset:25088
    v_accvgpr_read_b32 v4, a57
    v_accvgpr_read_b32 v5, a58
    v_mfma_f32_16x16x32_bf16 a[80:83], a[244:247], a[8:11], a[80:83]
    ds_read_b64_tr_b16 a[236:237], v21 offset:24576
    v_accvgpr_read_b32 v6, a59
    v_accvgpr_read_b32 v7, a60
    v_mfma_f32_16x16x32_bf16 a[88:91], a[244:247], a[12:15], a[88:91]
    ds_read_b64_tr_b16 a[238:239], v21 offset:25088
    v_accvgpr_read_b32 v26, a61
    s_waitcnt lgkmcnt(9)
    v_mfma_f32_16x16x32_bf16 a[84:87], a[248:251], a[0:3], 0
    ds_read_b64_tr_b16 a[240:241], v18 offset:28672
    v_accvgpr_read_b32 v27, a62
    v_accvgpr_read_b32 v28, a63
    v_mfma_f32_16x16x32_bf16 a[92:95], a[248:251], a[4:7], 0
    ds_read_b64_tr_b16 a[242:243], v18 offset:29184
    v_cvt_pk_bf16_f32 v3, v3, v4
    v_cvt_pk_bf16_f32 v7, v7, v26
    v_mfma_f32_16x16x32_bf16 a[84:87], a[252:255], a[8:11], a[84:87]
    ds_read_b64_tr_b16 a[244:245], v19 offset:28672
    v_cvt_pk_bf16_f32 v5, v5, v6
    v_cvt_pk_bf16_f32 v27, v27, v28
    v_mfma_f32_16x16x32_bf16 a[92:95], a[252:255], a[12:15], a[92:95]
    ds_read_b64_tr_b16 a[246:247], v19 offset:29184
    v_permlane16_swap_b32 v3, v7
    s_waitcnt lgkmcnt(8)
    v_mfma_f32_16x16x32_bf16 a[0:3], a[224:227], a[112:115], 0
    ds_read_b64_tr_b16 a[248:249], v20 offset:28672
    v_permlane16_swap_b32 v5, v27
    v_accvgpr_write_b32 a44, v3
    v_mfma_f32_16x16x32_bf16 a[8:11], a[224:227], a[116:119], 0
    ds_read_b64_tr_b16 a[250:251], v20 offset:29184
    v_accvgpr_write_b32 a46, v7
    v_accvgpr_write_b32 a45, v5
    v_mfma_f32_16x16x32_bf16 a[4:7], a[228:231], a[112:115], 0
    ds_read_b64_tr_b16 a[252:253], v21 offset:28672
    v_accvgpr_write_b32 a47, v27
    v_mfma_f32_16x16x32_bf16 a[12:15], a[228:231], a[116:119], 0
    ds_read_b64_tr_b16 a[254:255], v21 offset:29184
    s_waitcnt lgkmcnt(8)
    v_mfma_f32_16x16x32_bf16 a[16:19], a[232:235], a[112:115], 0
    ds_read_b128 a[224:227], v10 offset:8192
    v_mfma_f32_16x16x32_bf16 a[24:27], a[232:235], a[116:119], 0
    v_mfma_f32_16x16x32_bf16 a[20:23], a[236:239], a[112:115], 0
    ds_read_b128 a[228:231], v11 offset:8192
    v_mfma_f32_16x16x32_bf16 a[28:31], a[236:239], a[116:119], 0
    s_waitcnt lgkmcnt(6)
    v_mfma_f32_16x16x32_bf16 a[0:3], a[240:243], a[120:123], a[0:3]
    ds_read_b128 a[232:235], v10 offset:10240
    v_mfma_f32_16x16x32_bf16 a[8:11], a[240:243], a[124:127], a[8:11]
    v_mfma_f32_16x16x32_bf16 a[4:7], a[244:247], a[120:123], a[4:7]
    ds_read_b128 a[236:239], v11 offset:10240
    v_mfma_f32_16x16x32_bf16 a[12:15], a[244:247], a[124:127], a[12:15]
    ds_read_b32 v1, v31 offset:4
    s_waitcnt lgkmcnt(5)
    v_mfma_f32_16x16x32_bf16 a[16:19], a[248:251], a[120:123], a[16:19]
    ds_read_b128 a[240:243], v10 offset:12288
    v_mfma_f32_16x16x32_bf16 a[24:27], a[248:251], a[124:127], a[24:27]
    v_mfma_f32_16x16x32_bf16 a[20:23], a[252:255], a[120:123], a[20:23]
    ds_read_b128 a[244:247], v11 offset:12288
    v_mfma_f32_16x16x32_bf16 a[28:31], a[252:255], a[124:127], a[28:31]
    s_waitcnt lgkmcnt(5)
    v_mfma_f32_16x16x32_bf16 v[32:35], a[224:227], a[32:35], v[32:35]
    ds_read_b128 a[248:251], v10 offset:14336
    v_mfma_f32_16x16x32_bf16 v[40:43], a[224:227], a[36:39], v[40:43]
    s_waitcnt lgkmcnt(3)
    v_cmp_ne_u32 vcc, 0, v1
    v_mfma_f32_16x16x32_bf16 v[32:35], a[228:231], a[40:43], v[32:35]
    ds_read_b128 a[252:255], v11 offset:14336
    v_mfma_f32_16x16x32_bf16 v[40:43], a[228:231], a[44:47], v[40:43]
    ds_write_b32 v2, v31
    v_mfma_f32_16x16x32_bf16 v[36:39], a[232:235], a[32:35], v[36:39]
    s_getpc_b64 s[62:63]
    s_cbranch_vccnz L_cslow
    v_mfma_f32_16x16x32_bf16 v[44:47], a[232:235], a[36:39], v[44:47]
    ds_read_b64_tr_b16 a[224:225], v14 offset:49152
    ds_read_b64_tr_b16 a[226:227], v14 offset:49664
    v_mfma_f32_16x16x32_bf16 v[36:39], a[236:239], a[40:43], v[36:39]
    ds_read_b64_tr_b16 a[228:229], v15 offset:49152
    ds_read_b64_tr_b16 a[230:231], v15 offset:49664
    v_mfma_f32_16x16x32_bf16 v[44:47], a[236:239], a[44:47], v[44:47]
    v_add_u32 v31, 4, v31
    s_waitcnt lgkmcnt(7)
    v_mfma_f32_16x16x32_bf16 v[160:163], a[240:243], a[32:35], v[160:163]
    ds_read_b64_tr_b16 a[232:233], v16 offset:49152
    v_mfma_f32_16x16x32_bf16 v[168:171], a[240:243], a[36:39], v[168:171]
    ds_read_b64_tr_b16 a[234:235], v16 offset:49664
    v_mfma_f32_16x16x32_bf16 v[160:163], a[244:247], a[40:43], v[160:163]
    ds_read_b64_tr_b16 a[236:237], v17 offset:49152
    v_mfma_f32_16x16x32_bf16 v[168:171], a[244:247], a[44:47], v[168:171]
    ds_read_b64_tr_b16 a[238:239], v17 offset:49664
    s_waitcnt lgkmcnt(9)
    v_mfma_f32_16x16x32_bf16 v[164:167], a[248:251], a[32:35], v[164:167]
    ds_read_b64_tr_b16 a[240:241], v14 offset:53248
    v_mfma_f32_16x16x32_bf16 v[172:175], a[248:251], a[36:39], v[172:175]
    ds_read_b64_tr_b16 a[242:243], v14 offset:53760
    v_mfma_f32_16x16x32_bf16 v[164:167], a[252:255], a[40:43], v[164:167]
    ds_read_b64_tr_b16 a[244:245], v15 offset:53248
    v_mfma_f32_16x16x32_bf16 v[172:175], a[252:255], a[44:47], v[172:175]
    ds_read_b64_tr_b16 a[246:247], v15 offset:53760
    s_waitcnt lgkmcnt(8)
    v_mfma_f32_16x16x32_bf16 a[0:3], a[224:227], a[128:131], a[0:3]
    ds_read_b64_tr_b16 a[248:249], v16 offset:53248
    v_mfma_f32_16x16x32_bf16 a[8:11], a[224:227], a[132:135], a[8:11]
    ds_read_b64_tr_b16 a[250:251], v16 offset:53760
    v_mfma_f32_16x16x32_bf16 a[4:7], a[228:231], a[128:131], a[4:7]
    ds_read_b64_tr_b16 a[252:253], v17 offset:53248
    v_mfma_f32_16x16x32_bf16 a[12:15], a[228:231], a[132:135], a[12:15]
    ds_read_b64_tr_b16 a[254:255], v17 offset:53760
    s_waitcnt lgkmcnt(8)
    v_mfma_f32_16x16x32_bf16 a[16:19], a[232:235], a[128:131], a[16:19]
    ds_read_b128 a[224:227], v10 offset:16384
    v_mfma_f32_16x16x32_bf16 a[24:27], a[232:235], a[132:135], a[24:27]
    v_mfma_f32_16x16x32_bf16 a[20:23], a[236:239], a[128:131], a[20:23]
    ds_read_b128 a[228:231], v11 offset:16384
    v_mfma_f32_16x16x32_bf16 a[28:31], a[236:239], a[132:135], a[28:31]
    s_waitcnt lgkmcnt(6)
    v_mfma_f32_16x16x32_bf16 a[0:3], a[240:243], a[136:139], a[0:3]
    ds_read_b128 a[232:235], v10 offset:18432
    v_mfma_f32_16x16x32_bf16 a[8:11], a[240:243], a[140:143], a[8:11]
    v_mfma_f32_16x16x32_bf16 a[4:7], a[244:247], a[136:139], a[4:7]
    ds_read_b128 a[236:239], v11 offset:18432
    v_mfma_f32_16x16x32_bf16 a[12:15], a[244:247], a[140:143], a[12:15]
    ds_read_b32 v1, v31 offset:4
    s_waitcnt lgkmcnt(5)
    v_mfma_f32_16x16x32_bf16 a[16:19], a[248:251], a[136:139], a[16:19]
    ds_read_b128 a[240:243], v10 offset:20480
    v_mfma_f32_16x16x32_bf16 a[24:27], a[248:251], a[140:143], a[24:27]
    v_mfma_f32_16x16x32_bf16 a[20:23], a[252:255], a[136:139], a[20:23]
    ds_read_b128 a[244:247], v11 offset:20480
    v_mfma_f32_16x16x32_bf16 a[28:31], a[252:255], a[140:143], a[28:31]
    s_waitcnt lgkmcnt(5)
    v_mfma_f32_16x16x32_bf16 v[48:51], a[224:227], a[32:35], v[48:51]
    ds_read_b128 a[248:251], v10 offset:22528
    v_mfma_f32_16x16x32_bf16 v[56:59], a[224:227], a[36:39], v[56:59]
    s_waitcnt lgkmcnt(3)
    v_cmp_ne_u32 vcc, 0, v1
    v_mfma_f32_16x16x32_bf16 v[48:51], a[228:231], a[40:43], v[48:51]
    ds_read_b128 a[252:255], v11 offset:22528
    v_mfma_f32_16x16x32_bf16 v[56:59], a[228:231], a[44:47], v[56:59]
    ds_write_b32 v2, v31
    v_mfma_f32_16x16x32_bf16 v[52:55], a[232:235], a[32:35], v[52:55]
    s_getpc_b64 s[62:63]
    s_cbranch_vccnz L_cslow
    v_mfma_f32_16x16x32_bf16 v[60:63], a[232:235], a[36:39], v[60:63]
    ds_read_b64_tr_b16 a[224:225], v14 offset:57344
    ds_read_b64_tr_b16 a[226:227], v14 offset:57856
    v_mfma_f32_16x16x32_bf16 v[52:55], a[236:239], a[40:43], v[52:55]
    ds_read_b64_tr_b16 a[228:229], v15 offset:57344
    ds_read_b64_tr_b16 a[230:231], v15 offset:57856
    v_mfma_f32_16x16x32_bf16 v[60:63], a[236:239], a[44:47], v[60:63]
    v_add_u32 v31, 4, v31
    s_waitcnt lgkmcnt(7)
    v_mfma_f32_16x16x32_bf16 v[176:179], a[240:243], a[32:35], v[176:179]
    ds_read_b64_tr_b16 a[232:233], v16 offset:57344
    v_mfma_f32_16x16x32_bf16 v[184:187], a[240:243], a[36:39], v[184:187]
    ds_read_b64_tr_b16 a[234:235], v16 offset:57856
    v_mfma_f32_16x16x32_bf16 v[176:179], a[244:247], a[40:43], v[176:179]
    ds_read_b64_tr_b16 a[236:237], v17 offset:57344
    v_mfma_f32_16x16x32_bf16 v[184:187], a[244:247], a[44:47], v[184:187]
    ds_read_b64_tr_b16 a[238:239], v17 offset:57856
    s_waitcnt lgkmcnt(9)
    v_mfma_f32_16x16x32_bf16 v[180:183], a[248:251], a[32:35], v[180:183]
    ds_read_b64_tr_b16 a[240:241], v14 offset:61440
    v_mfma_f32_16x16x32_bf16 v[188:191], a[248:251], a[36:39], v[188:191]
    ds_read_b64_tr_b16 a[242:243], v14 offset:61952
    v_mfma_f32_16x16x32_bf16 v[180:183], a[252:255], a[40:43], v[180:183]
    ds_read_b64_tr_b16 a[244:245], v15 offset:61440
    v_mfma_f32_16x16x32_bf16 v[188:191], a[252:255], a[44:47], v[188:191]
    ds_read_b64_tr_b16 a[246:247], v15 offset:61952
    s_waitcnt lgkmcnt(8)
    v_mfma_f32_16x16x32_bf16 a[0:3], a[224:227], a[144:147], a[0:3]
    ds_read_b64_tr_b16 a[248:249], v16 offset:61440
    v_mfma_f32_16x16x32_bf16 a[8:11], a[224:227], a[148:151], a[8:11]
    ds_read_b64_tr_b16 a[250:251], v16 offset:61952
    v_mfma_f32_16x16x32_bf16 a[4:7], a[228:231], a[144:147], a[4:7]
    ds_read_b64_tr_b16 a[252:253], v17 offset:61440
    v_mfma_f32_16x16x32_bf16 a[12:15], a[228:231], a[148:151], a[12:15]
    ds_read_b64_tr_b16 a[254:255], v17 offset:61952
    s_waitcnt lgkmcnt(8)
    v_mfma_f32_16x16x32_bf16 a[16:19], a[232:235], a[144:147], a[16:19]
    ds_read_b128 a[224:227], v8 offset:8192
    v_mfma_f32_16x16x32_bf16 a[24:27], a[232:235], a[148:151], a[24:27]
    v_mfma_f32_16x16x32_bf16 a[20:23], a[236:239], a[144:147], a[20:23]
    ds_read_b128 a[228:231], v9 offset:8192
    v_mfma_f32_16x16x32_bf16 a[28:31], a[236:239], a[148:151], a[28:31]
    s_waitcnt lgkmcnt(6)
    v_mfma_f32_16x16x32_bf16 a[0:3], a[240:243], a[152:155], a[0:3]
    ds_read_b128 a[232:235], v8 offset:10240
    v_mfma_f32_16x16x32_bf16 a[8:11], a[240:243], a[156:159], a[8:11]
    v_mfma_f32_16x16x32_bf16 a[4:7], a[244:247], a[152:155], a[4:7]
    ds_read_b128 a[236:239], v9 offset:10240
    v_mfma_f32_16x16x32_bf16 a[12:15], a[244:247], a[156:159], a[12:15]
    ds_read_b32 v1, v31 offset:4
    s_waitcnt lgkmcnt(5)
    v_mfma_f32_16x16x32_bf16 a[16:19], a[248:251], a[152:155], a[16:19]
    ds_read_b128 a[240:243], v8 offset:12288
    v_mfma_f32_16x16x32_bf16 a[24:27], a[248:251], a[156:159], a[24:27]
    v_mfma_f32_16x16x32_bf16 a[20:23], a[252:255], a[152:155], a[20:23]
    ds_read_b128 a[244:247], v9 offset:12288
    v_mfma_f32_16x16x32_bf16 a[28:31], a[252:255], a[156:159], a[28:31]
    s_waitcnt lgkmcnt(5)
    v_mfma_f32_16x16x32_bf16 v[64:67], a[224:227], a[32:35], v[64:67]
    ds_read_b128 a[248:251], v8 offset:14336
    v_mfma_f32_16x16x32_bf16 v[72:75], a[224:227], a[36:39], v[72:75]
    s_waitcnt lgkmcnt(3)
    v_cmp_ne_u32 vcc, 0, v1
    v_mfma_f32_16x16x32_bf16 v[64:67], a[228:231], a[40:43], v[64:67]
    ds_read_b128 a[252:255], v9 offset:14336
    v_mfma_f32_16x16x32_bf16 v[72:75], a[228:231], a[44:47], v[72:75]
    ds_write_b32 v2, v31
    v_mfma_f32_16x16x32_bf16 v[68:71], a[232:235], a[32:35], v[68:71]
    s_getpc_b64 s[62:63]
    s_cbranch_vccnz L_cslow
    v_mfma_f32_16x16x32_bf16 v[76:79], a[232:235], a[36:39], v[76:79]
    ds_read_b64_tr_b16 a[224:225], v14 offset:0
    ds_read_b64_tr_b16 a[226:227], v14 offset:512
    v_mfma_f32_16x16x32_bf16 v[68:71], a[236:239], a[40:43], v[68:71]
    ds_read_b64_tr_b16 a[228:229], v15 offset:0
    ds_read_b64_tr_b16 a[230:231], v15 offset:512
    v_mfma_f32_16x16x32_bf16 v[76:79], a[236:239], a[44:47], v[76:79]
    v_add_u32 v31, 4, v31
    s_waitcnt lgkmcnt(7)
    v_mfma_f32_16x16x32_bf16 v[192:195], a[240:243], a[32:35], v[192:195]
    ds_read_b64_tr_b16 a[232:233], v16 offset:0
    v_mfma_f32_16x16x32_bf16 v[200:203], a[240:243], a[36:39], v[200:203]
    ds_read_b64_tr_b16 a[234:235], v16 offset:512
    v_mfma_f32_16x16x32_bf16 v[192:195], a[244:247], a[40:43], v[192:195]
    ds_read_b64_tr_b16 a[236:237], v17 offset:0
    v_mfma_f32_16x16x32_bf16 v[200:203], a[244:247], a[44:47], v[200:203]
    ds_read_b64_tr_b16 a[238:239], v17 offset:512
    s_waitcnt lgkmcnt(9)
    v_mfma_f32_16x16x32_bf16 v[196:199], a[248:251], a[32:35], v[196:199]
    ds_read_b64_tr_b16 a[240:241], v14 offset:4096
    v_mfma_f32_16x16x32_bf16 v[204:207], a[248:251], a[36:39], v[204:207]
    ds_read_b64_tr_b16 a[242:243], v14 offset:4608
    v_mfma_f32_16x16x32_bf16 v[196:199], a[252:255], a[40:43], v[196:199]
    ds_read_b64_tr_b16 a[244:245], v15 offset:4096
    v_mfma_f32_16x16x32_bf16 v[204:207], a[252:255], a[44:47], v[204:207]
    ds_read_b64_tr_b16 a[246:247], v15 offset:4608
    s_waitcnt lgkmcnt(8)
    v_mfma_f32_16x16x32_bf16 a[0:3], a[224:227], a[160:163], a[0:3]
    ds_read_b64_tr_b16 a[248:249], v16 offset:4096
    v_mfma_f32_16x16x32_bf16 a[8:11], a[224:227], a[164:167], a[8:11]
    ds_read_b64_tr_b16 a[250:251], v16 offset:4608
    v_mfma_f32_16x16x32_bf16 a[4:7], a[228:231], a[160:163], a[4:7]
    ds_read_b64_tr_b16 a[252:253], v17 offset:4096
    v_mfma_f32_16x16x32_bf16 a[12:15], a[228:231], a[164:167], a[12:15]
    ds_read_b64_tr_b16 a[254:255], v17 offset:4608
    s_waitcnt lgkmcnt(8)
    v_mfma_f32_16x16x32_bf16 a[16:19], a[232:235], a[160:163], a[16:19]
    ds_read_b128 a[224:227], v12 offset:8192
    v_mfma_f32_16x16x32_bf16 a[24:27], a[232:235], a[164:167], a[24:27]
    v_mfma_f32_16x16x32_bf16 a[20:23], a[236:239], a[160:163], a[20:23]
    ds_read_b128 a[228:231], v13 offset:8192
    v_mfma_f32_16x16x32_bf16 a[28:31], a[236:239], a[164:167], a[28:31]
    s_waitcnt lgkmcnt(6)
    v_mfma_f32_16x16x32_bf16 a[0:3], a[240:243], a[168:171], a[0:3]
    ds_read_b128 a[232:235], v12 offset:10240
    v_mfma_f32_16x16x32_bf16 a[8:11], a[240:243], a[172:175], a[8:11]
    v_mfma_f32_16x16x32_bf16 a[4:7], a[244:247], a[168:171], a[4:7]
    ds_read_b128 a[236:239], v13 offset:10240
    v_mfma_f32_16x16x32_bf16 a[12:15], a[244:247], a[172:175], a[12:15]
    ds_read_b32 v1, v31 offset:4
    s_waitcnt lgkmcnt(5)
    v_mfma_f32_16x16x32_bf16 a[16:19], a[248:251], a[168:171], a[16:19]
    ds_read_b128 a[240:243], v12 offset:12288
    v_mfma_f32_16x16x32_bf16 a[24:27], a[248:251], a[172:175], a[24:27]
    v_mfma_f32_16x16x32_bf16 a[20:23], a[252:255], a[168:171], a[20:23]
    ds_read_b128 a[244:247], v13 offset:12288
    v_mfma_f32_16x16x32_bf16 a[28:31], a[252:255], a[172:175], a[28:31]
    s_waitcnt lgkmcnt(5)
    v_mfma_f32_16x16x32_bf16 v[80:83], a[224:227], a[32:35], v[80:83]
    ds_read_b128 a[248:251], v12 offset:14336
    v_mfma_f32_16x16x32_bf16 v[88:91], a[224:227], a[36:39], v[88:91]
    s_waitcnt lgkmcnt(3)
    v_cmp_ne_u32 vcc, 0, v1
    v_mfma_f32_16x16x32_bf16 v[80:83], a[228:231], a[40:43], v[80:83]
    ds_read_b128 a[252:255], v13 offset:14336
    v_mfma_f32_16x16x32_bf16 v[88:91], a[228:231], a[44:47], v[88:91]
    ds_write_b32 v2, v31
    v_mfma_f32_16x16x32_bf16 v[84:87], a[232:235], a[32:35], v[84:87]
    s_getpc_b64 s[62:63]
    s_cbranch_vccnz L_cslow
    v_mfma_f32_16x16x32_bf16 v[92:95], a[232:235], a[36:39], v[92:95]
    ds_read_b64_tr_b16 a[224:225], v18 offset:0
    ds_read_b64_tr_b16 a[226:227], v18 offset:512
    v_mfma_f32_16x16x32_bf16 v[84:87], a[236:239], a[40:43], v[84:87]
    ds_read_b64_tr_b16 a[228:229], v19 offset:0
    ds_read_b64_tr_b16 a[230:231], v19 offset:512
    v_mfma_f32_16x16x32_bf16 v[92:95], a[236:239], a[44:47], v[92:95]
    v_add_u32 v31, 4, v31
    s_waitcnt lgkmcnt(7)
    v_mfma_f32_16x16x32_bf16 v[208:211], a[240:243], a[32:35], v[208:211]
    ds_read_b64_tr_b16 a[232:233], v20 offset:0
    v_mfma_f32_16x16x32_bf16 v[216:219], a[240:243], a[36:39], v[216:219]
    ds_read_b64_tr_b16 a[234:235], v20 offset:512
    v_mfma_f32_16x16x32_bf16 v[208:211], a[244:247], a[40:43], v[208:211]
    ds_read_b64_tr_b16 a[236:237], v21 offset:0
    v_mfma_f32_16x16x32_bf16 v[216:219], a[244:247], a[44:47], v[216:219]
    ds_read_b64_tr_b16 a[238:239], v21 offset:512
    s_waitcnt lgkmcnt(9)
    v_mfma_f32_16x16x32_bf16 v[212:215], a[248:251], a[32:35], v[212:215]
    ds_read_b64_tr_b16 a[240:241], v18 offset:4096
    v_mfma_f32_16x16x32_bf16 v[220:223], a[248:251], a[36:39], v[220:223]
    ds_read_b64_tr_b16 a[242:243], v18 offset:4608
    v_mfma_f32_16x16x32_bf16 v[212:215], a[252:255], a[40:43], v[212:215]
    ds_read_b64_tr_b16 a[244:245], v19 offset:4096
    v_mfma_f32_16x16x32_bf16 v[220:223], a[252:255], a[44:47], v[220:223]
    ds_read_b64_tr_b16 a[246:247], v19 offset:4608
    s_waitcnt lgkmcnt(8)
    v_mfma_f32_16x16x32_bf16 a[0:3], a[224:227], a[176:179], a[0:3]
    ds_read_b64_tr_b16 a[248:249], v20 offset:4096
    v_mfma_f32_16x16x32_bf16 a[8:11], a[224:227], a[180:183], a[8:11]
    ds_read_b64_tr_b16 a[250:251], v20 offset:4608
    v_mfma_f32_16x16x32_bf16 a[4:7], a[228:231], a[176:179], a[4:7]
    ds_read_b64_tr_b16 a[252:253], v21 offset:4096
    v_mfma_f32_16x16x32_bf16 a[12:15], a[228:231], a[180:183], a[12:15]
    ds_read_b64_tr_b16 a[254:255], v21 offset:4608
    s_waitcnt lgkmcnt(8)
    v_mfma_f32_16x16x32_bf16 a[16:19], a[232:235], a[176:179], a[16:19]
    ds_read_b128 a[224:227], v8 offset:24576
    v_mfma_f32_16x16x32_bf16 a[24:27], a[232:235], a[180:183], a[24:27]
    v_mfma_f32_16x16x32_bf16 a[20:23], a[236:239], a[176:179], a[20:23]
    ds_read_b128 a[228:231], v9 offset:24576
    v_mfma_f32_16x16x32_bf16 a[28:31], a[236:239], a[180:183], a[28:31]
    s_waitcnt lgkmcnt(6)
    v_mfma_f32_16x16x32_bf16 a[0:3], a[240:243], a[184:187], a[0:3]
    ds_read_b128 a[232:235], v8 offset:26624
    v_mfma_f32_16x16x32_bf16 a[8:11], a[240:243], a[188:191], a[8:11]
    v_mfma_f32_16x16x32_bf16 a[4:7], a[244:247], a[184:187], a[4:7]
    ds_read_b128 a[236:239], v9 offset:26624
    v_mfma_f32_16x16x32_bf16 a[12:15], a[244:247], a[188:191], a[12:15]
    ds_read_b32 v1, v31 offset:4
    s_waitcnt lgkmcnt(5)
    v_mfma_f32_16x16x32_bf16 a[16:19], a[248:251], a[184:187], a[16:19]
    ds_read_b128 a[240:243], v8 offset:28672
    v_mfma_f32_16x16x32_bf16 a[24:27], a[248:251], a[188:191], a[24:27]
    v_mfma_f32_16x16x32_bf16 a[20:23], a[252:255], a[184:187], a[20:23]
    ds_read_b128 a[244:247], v9 offset:28672
    v_mfma_f32_16x16x32_bf16 a[28:31], a[252:255], a[188:191], a[28:31]
    s_waitcnt lgkmcnt(5)
    v_mfma_f32_16x16x32_bf16 v[96:99], a[224:227], a[32:35], v[96:99]
    ds_read_b128 a[248:251], v8 offset:30720
    v_mfma_f32_16x16x32_bf16 v[104:107], a[224:227], a[36:39], v[104:107]
    s_waitcnt lgkmcnt(3)
    v_cmp_ne_u32 vcc, 0, v1
    v_mfma_f32_16x16x32_bf16 v[96:99], a[228:231], a[40:43], v[96:99]
    ds_read_b128 a[252:255], v9 offset:30720
    v_mfma_f32_16x16x32_bf16 v[104:107], a[228:231], a[44:47], v[104:107]
    ds_write_b32 v2, v31
    v_mfma_f32_16x16x32_bf16 v[100:103], a[232:235], a[32:35], v[100:103]
    s_getpc_b64 s[62:63]
    s_cbranch_vccnz L_cslow
    v_mfma_f32_16x16x32_bf16 v[108:111], a[232:235], a[36:39], v[108:111]
    ds_read_b64_tr_b16 a[224:225], v14 offset:16384
    ds_read_b64_tr_b16 a[226:227], v14 offset:16896
    v_mfma_f32_16x16x32_bf16 v[100:103], a[236:239], a[40:43], v[100:103]
    ds_read_b64_tr_b16 a[228:229], v15 offset:16384
    ds_read_b64_tr_b16 a[230:231], v15 offset:16896
    v_mfma_f32_16x16x32_bf16 v[108:111], a[236:239], a[44:47], v[108:111]
    v_add_u32 v31, 4, v31
    s_waitcnt lgkmcnt(7)
    v_mfma_f32_16x16x32_bf16 v[224:227], a[240:243], a[32:35], v[224:227]
    ds_read_b64_tr_b16 a[232:233], v16 offset:16384
    v_mfma_f32_16x16x32_bf16 v[232:235], a[240:243], a[36:39], v[232:235]
    ds_read_b64_tr_b16 a[234:235], v16 offset:16896
    v_mfma_f32_16x16x32_bf16 v[224:227], a[244:247], a[40:43], v[224:227]
    ds_read_b64_tr_b16 a[236:237], v17 offset:16384
    v_mfma_f32_16x16x32_bf16 v[232:235], a[244:247], a[44:47], v[232:235]
    ds_read_b64_tr_b16 a[238:239], v17 offset:16896
    s_waitcnt lgkmcnt(9)
    v_mfma_f32_16x16x32_bf16 v[228:231], a[248:251], a[32:35], v[228:231]
    ds_read_b64_tr_b16 a[240:241], v14 offset:20480
    v_mfma_f32_16x16x32_bf16 v[236:239], a[248:251], a[36:39], v[236:239]
    ds_read_b64_tr_b16 a[242:243], v14 offset:20992
    v_mfma_f32_16x16x32_bf16 v[228:231], a[252:255], a[40:43], v[228:231]
    ds_read_b64_tr_b16 a[244:245], v15 offset:20480
    v_mfma_f32_16x16x32_bf16 v[236:239], a[252:255], a[44:47], v[236:239]
    ds_read_b64_tr_b16 a[246:247], v15 offset:20992
    s_waitcnt lgkmcnt(8)
    v_mfma_f32_16x16x32_bf16 a[0:3], a[224:227], a[192:195], a[0:3]
    ds_read_b64_tr_b16 a[248:249], v16 offset:20480
    v_mfma_f32_16x16x32_bf16 a[8:11], a[224:227], a[196:199], a[8:11]
    ds_read_b64_tr_b16 a[250:251], v16 offset:20992
    v_mfma_f32_16x16x32_bf16 a[4:7], a[228:231], a[192:195], a[4:7]
    ds_read_b64_tr_b16 a[252:253], v17 offset:20480
    v_mfma_f32_16x16x32_bf16 a[12:15], a[228:231], a[196:199], a[12:15]
    ds_read_b64_tr_b16 a[254:255], v17 offset:20992
    s_waitcnt lgkmcnt(8)
    v_mfma_f32_16x16x32_bf16 a[16:19], a[232:235], a[192:195], a[16:19]
    ds_read_b128 a[224:227], v10 offset:49152
    v_mfma_f32_16x16x32_bf16 a[24:27], a[232:235], a[196:199], a[24:27]
    v_mfma_f32_16x16x32_bf16 a[20:23], a[236:239], a[192:195], a[20:23]
    ds_read_b128 a[228:231], v11 offset:49152
    v_mfma_f32_16x16x32_bf16 a[28:31], a[236:239], a[196:199], a[28:31]
    s_waitcnt lgkmcnt(6)
    v_mfma_f32_16x16x32_bf16 a[0:3], a[240:243], a[200:203], a[0:3]
    ds_read_b128 a[232:235], v10 offset:51200
    v_mfma_f32_16x16x32_bf16 a[8:11], a[240:243], a[204:207], a[8:11]
    v_mfma_f32_16x16x32_bf16 a[4:7], a[244:247], a[200:203], a[4:7]
    ds_read_b128 a[236:239], v11 offset:51200
    v_mfma_f32_16x16x32_bf16 a[12:15], a[244:247], a[204:207], a[12:15]
    ds_read_b32 v1, v31 offset:4
    s_waitcnt lgkmcnt(5)
    v_mfma_f32_16x16x32_bf16 a[16:19], a[248:251], a[200:203], a[16:19]
    ds_read_b128 a[240:243], v10 offset:53248
    v_mfma_f32_16x16x32_bf16 a[24:27], a[248:251], a[204:207], a[24:27]
    v_mfma_f32_16x16x32_bf16 a[20:23], a[252:255], a[200:203], a[20:23]
    ds_read_b128 a[244:247], v11 offset:53248
    v_mfma_f32_16x16x32_bf16 a[28:31], a[252:255], a[204:207], a[28:31]
    s_waitcnt lgkmcnt(5)
    v_mfma_f32_16x16x32_bf16 v[112:115], a[224:227], a[32:35], v[112:115]
    ds_read_b128 a[248:251], v10 offset:55296
    v_mfma_f32_16x16x32_bf16 v[120:123], a[224:227], a[36:39], v[120:123]
    s_waitcnt lgkmcnt(3)
    v_cmp_ne_u32 vcc, 0, v1
    v_mfma_f32_16x16x32_bf16 v[112:115], a[228:231], a[40:43], v[112:115]
    ds_read_b128 a[252:255], v11 offset:55296
    v_mfma_f32_16x16x32_bf16 v[120:123], a[228:231], a[44:47], v[120:123]
    ds_write_b32 v2, v31
    v_mfma_f32_16x16x32_bf16 v[116:119], a[232:235], a[32:35], v[116:119]
    s_getpc_b64 s[62:63]
    s_cbranch_vccnz L_cslow
    v_mfma_f32_16x16x32_bf16 v[124:127], a[232:235], a[36:39], v[124:127]
    ds_read_b64_tr_b16 a[224:225], v22 offset:16384
    ds_read_b64_tr_b16 a[226:227], v22 offset:16896
    v_mfma_f32_16x16x32_bf16 v[116:119], a[236:239], a[40:43], v[116:119]
    ds_read_b64_tr_b16 a[228:229], v23 offset:16384
    ds_read_b64_tr_b16 a[230:231], v23 offset:16896
    v_mfma_f32_16x16x32_bf16 v[124:127], a[236:239], a[44:47], v[124:127]
    v_add_u32 v31, 4, v31
    s_waitcnt lgkmcnt(7)
    v_mfma_f32_16x16x32_bf16 v[240:243], a[240:243], a[32:35], v[240:243]
    ds_read_b64_tr_b16 a[232:233], v22 offset:20480
    v_mfma_f32_16x16x32_bf16 v[248:251], a[240:243], a[36:39], v[248:251]
    ds_read_b64_tr_b16 a[234:235], v22 offset:20992
    v_mfma_f32_16x16x32_bf16 v[240:243], a[244:247], a[40:43], v[240:243]
    ds_read_b64_tr_b16 a[236:237], v23 offset:20480
    v_mfma_f32_16x16x32_bf16 v[248:251], a[244:247], a[44:47], v[248:251]
    ds_read_b64_tr_b16 a[238:239], v23 offset:20992
    s_waitcnt lgkmcnt(9)
    v_mfma_f32_16x16x32_bf16 v[244:247], a[248:251], a[32:35], v[244:247]
    ds_read_b64_tr_b16 a[240:241], v24 offset:16384
    v_mfma_f32_16x16x32_bf16 v[252:255], a[248:251], a[36:39], v[252:255]
    ds_read_b64_tr_b16 a[242:243], v24 offset:16896
    v_mfma_f32_16x16x32_bf16 v[244:247], a[252:255], a[40:43], v[244:247]
    ds_read_b64_tr_b16 a[244:245], v25 offset:16384
    v_mfma_f32_16x16x32_bf16 v[252:255], a[252:255], a[44:47], v[252:255]
    ds_read_b64_tr_b16 a[246:247], v25 offset:16896
    s_waitcnt lgkmcnt(8)
    v_mfma_f32_16x16x32_bf16 a[0:3], a[224:227], a[208:211], a[0:3]
    ds_read_b64_tr_b16 a[248:249], v24 offset:20480
    v_mfma_f32_16x16x32_bf16 a[8:11], a[224:227], a[212:215], a[8:11]
    ds_read_b64_tr_b16 a[250:251], v24 offset:20992
    v_mfma_f32_16x16x32_bf16 a[4:7], a[228:231], a[208:211], a[4:7]
    ds_read_b64_tr_b16 a[252:253], v25 offset:20480
    v_mfma_f32_16x16x32_bf16 a[12:15], a[228:231], a[212:215], a[12:15]
    ds_read_b64_tr_b16 a[254:255], v25 offset:20992
    s_waitcnt lgkmcnt(8)
    v_mfma_f32_16x16x32_bf16 a[0:3], a[232:235], a[216:219], a[0:3]
    ds_read_b128 a[224:227], v8 offset:32768
    v_mfma_f32_16x16x32_bf16 a[8:11], a[232:235], a[220:223], a[8:11]
    v_mfma_f32_16x16x32_bf16 a[4:7], a[236:239], a[216:219], a[4:7]
    ds_read_b128 a[228:231], v9 offset:32768
    v_mfma_f32_16x16x32_bf16 a[12:15], a[236:239], a[220:223], a[12:15]
    s_waitcnt lgkmcnt(6)
    v_mfma_f32_16x16x32_bf16 a[16:19], a[240:243], a[208:211], a[16:19]
    ds_read_b128 a[232:235], v8 offset:34816
    v_mfma_f32_16x16x32_bf16 a[24:27], a[240:243], a[212:215], a[24:27]
    v_mfma_f32_16x16x32_bf16 a[20:23], a[244:247], a[208:211], a[20:23]
    ds_read_b128 a[236:239], v9 offset:34816
    v_accvgpr_read_b32 v3, a0
    v_accvgpr_read_b32 v4, a1
    v_mfma_f32_16x16x32_bf16 a[28:31], a[244:247], a[212:215], a[28:31]
    ds_read_b32 v1, v31 offset:4
    v_accvgpr_read_b32 v5, a2
    s_waitcnt lgkmcnt(5)
    v_mfma_f32_16x16x32_bf16 a[16:19], a[248:251], a[216:219], a[16:19]
    ds_read_b128 a[240:243], v8 offset:36864
    v_accvgpr_read_b32 v6, a3
    v_accvgpr_read_b32 v7, a4
    v_mfma_f32_16x16x32_bf16 a[24:27], a[248:251], a[220:223], a[24:27]
    v_accvgpr_read_b32 v26, a5
    v_accvgpr_read_b32 v27, a6
    v_mfma_f32_16x16x32_bf16 a[20:23], a[252:255], a[216:219], a[20:23]
    ds_read_b128 a[244:247], v9 offset:36864
    v_accvgpr_read_b32 v28, a7
    v_cvt_pk_bf16_f32 v3, v3, v4
    v_mfma_f32_16x16x32_bf16 a[28:31], a[252:255], a[220:223], a[28:31]
    v_cvt_pk_bf16_f32 v7, v7, v26
    v_cvt_pk_bf16_f32 v5, v5, v6
    s_waitcnt lgkmcnt(5)
    v_mfma_f32_16x16x32_bf16 v[128:131], a[224:227], a[32:35], v[128:131]
    ds_read_b128 a[248:251], v8 offset:38912
    v_cvt_pk_bf16_f32 v27, v27, v28
    v_permlane16_swap_b32 v3, v7
    v_mfma_f32_16x16x32_bf16 v[136:139], a[224:227], a[36:39], v[136:139]
    s_waitcnt lgkmcnt(3)
    v_cmp_ne_u32 vcc, 0, v1
    v_permlane16_swap_b32 v5, v27
    v_mfma_f32_16x16x32_bf16 v[128:131], a[228:231], a[40:43], v[128:131]
    ds_read_b128 a[252:255], v9 offset:38912
    v_accvgpr_write_b32 a0, v3
    v_accvgpr_write_b32 a2, v7
    v_mfma_f32_16x16x32_bf16 v[136:139], a[228:231], a[44:47], v[136:139]
    ds_write_b32 v2, v31
    v_accvgpr_write_b32 a1, v5
    v_mfma_f32_16x16x32_bf16 v[132:135], a[232:235], a[32:35], v[132:135]
    s_getpc_b64 s[62:63]
    s_cbranch_vccnz L_cslow
    v_accvgpr_write_b32 a3, v27
    v_mfma_f32_16x16x32_bf16 v[140:143], a[232:235], a[36:39], v[140:143]
    ds_read_b128 a[224:227], v8 offset:40960
    v_accvgpr_read_b32 v3, a8
    v_accvgpr_read_b32 v4, a9
    v_mfma_f32_16x16x32_bf16 v[132:135], a[236:239], a[40:43], v[132:135]
    ds_read_b128 a[228:231], v9 offset:40960
    v_accvgpr_read_b32 v5, a10
    v_accvgpr_read_b32 v6, a11
    v_mfma_f32_16x16x32_bf16 v[140:143], a[236:239], a[44:47], v[140:143]
    v_add_u32 v31, 4, v31
    v_accvgpr_read_b32 v7, a12
    s_waitcnt lgkmcnt(5)
    v_mfma_f32_16x16x32_bf16 a[64:67], a[240:243], a[32:35], a[64:67]
    ds_read_b128 a[232:235], v8 offset:43008
    v_accvgpr_read_b32 v26, a13
    v_accvgpr_read_b32 v27, a14
    v_mfma_f32_16x16x32_bf16 a[72:75], a[240:243], a[36:39], a[72:75]
    v_accvgpr_read_b32 v28, a15
    v_cvt_pk_bf16_f32 v3, v3, v4
    v_mfma_f32_16x16x32_bf16 a[64:67], a[244:247], a[40:43], a[64:67]
    ds_read_b128 a[236:239], v9 offset:43008
    v_cvt_pk_bf16_f32 v7, v7, v26
    v_cvt_pk_bf16_f32 v5, v5, v6
    v_mfma_f32_16x16x32_bf16 a[72:75], a[244:247], a[44:47], a[72:75]
    v_cvt_pk_bf16_f32 v27, v27, v28
    v_permlane16_swap_b32 v3, v7
    s_waitcnt lgkmcnt(5)
    v_mfma_f32_16x16x32_bf16 a[68:71], a[248:251], a[32:35], a[68:71]
    ds_read_b128 a[240:243], v8 offset:45056
    v_permlane16_swap_b32 v5, v27
    v_accvgpr_write_b32 a4, v3
    v_mfma_f32_16x16x32_bf16 a[76:79], a[248:251], a[36:39], a[76:79]
    v_accvgpr_write_b32 a6, v7
    v_accvgpr_write_b32 a5, v5
    v_mfma_f32_16x16x32_bf16 a[68:71], a[252:255], a[40:43], a[68:71]
    ds_read_b128 a[244:247], v9 offset:45056
    v_accvgpr_write_b32 a7, v27
    v_accvgpr_read_b32 v3, a16
    v_mfma_f32_16x16x32_bf16 a[76:79], a[252:255], a[44:47], a[76:79]
    v_accvgpr_read_b32 v4, a17
    v_accvgpr_read_b32 v5, a18
    s_waitcnt lgkmcnt(4)
    v_mfma_f32_16x16x32_bf16 v[144:147], a[224:227], a[32:35], v[144:147]
    ds_read_b128 a[248:251], v8 offset:47104
    v_accvgpr_read_b32 v6, a19
    v_accvgpr_read_b32 v7, a20
    v_mfma_f32_16x16x32_bf16 v[152:155], a[224:227], a[36:39], v[152:155]
    v_accvgpr_read_b32 v26, a21
    v_accvgpr_read_b32 v27, a22
    v_mfma_f32_16x16x32_bf16 v[144:147], a[228:231], a[40:43], v[144:147]
    ds_read_b128 a[252:255], v9 offset:47104
    v_accvgpr_read_b32 v28, a23
    v_cvt_pk_bf16_f32 v3, v3, v4
    v_mfma_f32_16x16x32_bf16 v[152:155], a[228:231], a[44:47], v[152:155]
    v_cvt_pk_bf16_f32 v7, v7, v26
    v_cvt_pk_bf16_f32 v5, v5, v6
    s_waitcnt lgkmcnt(4)
    v_mfma_f32_16x16x32_bf16 v[148:151], a[232:235], a[32:35], v[148:151]
    ds_read_b64_tr_b16 a[224:225], v18 offset:57344
    v_cvt_pk_bf16_f32 v27, v27, v28
    v_permlane16_swap_b32 v3, v7
    v_mfma_f32_16x16x32_bf16 v[156:159], a[232:235], a[36:39], v[156:159]
    ds_read_b64_tr_b16 a[226:227], v18 offset:57856
    v_permlane16_swap_b32 v5, v27
    v_accvgpr_write_b32 a8, v3
    v_mfma_f32_16x16x32_bf16 v[148:151], a[236:239], a[40:43], v[148:151]
    ds_read_b64_tr_b16 a[228:229], v19 offset:57344
    v_accvgpr_write_b32 a10, v7
    v_accvgpr_write_b32 a9, v5
    v_mfma_f32_16x16x32_bf16 v[156:159], a[236:239], a[44:47], v[156:159]
    ds_read_b64_tr_b16 a[230:231], v19 offset:57856
    v_accvgpr_write_b32 a11, v27
    s_waitcnt lgkmcnt(6)
    v_mfma_f32_16x16x32_bf16 a[80:83], a[240:243], a[32:35], a[80:83]
    ds_read_b64_tr_b16 a[232:233], v20 offset:57344
    v_accvgpr_read_b32 v3, a24
    v_accvgpr_read_b32 v4, a25
    v_mfma_f32_16x16x32_bf16 a[88:91], a[240:243], a[36:39], a[88:91]
    ds_read_b64_tr_b16 a[234:235], v20 offset:57856
    v_accvgpr_read_b32 v5, a26
    v_accvgpr_read_b32 v6, a27
    v_mfma_f32_16x16x32_bf16 a[80:83], a[244:247], a[40:43], a[80:83]
    ds_read_b64_tr_b16 a[236:237], v21 offset:57344
    ds_read_b64_tr_b16 a[238:239], v21 offset:57856
    v_accvgpr_read_b32 v7, a28
    v_mfma_f32_16x16x32_bf16 a[88:91], a[244:247], a[44:47], a[88:91]
    ds_read_b32 v1, v31 offset:4
    v_accvgpr_read_b32 v26, a29
    s_waitcnt lgkmcnt(9)
    v_mfma_f32_16x16x32_bf16 a[84:87], a[248:251], a[32:35], a[84:87]
    ds_read_b64_tr_b16 a[240:241], v18 offset:61440
    v_accvgpr_read_b32 v27, a30
    v_accvgpr_read_b32 v28, a31
    v_mfma_f32_16x16x32_bf16 a[92:95], a[248:251], a[36:39], a[92:95]
    ds_read_b64_tr_b16 a[242:243], v18 offset:61952
    v_cvt_pk_bf16_f32 v3, v3, v4
    v_cvt_pk_bf16_f32 v7, v7, v26
    v_mfma_f32_16x16x32_bf16 a[84:87], a[252:255], a[40:43], a[84:87]
    ds_read_b64_tr_b16 a[244:245], v19 offset:61440
    v_cvt_pk_bf16_f32 v5, v5, v6
    v_cvt_pk_bf16_f32 v27, v27, v28
    v_mfma_f32_16x16x32_bf16 a[92:95], a[252:255], a[44:47], a[92:95]
    ds_read_b64_tr_b16 a[246:247], v19 offset:61952
    v_permlane16_swap_b32 v3, v7
    s_waitcnt lgkmcnt(9)
    v_mfma_f32_16x16x32_bf16 a[32:35], a[224:227], a[112:115], 0
    ds_read_b64_tr_b16 a[248:249], v20 offset:61440
    v_permlane16_swap_b32 v5, v27
    v_accvgpr_write_b32 a12, v3
    v_mfma_f32_16x16x32_bf16 a[40:43], a[224:227], a[116:119], 0
    ds_read_b64_tr_b16 a[250:251], v20 offset:61952
    s_waitcnt lgkmcnt(6)
    v_cmp_ne_u32 vcc, 0, v1
    v_accvgpr_write_b32 a14, v7
    v_mfma_f32_16x16x32_bf16 a[36:39], a[228:231], a[112:115], 0
    ds_read_b64_tr_b16 a[252:253], v21 offset:61440
    ds_read_b64_tr_b16 a[254:255], v21 offset:61952
    v_accvgpr_write_b32 a13, v5
    v_mfma_f32_16x16x32_bf16 a[44:47], a[228:231], a[116:119], 0
    ds_write_b32 v2, v31
    v_accvgpr_write_b32 a15, v27
    v_mfma_f32_16x16x32_bf16 a[48:51], a[232:235], a[112:115], 0
    s_getpc_b64 s[62:63]
    s_cbranch_vccnz L_cslow
    v_mfma_f32_16x16x32_bf16 a[56:59], a[232:235], a[116:119], 0
    ds_read_b128 a[224:227], v10 offset:8192
    v_mfma_f32_16x16x32_bf16 a[52:55], a[236:239], a[112:115], 0
    ds_read_b128 a[228:231], v11 offset:8192
    v_mfma_f32_16x16x32_bf16 a[60:63], a[236:239], a[116:119], 0
    v_add_u32 v31, 4, v31
    s_waitcnt lgkmcnt(7)
    v_mfma_f32_16x16x32_bf16 a[32:35], a[240:243], a[120:123], a[32:35]
    ds_read_b128 a[232:235], v10 offset:10240
    v_mfma_f32_16x16x32_bf16 a[40:43], a[240:243], a[124:127], a[40:43]
    v_mfma_f32_16x16x32_bf16 a[36:39], a[244:247], a[120:123], a[36:39]
    ds_read_b128 a[236:239], v11 offset:10240
    v_mfma_f32_16x16x32_bf16 a[44:47], a[244:247], a[124:127], a[44:47]
    s_waitcnt lgkmcnt(5)
    v_mfma_f32_16x16x32_bf16 a[48:51], a[248:251], a[120:123], a[48:51]
    ds_read_b128 a[240:243], v10 offset:12288
    v_mfma_f32_16x16x32_bf16 a[56:59], a[248:251], a[124:127], a[56:59]
    v_mfma_f32_16x16x32_bf16 a[52:55], a[252:255], a[120:123], a[52:55]
    ds_read_b128 a[244:247], v11 offset:12288
    v_mfma_f32_16x16x32_bf16 a[60:63], a[252:255], a[124:127], a[60:63]
    s_waitcnt lgkmcnt(4)
    v_mfma_f32_16x16x32_bf16 v[32:35], a[224:227], a[0:3], v[32:35]
    ds_read_b128 a[248:251], v10 offset:14336
    v_mfma_f32_16x16x32_bf16 v[40:43], a[224:227], a[4:7], v[40:43]
    v_mfma_f32_16x16x32_bf16 v[32:35], a[228:231], a[8:11], v[32:35]
    ds_read_b128 a[252:255], v11 offset:14336
    v_mfma_f32_16x16x32_bf16 v[40:43], a[228:231], a[12:15], v[40:43]
    s_waitcnt lgkmcnt(4)
    v_mfma_f32_16x16x32_bf16 v[36:39], a[232:235], a[0:3], v[36:39]
    ds_read_b64_tr_b16 a[224:225], v22 offset:0
    v_mfma_f32_16x16x32_bf16 v[44:47], a[232:235], a[4:7], v[44:47]
    ds_read_b64_tr_b16 a[226:227], v22 offset:512
    v_mfma_f32_16x16x32_bf16 v[36:39], a[236:239], a[8:11], v[36:39]
    ds_read_b64_tr_b16 a[228:229], v23 offset:0
    v_mfma_f32_16x16x32_bf16 v[44:47], a[236:239], a[12:15], v[44:47]
    ds_read_b64_tr_b16 a[230:231], v23 offset:512
    s_waitcnt lgkmcnt(6)
    v_mfma_f32_16x16x32_bf16 v[160:163], a[240:243], a[0:3], v[160:163]
    ds_read_b64_tr_b16 a[232:233], v24 offset:0
    v_mfma_f32_16x16x32_bf16 v[168:171], a[240:243], a[4:7], v[168:171]
    ds_read_b64_tr_b16 a[234:235], v24 offset:512
    v_mfma_f32_16x16x32_bf16 v[160:163], a[244:247], a[8:11], v[160:163]
    ds_read_b64_tr_b16 a[236:237], v25 offset:0
    ds_read_b64_tr_b16 a[238:239], v25 offset:512
    v_mfma_f32_16x16x32_bf16 v[168:171], a[244:247], a[12:15], v[168:171]
    ds_read_b32 v1, v31 offset:4
    s_waitcnt lgkmcnt(9)
    v_mfma_f32_16x16x32_bf16 v[164:167], a[248:251], a[0:3], v[164:167]
    ds_read_b64_tr_b16 a[240:241], v22 offset:4096
    v_mfma_f32_16x16x32_bf16 v[172:175], a[248:251], a[4:7], v[172:175]
    ds_read_b64_tr_b16 a[242:243], v22 offset:4608
    v_mfma_f32_16x16x32_bf16 v[164:167], a[252:255], a[8:11], v[164:167]
    ds_read_b64_tr_b16 a[244:245], v23 offset:4096
    v_mfma_f32_16x16x32_bf16 v[172:175], a[252:255], a[12:15], v[172:175]
    ds_read_b64_tr_b16 a[246:247], v23 offset:4608
    s_waitcnt lgkmcnt(9)
    v_mfma_f32_16x16x32_bf16 a[32:35], a[224:227], a[128:131], a[32:35]
    ds_read_b64_tr_b16 a[248:249], v24 offset:4096
    v_mfma_f32_16x16x32_bf16 a[40:43], a[224:227], a[132:135], a[40:43]
    ds_read_b64_tr_b16 a[250:251], v24 offset:4608
    s_waitcnt lgkmcnt(6)
    v_cmp_ne_u32 vcc, 0, v1
    v_mfma_f32_16x16x32_bf16 a[36:39], a[228:231], a[128:131], a[36:39]
    ds_read_b64_tr_b16 a[252:253], v25 offset:4096
    ds_read_b64_tr_b16 a[254:255], v25 offset:4608
    v_mfma_f32_16x16x32_bf16 a[44:47], a[228:231], a[132:135], a[44:47]
    ds_write_b32 v2, v31
    v_mfma_f32_16x16x32_bf16 a[48:51], a[232:235], a[128:131], a[48:51]
    s_getpc_b64 s[62:63]
    s_cbranch_vccnz L_cslow
    v_mfma_f32_16x16x32_bf16 a[56:59], a[232:235], a[132:135], a[56:59]
    ds_read_b128 a[224:227], v10 offset:24576
    v_mfma_f32_16x16x32_bf16 a[52:55], a[236:239], a[128:131], a[52:55]
    ds_read_b128 a[228:231], v11 offset:24576
    v_mfma_f32_16x16x32_bf16 a[60:63], a[236:239], a[132:135], a[60:63]
    v_add_u32 v31, 4, v31
    s_waitcnt lgkmcnt(7)
    v_mfma_f32_16x16x32_bf16 a[32:35], a[240:243], a[136:139], a[32:35]
    ds_read_b128 a[232:235], v10 offset:26624
    v_mfma_f32_16x16x32_bf16 a[40:43], a[240:243], a[140:143], a[40:43]
    v_mfma_f32_16x16x32_bf16 a[36:39], a[244:247], a[136:139], a[36:39]
    ds_read_b128 a[236:239], v11 offset:26624
    v_mfma_f32_16x16x32_bf16 a[44:47], a[244:247], a[140:143], a[44:47]
    s_waitcnt lgkmcnt(5)
    v_mfma_f32_16x16x32_bf16 a[48:51], a[248:251], a[136:139], a[48:51]
    ds_read_b128 a[240:243], v10 offset:28672
    v_mfma_f32_16x16x32_bf16 a[56:59], a[248:251], a[140:143], a[56:59]
    v_mfma_f32_16x16x32_bf16 a[52:55], a[252:255], a[136:139], a[52:55]
    ds_read_b128 a[244:247], v11 offset:28672
    v_mfma_f32_16x16x32_bf16 a[60:63], a[252:255], a[140:143], a[60:63]
    s_waitcnt lgkmcnt(4)
    v_mfma_f32_16x16x32_bf16 v[48:51], a[224:227], a[0:3], v[48:51]
    ds_read_b128 a[248:251], v10 offset:30720
    v_mfma_f32_16x16x32_bf16 v[56:59], a[224:227], a[4:7], v[56:59]
    v_mfma_f32_16x16x32_bf16 v[48:51], a[228:231], a[8:11], v[48:51]
    ds_read_b128 a[252:255], v11 offset:30720
    v_mfma_f32_16x16x32_bf16 v[56:59], a[228:231], a[12:15], v[56:59]
    s_waitcnt lgkmcnt(4)
    v_mfma_f32_16x16x32_bf16 v[52:55], a[232:235], a[0:3], v[52:55]
    ds_read_b64_tr_b16 a[224:225], v18 offset:32768
    v_mfma_f32_16x16x32_bf16 v[60:63], a[232:235], a[4:7], v[60:63]
    ds_read_b64_tr_b16 a[226:227], v18 offset:33280
    v_mfma_f32_16x16x32_bf16 v[52:55], a[236:239], a[8:11], v[52:55]
    ds_read_b64_tr_b16 a[228:229], v19 offset:32768
    v_mfma_f32_16x16x32_bf16 v[60:63], a[236:239], a[12:15], v[60:63]
    ds_read_b64_tr_b16 a[230:231], v19 offset:33280
    s_waitcnt lgkmcnt(6)
    v_mfma_f32_16x16x32_bf16 v[176:179], a[240:243], a[0:3], v[176:179]
    ds_read_b64_tr_b16 a[232:233], v20 offset:32768
    v_mfma_f32_16x16x32_bf16 v[184:187], a[240:243], a[4:7], v[184:187]
    ds_read_b64_tr_b16 a[234:235], v20 offset:33280
    v_mfma_f32_16x16x32_bf16 v[176:179], a[244:247], a[8:11], v[176:179]
    ds_read_b64_tr_b16 a[236:237], v21 offset:32768
    ds_read_b64_tr_b16 a[238:239], v21 offset:33280
    v_mfma_f32_16x16x32_bf16 v[184:187], a[244:247], a[12:15], v[184:187]
    ds_read_b32 v1, v31 offset:4
    s_waitcnt lgkmcnt(9)
    v_mfma_f32_16x16x32_bf16 v[180:183], a[248:251], a[0:3], v[180:183]
    ds_read_b64_tr_b16 a[240:241], v18 offset:36864
    v_mfma_f32_16x16x32_bf16 v[188:191], a[248:251], a[4:7], v[188:191]
    ds_read_b64_tr_b16 a[242:243], v18 offset:37376
    v_mfma_f32_16x16x32_bf16 v[180:183], a[252:255], a[8:11], v[180:183]
    ds_read_b64_tr_b16 a[244:245], v19 offset:36864
    v_mfma_f32_16x16x32_bf16 v[188:191], a[252:255], a[12:15], v[188:191]
    ds_read_b64_tr_b16 a[246:247], v19 offset:37376
    s_waitcnt lgkmcnt(9)
    v_mfma_f32_16x16x32_bf16 a[32:35], a[224:227], a[144:147], a[32:35]
    ds_read_b64_tr_b16 a[248:249], v20 offset:36864
    v_mfma_f32_16x16x32_bf16 a[40:43], a[224:227], a[148:151], a[40:43]
    ds_read_b64_tr_b16 a[250:251], v20 offset:37376
    s_waitcnt lgkmcnt(6)
    v_cmp_ne_u32 vcc, 0, v1
    v_mfma_f32_16x16x32_bf16 a[36:39], a[228:231], a[144:147], a[36:39]
    ds_read_b64_tr_b16 a[252:253], v21 offset:36864
    ds_read_b64_tr_b16 a[254:255], v21 offset:37376
    v_mfma_f32_16x16x32_bf16 a[44:47], a[228:231], a[148:151], a[44:47]
    ds_write_b32 v2, v31
    v_mfma_f32_16x16x32_bf16 a[48:51], a[232:235], a[144:147], a[48:51]
    s_getpc_b64 s[62:63]
    s_cbranch_vccnz L_cslow
    v_mfma_f32_16x16x32_bf16 a[56:59], a[232:235], a[148:151], a[56:59]
    ds_read_b128 a[224:227], v8 offset:8192
    v_mfma_f32_16x16x32_bf16 a[52:55], a[236:239], a[144:147], a[52:55]
    ds_read_b128 a[228:231], v9 offset:8192
    v_mfma_f32_16x16x32_bf16 a[60:63], a[236:239], a[148:151], a[60:63]
    v_add_u32 v31, 4, v31
    s_waitcnt lgkmcnt(7)
    v_mfma_f32_16x16x32_bf16 a[32:35], a[240:243], a[152:155], a[32:35]
    ds_read_b128 a[232:235], v8 offset:10240
    v_mfma_f32_16x16x32_bf16 a[40:43], a[240:243], a[156:159], a[40:43]
    v_mfma_f32_16x16x32_bf16 a[36:39], a[244:247], a[152:155], a[36:39]
    ds_read_b128 a[236:239], v9 offset:10240
    v_mfma_f32_16x16x32_bf16 a[44:47], a[244:247], a[156:159], a[44:47]
    s_waitcnt lgkmcnt(5)
    v_mfma_f32_16x16x32_bf16 a[48:51], a[248:251], a[152:155], a[48:51]
    ds_read_b128 a[240:243], v8 offset:12288
    v_mfma_f32_16x16x32_bf16 a[56:59], a[248:251], a[156:159], a[56:59]
    v_mfma_f32_16x16x32_bf16 a[52:55], a[252:255], a[152:155], a[52:55]
    ds_read_b128 a[244:247], v9 offset:12288
    v_mfma_f32_16x16x32_bf16 a[60:63], a[252:255], a[156:159], a[60:63]
    s_waitcnt lgkmcnt(4)
    v_mfma_f32_16x16x32_bf16 v[64:67], a[224:227], a[0:3], v[64:67]
    ds_read_b128 a[248:251], v8 offset:14336
    v_mfma_f32_16x16x32_bf16 v[72:75], a[224:227], a[4:7], v[72:75]
    v_mfma_f32_16x16x32_bf16 v[64:67], a[228:231], a[8:11], v[64:67]
    ds_read_b128 a[252:255], v9 offset:14336
    v_mfma_f32_16x16x32_bf16 v[72:75], a[228:231], a[12:15], v[72:75]
    s_waitcnt lgkmcnt(4)
    v_mfma_f32_16x16x32_bf16 v[68:71], a[232:235], a[0:3], v[68:71]
    ds_read_b64_tr_b16 a[224:225], v18 offset:40960
    v_mfma_f32_16x16x32_bf16 v[76:79], a[232:235], a[4:7], v[76:79]
    ds_read_b64_tr_b16 a[226:227], v18 offset:41472
    v_mfma_f32_16x16x32_bf16 v[68:71], a[236:239], a[8:11], v[68:71]
    ds_read_b64_tr_b16 a[228:229], v19 offset:40960
    v_mfma_f32_16x16x32_bf16 v[76:79], a[236:239], a[12:15], v[76:79]
    ds_read_b64_tr_b16 a[230:231], v19 offset:41472
    s_waitcnt lgkmcnt(6)
    v_mfma_f32_16x16x32_bf16 v[192:195], a[240:243], a[0:3], v[192:195]
    ds_read_b64_tr_b16 a[232:233], v20 offset:40960
    v_mfma_f32_16x16x32_bf16 v[200:203], a[240:243], a[4:7], v[200:203]
    ds_read_b64_tr_b16 a[234:235], v20 offset:41472
    v_mfma_f32_16x16x32_bf16 v[192:195], a[244:247], a[8:11], v[192:195]
    ds_read_b64_tr_b16 a[236:237], v21 offset:40960
    ds_read_b64_tr_b16 a[238:239], v21 offset:41472
    v_mfma_f32_16x16x32_bf16 v[200:203], a[244:247], a[12:15], v[200:203]
    ds_read_b32 v1, v31 offset:4
    s_waitcnt lgkmcnt(9)
    v_mfma_f32_16x16x32_bf16 v[196:199], a[248:251], a[0:3], v[196:199]
    ds_read_b64_tr_b16 a[240:241], v18 offset:45056
    v_mfma_f32_16x16x32_bf16 v[204:207], a[248:251], a[4:7], v[204:207]
    ds_read_b64_tr_b16 a[242:243], v18 offset:45568
    v_mfma_f32_16x16x32_bf16 v[196:199], a[252:255], a[8:11], v[196:199]
    ds_read_b64_tr_b16 a[244:245], v19 offset:45056
    v_mfma_f32_16x16x32_bf16 v[204:207], a[252:255], a[12:15], v[204:207]
    ds_read_b64_tr_b16 a[246:247], v19 offset:45568
    s_waitcnt lgkmcnt(9)
    v_mfma_f32_16x16x32_bf16 a[32:35], a[224:227], a[160:163], a[32:35]
    ds_read_b64_tr_b16 a[248:249], v20 offset:45056
    v_mfma_f32_16x16x32_bf16 a[40:43], a[224:227], a[164:167], a[40:43]
    ds_read_b64_tr_b16 a[250:251], v20 offset:45568
    s_waitcnt lgkmcnt(6)
    v_cmp_ne_u32 vcc, 0, v1
    v_mfma_f32_16x16x32_bf16 a[36:39], a[228:231], a[160:163], a[36:39]
    ds_read_b64_tr_b16 a[252:253], v21 offset:45056
    ds_read_b64_tr_b16 a[254:255], v21 offset:45568
    v_mfma_f32_16x16x32_bf16 a[44:47], a[228:231], a[164:167], a[44:47]
    ds_write_b32 v2, v31
    v_mfma_f32_16x16x32_bf16 a[48:51], a[232:235], a[160:163], a[48:51]
    s_getpc_b64 s[62:63]
    s_cbranch_vccnz L_cslow
    v_mfma_f32_16x16x32_bf16 a[56:59], a[232:235], a[164:167], a[56:59]
    ds_read_b128 a[224:227], v8 offset:57344
    v_mfma_f32_16x16x32_bf16 a[52:55], a[236:239], a[160:163], a[52:55]
    ds_read_b128 a[228:231], v9 offset:57344
    v_mfma_f32_16x16x32_bf16 a[60:63], a[236:239], a[164:167], a[60:63]
    v_add_u32 v31, 4, v31
    s_waitcnt lgkmcnt(7)
    v_mfma_f32_16x16x32_bf16 a[32:35], a[240:243], a[168:171], a[32:35]
    ds_read_b128 a[232:235], v8 offset:59392
    v_mfma_f32_16x16x32_bf16 a[40:43], a[240:243], a[172:175], a[40:43]
    v_mfma_f32_16x16x32_bf16 a[36:39], a[244:247], a[168:171], a[36:39]
    ds_read_b128 a[236:239], v9 offset:59392
    v_mfma_f32_16x16x32_bf16 a[44:47], a[244:247], a[172:175], a[44:47]
    s_waitcnt lgkmcnt(5)
    v_mfma_f32_16x16x32_bf16 a[48:51], a[248:251], a[168:171], a[48:51]
    ds_read_b128 a[240:243], v8 offset:61440
    v_mfma_f32_16x16x32_bf16 a[56:59], a[248:251], a[172:175], a[56:59]
    v_mfma_f32_16x16x32_bf16 a[52:55], a[252:255], a[168:171], a[52:55]
    ds_read_b128 a[244:247], v9 offset:61440
    v_mfma_f32_16x16x32_bf16 a[60:63], a[252:255], a[172:175], a[60:63]
    s_waitcnt lgkmcnt(4)
    v_mfma_f32_16x16x32_bf16 v[80:83], a[224:227], a[0:3], v[80:83]
    ds_read_b128 a[248:251], v8 offset:63488
    v_mfma_f32_16x16x32_bf16 v[88:91], a[224:227], a[4:7], v[88:91]
    v_mfma_f32_16x16x32_bf16 v[80:83], a[228:231], a[8:11], v[80:83]
    ds_read_b128 a[252:255], v9 offset:63488
    v_mfma_f32_16x16x32_bf16 v[88:91], a[228:231], a[12:15], v[88:91]
    s_waitcnt lgkmcnt(4)
    v_mfma_f32_16x16x32_bf16 v[84:87], a[232:235], a[0:3], v[84:87]
    ds_read_b64_tr_b16 a[224:225], v14 offset:49152
    v_mfma_f32_16x16x32_bf16 v[92:95], a[232:235], a[4:7], v[92:95]
    ds_read_b64_tr_b16 a[226:227], v14 offset:49664
    v_mfma_f32_16x16x32_bf16 v[84:87], a[236:239], a[8:11], v[84:87]
    ds_read_b64_tr_b16 a[228:229], v15 offset:49152
    v_mfma_f32_16x16x32_bf16 v[92:95], a[236:239], a[12:15], v[92:95]
    ds_read_b64_tr_b16 a[230:231], v15 offset:49664
    s_waitcnt lgkmcnt(6)
    v_mfma_f32_16x16x32_bf16 v[208:211], a[240:243], a[0:3], v[208:211]
    ds_read_b64_tr_b16 a[232:233], v16 offset:49152
    v_mfma_f32_16x16x32_bf16 v[216:219], a[240:243], a[4:7], v[216:219]
    ds_read_b64_tr_b16 a[234:235], v16 offset:49664
    v_mfma_f32_16x16x32_bf16 v[208:211], a[244:247], a[8:11], v[208:211]
    ds_read_b64_tr_b16 a[236:237], v17 offset:49152
    ds_read_b64_tr_b16 a[238:239], v17 offset:49664
    v_mfma_f32_16x16x32_bf16 v[216:219], a[244:247], a[12:15], v[216:219]
    ds_read_b32 v1, v31 offset:4
    s_waitcnt lgkmcnt(9)
    v_mfma_f32_16x16x32_bf16 v[212:215], a[248:251], a[0:3], v[212:215]
    ds_read_b64_tr_b16 a[240:241], v14 offset:53248
    v_mfma_f32_16x16x32_bf16 v[220:223], a[248:251], a[4:7], v[220:223]
    ds_read_b64_tr_b16 a[242:243], v14 offset:53760
    v_mfma_f32_16x16x32_bf16 v[212:215], a[252:255], a[8:11], v[212:215]
    ds_read_b64_tr_b16 a[244:245], v15 offset:53248
    v_mfma_f32_16x16x32_bf16 v[220:223], a[252:255], a[12:15], v[220:223]
    ds_read_b64_tr_b16 a[246:247], v15 offset:53760
    s_waitcnt lgkmcnt(9)
    v_mfma_f32_16x16x32_bf16 a[32:35], a[224:227], a[176:179], a[32:35]
    ds_read_b64_tr_b16 a[248:249], v16 offset:53248
    v_mfma_f32_16x16x32_bf16 a[40:43], a[224:227], a[180:183], a[40:43]
    ds_read_b64_tr_b16 a[250:251], v16 offset:53760
    s_waitcnt lgkmcnt(6)
    v_cmp_ne_u32 vcc, 0, v1
    v_mfma_f32_16x16x32_bf16 a[36:39], a[228:231], a[176:179], a[36:39]
    ds_read_b64_tr_b16 a[252:253], v17 offset:53248
    ds_read_b64_tr_b16 a[254:255], v17 offset:53760
    v_mfma_f32_16x16x32_bf16 a[44:47], a[228:231], a[180:183], a[44:47]
    ds_write_b32 v2, v31
    v_mfma_f32_16x16x32_bf16 a[48:51], a[232:235], a[176:179], a[48:51]
    s_getpc_b64 s[62:63]
    s_cbranch_vccnz L_cslow
    v_mfma_f32_16x16x32_bf16 a[56:59], a[232:235], a[180:183], a[56:59]
    ds_read_b128 a[224:227], v12 offset:8192
    v_mfma_f32_16x16x32_bf16 a[52:55], a[236:239], a[176:179], a[52:55]
    ds_read_b128 a[228:231], v13 offset:8192
    v_mfma_f32_16x16x32_bf16 a[60:63], a[236:239], a[180:183], a[60:63]
    v_add_u32 v31, 4, v31
    s_waitcnt lgkmcnt(7)
    v_mfma_f32_16x16x32_bf16 a[32:35], a[240:243], a[184:187], a[32:35]
    ds_read_b128 a[232:235], v12 offset:10240
    v_mfma_f32_16x16x32_bf16 a[40:43], a[240:243], a[188:191], a[40:43]
    v_mfma_f32_16x16x32_bf16 a[36:39], a[244:247], a[184:187], a[36:39]
    ds_read_b128 a[236:239], v13 offset:10240
    v_mfma_f32_16x16x32_bf16 a[44:47], a[244:247], a[188:191], a[44:47]
    s_waitcnt lgkmcnt(5)
    v_mfma_f32_16x16x32_bf16 a[48:51], a[248:251], a[184:187], a[48:51]
    ds_read_b128 a[240:243], v12 offset:12288
    v_mfma_f32_16x16x32_bf16 a[56:59], a[248:251], a[188:191], a[56:59]
    v_mfma_f32_16x16x32_bf16 a[52:55], a[252:255], a[184:187], a[52:55]
    ds_read_b128 a[244:247], v13 offset:12288
    v_mfma_f32_16x16x32_bf16 a[60:63], a[252:255], a[188:191], a[60:63]
    s_waitcnt lgkmcnt(4)
    v_mfma_f32_16x16x32_bf16 v[96:99], a[224:227], a[0:3], v[96:99]
    ds_read_b128 a[248:251], v12 offset:14336
    v_mfma_f32_16x16x32_bf16 v[104:107], a[224:227], a[4:7], v[104:107]
    v_mfma_f32_16x16x32_bf16 v[96:99], a[228:231], a[8:11], v[96:99]
    ds_read_b128 a[252:255], v13 offset:14336
    v_mfma_f32_16x16x32_bf16 v[104:107], a[228:231], a[12:15], v[104:107]
    s_waitcnt lgkmcnt(4)
    v_mfma_f32_16x16x32_bf16 v[100:103], a[232:235], a[0:3], v[100:103]
    ds_read_b64_tr_b16 a[224:225], v18 offset:16384
    v_mfma_f32_16x16x32_bf16 v[108:111], a[232:235], a[4:7], v[108:111]
    ds_read_b64_tr_b16 a[226:227], v18 offset:16896
    v_mfma_f32_16x16x32_bf16 v[100:103], a[236:239], a[8:11], v[100:103]
    ds_read_b64_tr_b16 a[228:229], v19 offset:16384
    v_mfma_f32_16x16x32_bf16 v[108:111], a[236:239], a[12:15], v[108:111]
    ds_read_b64_tr_b16 a[230:231], v19 offset:16896
    s_waitcnt lgkmcnt(6)
    v_mfma_f32_16x16x32_bf16 v[224:227], a[240:243], a[0:3], v[224:227]
    ds_read_b64_tr_b16 a[232:233], v20 offset:16384
    v_mfma_f32_16x16x32_bf16 v[232:235], a[240:243], a[4:7], v[232:235]
    ds_read_b64_tr_b16 a[234:235], v20 offset:16896
    v_mfma_f32_16x16x32_bf16 v[224:227], a[244:247], a[8:11], v[224:227]
    ds_read_b64_tr_b16 a[236:237], v21 offset:16384
    ds_read_b64_tr_b16 a[238:239], v21 offset:16896
    v_mfma_f32_16x16x32_bf16 v[232:235], a[244:247], a[12:15], v[232:235]
    ds_read_b32 v1, v31 offset:4
    s_waitcnt lgkmcnt(9)
    v_mfma_f32_16x16x32_bf16 v[228:231], a[248:251], a[0:3], v[228:231]
    ds_read_b64_tr_b16 a[240:241], v18 offset:20480
    v_mfma_f32_16x16x32_bf16 v[236:239], a[248:251], a[4:7], v[236:239]
    ds_read_b64_tr_b16 a[242:243], v18 offset:20992
    v_mfma_f32_16x16x32_bf16 v[228:231], a[252:255], a[8:11], v[228:231]
    ds_read_b64_tr_b16 a[244:245], v19 offset:20480
    v_mfma_f32_16x16x32_bf16 v[236:239], a[252:255], a[12:15], v[236:239]
    ds_read_b64_tr_b16 a[246:247], v19 offset:20992
    s_waitcnt lgkmcnt(9)
    v_mfma_f32_16x16x32_bf16 a[32:35], a[224:227], a[192:195], a[32:35]
    ds_read_b64_tr_b16 a[248:249], v20 offset:20480
    v_mfma_f32_16x16x32_bf16 a[40:43], a[224:227], a[196:199], a[40:43]
    ds_read_b64_tr_b16 a[250:251], v20 offset:20992
    s_waitcnt lgkmcnt(6)
    v_cmp_ne_u32 vcc, 0, v1
    v_mfma_f32_16x16x32_bf16 a[36:39], a[228:231], a[192:195], a[36:39]
    ds_read_b64_tr_b16 a[252:253], v21 offset:20480
    ds_read_b64_tr_b16 a[254:255], v21 offset:20992
    v_mfma_f32_16x16x32_bf16 a[44:47], a[228:231], a[196:199], a[44:47]
    ds_write_b32 v2, v31
    v_mfma_f32_16x16x32_bf16 a[48:51], a[232:235], a[192:195], a[48:51]
    s_getpc_b64 s[62:63]
    s_cbranch_vccnz L_cslow
    v_mfma_f32_16x16x32_bf16 a[56:59], a[232:235], a[196:199], a[56:59]
    ds_read_b128 a[224:227], v8 offset:24576
    v_mfma_f32_16x16x32_bf16 a[52:55], a[236:239], a[192:195], a[52:55]
    ds_read_b128 a[228:231], v9 offset:24576
    v_mfma_f32_16x16x32_bf16 a[60:63], a[236:239], a[196:199], a[60:63]
    v_add_u32 v31, 4, v31
    s_waitcnt lgkmcnt(7)
    v_mfma_f32_16x16x32_bf16 a[32:35], a[240:243], a[200:203], a[32:35]
    ds_read_b128 a[232:235], v8 offset:26624
    v_mfma_f32_16x16x32_bf16 a[40:43], a[240:243], a[204:207], a[40:43]
    v_mfma_f32_16x16x32_bf16 a[36:39], a[244:247], a[200:203], a[36:39]
    ds_read_b128 a[236:239], v9 offset:26624
    v_mfma_f32_16x16x32_bf16 a[44:47], a[244:247], a[204:207], a[44:47]
    s_waitcnt lgkmcnt(5)
    v_mfma_f32_16x16x32_bf16 a[48:51], a[248:251], a[200:203], a[48:51]
    ds_read_b128 a[240:243], v8 offset:28672
    v_mfma_f32_16x16x32_bf16 a[56:59], a[248:251], a[204:207], a[56:59]
    v_mfma_f32_16x16x32_bf16 a[52:55], a[252:255], a[200:203], a[52:55]
    ds_read_b128 a[244:247], v9 offset:28672
    v_mfma_f32_16x16x32_bf16 a[60:63], a[252:255], a[204:207], a[60:63]
    s_waitcnt lgkmcnt(4)
    v_mfma_f32_16x16x32_bf16 v[112:115], a[224:227], a[0:3], v[112:115]
    ds_read_b128 a[248:251], v8 offset:30720
    v_mfma_f32_16x16x32_bf16 v[120:123], a[224:227], a[4:7], v[120:123]
    v_mfma_f32_16x16x32_bf16 v[112:115], a[228:231], a[8:11], v[112:115]
    ds_read_b128 a[252:255], v9 offset:30720
    v_mfma_f32_16x16x32_bf16 v[120:123], a[228:231], a[12:15], v[120:123]
    s_waitcnt lgkmcnt(4)
    v_mfma_f32_16x16x32_bf16 v[116:119], a[232:235], a[0:3], v[116:119]
    ds_read_b64_tr_b16 a[224:225], v14 offset:0
    v_mfma_f32_16x16x32_bf16 v[124:127], a[232:235], a[4:7], v[124:127]
    ds_read_b64_tr_b16 a[226:227], v14 offset:512
    v_mfma_f32_16x16x32_bf16 v[116:119], a[236:239], a[8:11], v[116:119]
    ds_read_b64_tr_b16 a[228:229], v15 offset:0
    v_mfma_f32_16x16x32_bf16 v[124:127], a[236:239], a[12:15], v[124:127]
    ds_read_b64_tr_b16 a[230:231], v15 offset:512
    s_waitcnt lgkmcnt(6)
    v_mfma_f32_16x16x32_bf16 v[240:243], a[240:243], a[0:3], v[240:243]
    ds_read_b64_tr_b16 a[232:233], v14 offset:4096
    v_mfma_f32_16x16x32_bf16 v[248:251], a[240:243], a[4:7], v[248:251]
    ds_read_b64_tr_b16 a[234:235], v14 offset:4608
    v_mfma_f32_16x16x32_bf16 v[240:243], a[244:247], a[8:11], v[240:243]
    ds_read_b64_tr_b16 a[236:237], v15 offset:4096
    ds_read_b64_tr_b16 a[238:239], v15 offset:4608
    v_mfma_f32_16x16x32_bf16 v[248:251], a[244:247], a[12:15], v[248:251]
    ds_read_b32 v1, v31 offset:4
    s_waitcnt lgkmcnt(9)
    v_mfma_f32_16x16x32_bf16 v[244:247], a[248:251], a[0:3], v[244:247]
    ds_read_b64_tr_b16 a[240:241], v16 offset:0
    v_mfma_f32_16x16x32_bf16 v[252:255], a[248:251], a[4:7], v[252:255]
    ds_read_b64_tr_b16 a[242:243], v16 offset:512
    v_mfma_f32_16x16x32_bf16 v[244:247], a[252:255], a[8:11], v[244:247]
    ds_read_b64_tr_b16 a[244:245], v17 offset:0
    v_mfma_f32_16x16x32_bf16 v[252:255], a[252:255], a[12:15], v[252:255]
    ds_read_b64_tr_b16 a[246:247], v17 offset:512
    s_waitcnt lgkmcnt(9)
    v_mfma_f32_16x16x32_bf16 a[32:35], a[224:227], a[208:211], a[32:35]
    ds_read_b64_tr_b16 a[248:249], v16 offset:4096
    v_mfma_f32_16x16x32_bf16 a[40:43], a[224:227], a[212:215], a[40:43]
    ds_read_b64_tr_b16 a[250:251], v16 offset:4608
    s_waitcnt lgkmcnt(6)
    v_cmp_ne_u32 vcc, 0, v1
    v_mfma_f32_16x16x32_bf16 a[36:39], a[228:231], a[208:211], a[36:39]
    ds_read_b64_tr_b16 a[252:253], v17 offset:4096
    ds_read_b64_tr_b16 a[254:255], v17 offset:4608
    v_mfma_f32_16x16x32_bf16 a[44:47], a[228:231], a[212:215], a[44:47]
    ds_write_b32 v2, v31
    v_mfma_f32_16x16x32_bf16 a[32:35], a[232:235], a[216:219], a[32:35]
    s_getpc_b64 s[62:63]
    s_cbranch_vccnz L_cslow
    v_mfma_f32_16x16x32_bf16 a[40:43], a[232:235], a[220:223], a[40:43]
    ds_read_b128 a[224:227], v10 offset:0
    v_mfma_f32_16x16x32_bf16 a[36:39], a[236:239], a[216:219], a[36:39]
    ds_read_b128 a[228:231], v11 offset:0
    v_mfma_f32_16x16x32_bf16 a[44:47], a[236:239], a[220:223], a[44:47]
    v_add_u32 v31, 4, v31
    s_waitcnt lgkmcnt(7)
    v_mfma_f32_16x16x32_bf16 a[48:51], a[240:243], a[208:211], a[48:51]
    ds_read_b128 a[232:235], v10 offset:2048
    v_mfma_f32_16x16x32_bf16 a[56:59], a[240:243], a[212:215], a[56:59]
    v_mfma_f32_16x16x32_bf16 a[52:55], a[244:247], a[208:211], a[52:55]
    ds_read_b128 a[236:239], v11 offset:2048
    v_accvgpr_read_b32 v3, a32
    v_accvgpr_read_b32 v4, a33
    v_mfma_f32_16x16x32_bf16 a[60:63], a[244:247], a[212:215], a[60:63]
    v_accvgpr_read_b32 v5, a34
    v_accvgpr_read_b32 v6, a35
    s_waitcnt lgkmcnt(5)
    v_mfma_f32_16x16x32_bf16 a[48:51], a[248:251], a[216:219], a[48:51]
    ds_read_b128 a[240:243], v10 offset:4096
    v_accvgpr_read_b32 v7, a36
    v_accvgpr_read_b32 v26, a37
    v_mfma_f32_16x16x32_bf16 a[56:59], a[248:251], a[220:223], a[56:59]
    v_accvgpr_read_b32 v27, a38
    v_accvgpr_read_b32 v28, a39
    v_mfma_f32_16x16x32_bf16 a[52:55], a[252:255], a[216:219], a[52:55]
    ds_read_b128 a[244:247], v11 offset:4096
    v_cvt_pk_bf16_f32 v3, v3, v4
    v_cvt_pk_bf16_f32 v7, v7, v26
    v_mfma_f32_16x16x32_bf16 a[60:63], a[252:255], a[220:223], a[60:63]
    v_cvt_pk_bf16_f32 v5, v5, v6
    v_cvt_pk_bf16_f32 v27, v27, v28
    s_waitcnt lgkmcnt(4)
    v_mfma_f32_16x16x32_bf16 v[128:131], a[224:227], a[0:3], v[128:131]
    ds_read_b128 a[248:251], v10 offset:6144
    v_permlane16_swap_b32 v3, v7
    v_permlane16_swap_b32 v5, v27
    v_mfma_f32_16x16x32_bf16 v[136:139], a[224:227], a[4:7], v[136:139]
    v_accvgpr_write_b32 a32, v3
    v_accvgpr_write_b32 a34, v7
    v_mfma_f32_16x16x32_bf16 v[128:131], a[228:231], a[8:11], v[128:131]
    ds_read_b128 a[252:255], v11 offset:6144
    v_accvgpr_write_b32 a33, v5
    v_accvgpr_write_b32 a35, v27
    v_mfma_f32_16x16x32_bf16 v[136:139], a[228:231], a[12:15], v[136:139]
    v_accvgpr_read_b32 v3, a40
    v_accvgpr_read_b32 v4, a41
    s_waitcnt lgkmcnt(4)
    v_mfma_f32_16x16x32_bf16 v[132:135], a[232:235], a[0:3], v[132:135]
    ds_read_b128 a[224:227], v8 offset:16384
    v_accvgpr_read_b32 v5, a42
    v_accvgpr_read_b32 v6, a43
    v_mfma_f32_16x16x32_bf16 v[140:143], a[232:235], a[4:7], v[140:143]
    v_accvgpr_read_b32 v7, a44
    v_accvgpr_read_b32 v26, a45
    v_mfma_f32_16x16x32_bf16 v[132:135], a[236:239], a[8:11], v[132:135]
    ds_read_b128 a[228:231], v9 offset:16384
    v_accvgpr_read_b32 v27, a46
    v_accvgpr_read_b32 v28, a47
    v_mfma_f32_16x16x32_bf16 v[140:143], a[236:239], a[12:15], v[140:143]
    v_cvt_pk_bf16_f32 v3, v3, v4
    v_cvt_pk_bf16_f32 v7, v7, v26
    s_waitcnt lgkmcnt(4)
    v_mfma_f32_16x16x32_bf16 a[64:67], a[240:243], a[0:3], a[64:67]
    ds_read_b128 a[232:235], v8 offset:18432
    v_cvt_pk_bf16_f32 v5, v5, v6
    v_cvt_pk_bf16_f32 v27, v27, v28
    v_mfma_f32_16x16x32_bf16 a[72:75], a[240:243], a[4:7], a[72:75]
    v_permlane16_swap_b32 v3, v7
    v_permlane16_swap_b32 v5, v27
    v_mfma_f32_16x16x32_bf16 a[64:67], a[244:247], a[8:11], a[64:67]
    ds_read_b128 a[236:239], v9 offset:18432
    v_accvgpr_write_b32 a36, v3
    v_accvgpr_write_b32 a38, v7
    v_mfma_f32_16x16x32_bf16 a[72:75], a[244:247], a[12:15], a[72:75]
    ds_read_b32 v1, v31 offset:4
    v_accvgpr_write_b32 a37, v5
    s_waitcnt lgkmcnt(5)
    v_mfma_f32_16x16x32_bf16 a[68:71], a[248:251], a[0:3], a[68:71]
    ds_read_b128 a[240:243], v8 offset:20480
    v_accvgpr_write_b32 a39, v27
    v_accvgpr_read_b32 v3, a48
    v_mfma_f32_16x16x32_bf16 a[76:79], a[248:251], a[4:7], a[76:79]
    v_accvgpr_read_b32 v4, a49
    v_accvgpr_read_b32 v5, a50
    v_mfma_f32_16x16x32_bf16 a[68:71], a[252:255], a[8:11], a[68:71]
    ds_read_b128 a[244:247], v9 offset:20480
    v_accvgpr_read_b32 v6, a51
    v_accvgpr_read_b32 v7, a52
    v_mfma_f32_16x16x32_bf16 a[76:79], a[252:255], a[12:15], a[76:79]
    v_accvgpr_read_b32 v26, a53
    v_accvgpr_read_b32 v27, a54
    s_waitcnt lgkmcnt(5)
    v_mfma_f32_16x16x32_bf16 v[144:147], a[224:227], a[0:3], v[144:147]
    ds_read_b128 a[248:251], v8 offset:22528
    v_accvgpr_read_b32 v28, a55
    v_cvt_pk_bf16_f32 v3, v3, v4
    v_mfma_f32_16x16x32_bf16 v[152:155], a[224:227], a[4:7], v[152:155]
    s_waitcnt lgkmcnt(3)
    v_cmp_ne_u32 vcc, 0, v1
    v_cvt_pk_bf16_f32 v7, v7, v26
    v_mfma_f32_16x16x32_bf16 v[144:147], a[228:231], a[8:11], v[144:147]
    ds_read_b128 a[252:255], v9 offset:22528
    v_cvt_pk_bf16_f32 v5, v5, v6
    v_cvt_pk_bf16_f32 v27, v27, v28
    v_mfma_f32_16x16x32_bf16 v[152:155], a[228:231], a[12:15], v[152:155]
    ds_write_b32 v2, v31
    v_permlane16_swap_b32 v3, v7
    v_mfma_f32_16x16x32_bf16 v[148:151], a[232:235], a[0:3], v[148:151]
    s_getpc_b64 s[62:63]
    s_cbranch_vccnz L_cslow
    v_permlane16_swap_b32 v5, v27
    v_mfma_f32_16x16x32_bf16 v[156:159], a[232:235], a[4:7], v[156:159]
    ds_read_b128 a[224:227], v10 offset:49152
    v_accvgpr_write_b32 a40, v3
    v_accvgpr_write_b32 a42, v7
    v_mfma_f32_16x16x32_bf16 v[148:151], a[236:239], a[8:11], v[148:151]
    ds_read_b128 a[228:231], v11 offset:49152
    v_accvgpr_write_b32 a41, v5
    v_accvgpr_write_b32 a43, v27
    v_mfma_f32_16x16x32_bf16 v[156:159], a[236:239], a[12:15], v[156:159]
    v_add_u32 v31, 4, v31
    v_accvgpr_read_b32 v3, a56
    s_waitcnt lgkmcnt(5)
    v_mfma_f32_16x16x32_bf16 a[80:83], a[240:243], a[0:3], a[80:83]
    ds_read_b128 a[232:235], v10 offset:51200
    v_accvgpr_read_b32 v4, a57
    v_accvgpr_read_b32 v5, a58
    v_mfma_f32_16x16x32_bf16 a[88:91], a[240:243], a[4:7], a[88:91]
    v_accvgpr_read_b32 v6, a59
    v_accvgpr_read_b32 v7, a60
    v_mfma_f32_16x16x32_bf16 a[80:83], a[244:247], a[8:11], a[80:83]
    ds_read_b128 a[236:239], v11 offset:51200
    v_accvgpr_read_b32 v26, a61
    v_accvgpr_read_b32 v27, a62
    v_mfma_f32_16x16x32_bf16 a[88:91], a[244:247], a[12:15], a[88:91]
    v_accvgpr_read_b32 v28, a63
    v_cvt_pk_bf16_f32 v3, v3, v4
    s_waitcnt lgkmcnt(5)
    v_mfma_f32_16x16x32_bf16 a[84:87], a[248:251], a[0:3], a[84:87]
    ds_read_b128 a[240:243], v10 offset:53248
    v_cvt_pk_bf16_f32 v7, v7, v26
    v_cvt_pk_bf16_f32 v5, v5, v6
    v_mfma_f32_16x16x32_bf16 a[92:95], a[248:251], a[4:7], a[92:95]
    v_cvt_pk_bf16_f32 v27, v27, v28
    v_permlane16_swap_b32 v3, v7
    v_mfma_f32_16x16x32_bf16 a[84:87], a[252:255], a[8:11], a[84:87]
    ds_read_b128 a[244:247], v11 offset:53248
    v_permlane16_swap_b32 v5, v27
    v_accvgpr_write_b32 a44, v3
    v_mfma_f32_16x16x32_bf16 a[92:95], a[252:255], a[12:15], a[92:95]
    v_accvgpr_write_b32 a46, v7
    v_accvgpr_write_b32 a45, v5
    s_waitcnt lgkmcnt(4)
    v_mfma_f32_16x16x32_bf16 v[32:35], a[224:227], a[32:35], v[32:35]
    ds_read_b128 a[248:251], v10 offset:55296
    v_accvgpr_write_b32 a47, v27
    v_accvgpr_read_b32 v14, a96
    v_mfma_f32_16x16x32_bf16 v[40:43], a[224:227], a[36:39], v[40:43]
    v_xor_b32 v15, 32, v14
    v_xor_b32 v16, 64, v14
    v_mfma_f32_16x16x32_bf16 v[32:35], a[228:231], a[40:43], v[32:35]
    ds_read_b128 a[252:255], v11 offset:55296
    v_xor_b32 v17, 96, v14
    v_add_u32 v18, 0x10000, v14
    v_mfma_f32_16x16x32_bf16 v[40:43], a[228:231], a[44:47], v[40:43]
    v_add_u32 v19, 0x10000, v15
    v_add_u32 v20, 0x10000, v16
    s_waitcnt lgkmcnt(4)
    v_mfma_f32_16x16x32_bf16 v[36:39], a[232:235], a[32:35], v[36:39]
    ds_read_b128 a[224:227], v8 offset:32768
    v_add_u32 v21, 0x10000, v17
    v_add_u32 v22, 0x20000, v14
    v_mfma_f32_16x16x32_bf16 v[44:47], a[232:235], a[36:39], v[44:47]
    v_add_u32 v23, 0x20000, v15
    v_add_u32 v24, 0x20000, v16
    v_mfma_f32_16x16x32_bf16 v[36:39], a[236:239], a[40:43], v[36:39]
    ds_read_b128 a[228:231], v9 offset:32768
    v_add_u32 v25, 0x20000, v17
    v_mfma_f32_16x16x32_bf16 v[44:47], a[236:239], a[44:47], v[44:47]
    s_waitcnt lgkmcnt(4)
    v_mfma_f32_16x16x32_bf16 v[160:163], a[240:243], a[32:35], v[160:163]
    ds_read_b128 a[232:235], v8 offset:34816
    v_mfma_f32_16x16x32_bf16 v[168:171], a[240:243], a[36:39], v[168:171]
    v_mfma_f32_16x16x32_bf16 v[160:163], a[244:247], a[40:43], v[160:163]
    ds_read_b128 a[236:239], v9 offset:34816
    v_max_f32 v26, v32, v33
    v_max_f32 v27, v40, v41
    v_max3_f32 v26, v26, v34, v35
    v_max3_f32 v27, v27, v42, v43
    v_max3_f32 v26, v26, v36, v37
    v_mfma_f32_16x16x32_bf16 v[168:171], a[244:247], a[44:47], v[168:171]
    ds_read_b32 v1, v31 offset:4
    v_max3_f32 v27, v27, v44, v45
    v_max3_f32 v26, v26, v38, v39
    v_max3_f32 v27, v27, v46, v47
    v_mul_f32 v28, s56, v26
    s_waitcnt lgkmcnt(5)
    v_mfma_f32_16x16x32_bf16 v[164:167], a[248:251], a[32:35], v[164:167]
    ds_read_b128 a[240:243], v8 offset:36864
    v_mul_f32 v29, s56, v27
    v_ceil_f32 v28, v28
    v_ceil_f32 v29, v29
    v_accvgpr_write_b32 a112, v28
    v_accvgpr_write_b32 a113, v29
    v_mfma_f32_16x16x32_bf16 v[172:175], a[248:251], a[36:39], v[172:175]
    v_fma_f32 v32, v32, s56, -v28
    v_fma_f32 v33, v33, s56, -v28
    v_exp_f32 v32, v32
    v_fma_f32 v34, v34, s56, -v28
    v_mfma_f32_16x16x32_bf16 v[164:167], a[252:255], a[40:43], v[164:167]
    ds_read_b128 a[244:247], v9 offset:36864
    v_exp_f32 v33, v33
    v_fma_f32 v35, v35, s56, -v28
    v_exp_f32 v34, v34
    v_mfma_f32_16x16x32_bf16 v[172:175], a[252:255], a[44:47], v[172:175]
    v_fma_f32 v36, v36, s56, -v28
    v_exp_f32 v35, v35
    v_fma_f32 v37, v37, s56, -v28
    v_exp_f32 v36, v36
    s_waitcnt lgkmcnt(5)
    v_mfma_f32_16x16x32_bf16 v[48:51], a[224:227], a[32:35], v[48:51]
    ds_read_b128 a[248:251], v8 offset:38912
    v_fma_f32 v38, v38, s56, -v28
    v_exp_f32 v37, v37
    v_fma_f32 v39, v39, s56, -v28
    v_mfma_f32_16x16x32_bf16 v[56:59], a[224:227], a[36:39], v[56:59]
    s_waitcnt lgkmcnt(3)
    v_cmp_ne_u32 vcc, 0, v1
    v_exp_f32 v38, v38
    v_exp_f32 v39, v39
    v_mfma_f32_16x16x32_bf16 v[48:51], a[228:231], a[40:43], v[48:51]
    ds_read_b128 a[252:255], v9 offset:38912
    v_cvt_pk_bf16_f32 v32, v32, v33
    v_cvt_pk_bf16_f32 v33, v34, v35
    v_cvt_pk_bf16_f32 v34, v36, v37
    v_cvt_pk_bf16_f32 v35, v38, v39
    v_fma_f32 v40, v40, s56, -v29
    v_mfma_f32_16x16x32_bf16 v[56:59], a[228:231], a[44:47], v[56:59]
    ds_write_b32 v2, v31
    v_fma_f32 v41, v41, s56, -v29
    v_exp_f32 v40, v40
    v_fma_f32 v42, v42, s56, -v29
    v_mfma_f32_16x16x32_bf16 v[52:55], a[232:235], a[32:35], v[52:55]
    s_getpc_b64 s[62:63]
    s_cbranch_vccnz L_cslow
    v_exp_f32 v41, v41
    v_fma_f32 v43, v43, s56, -v29
    v_exp_f32 v42, v42
    v_mfma_f32_16x16x32_bf16 v[60:63], a[232:235], a[36:39], v[60:63]
    ds_read_b128 a[224:227], v12 offset:16384
    v_fma_f32 v44, v44, s56, -v29
    v_exp_f32 v43, v43
    v_fma_f32 v45, v45, s56, -v29
    v_mfma_f32_16x16x32_bf16 v[52:55], a[236:239], a[40:43], v[52:55]
    ds_read_b128 a[228:231], v13 offset:16384
    v_exp_f32 v44, v44
    v_fma_f32 v46, v46, s56, -v29
    v_exp_f32 v45, v45
    v_mfma_f32_16x16x32_bf16 v[60:63], a[236:239], a[44:47], v[60:63]
    v_add_u32 v31, 4, v31
    v_fma_f32 v47, v47, s56, -v29
    v_exp_f32 v46, v46
    v_exp_f32 v47, v47
    s_waitcnt lgkmcnt(5)
    v_mfma_f32_16x16x32_bf16 v[176:179], a[240:243], a[32:35], v[176:179]
    ds_read_b128 a[232:235], v12 offset:18432
    v_cvt_pk_bf16_f32 v36, v40, v41
    v_cvt_pk_bf16_f32 v37, v42, v43
    v_cvt_pk_bf16_f32 v38, v44, v45
    v_cvt_pk_bf16_f32 v39, v46, v47
    v_mfma_f32_16x16x32_bf16 v[184:187], a[240:243], a[36:39], v[184:187]
    v_max3_f32 v26, v26, v160, v161
    v_max3_f32 v27, v27, v168, v169
    v_max3_f32 v26, v26, v162, v163
    v_max3_f32 v27, v27, v170, v171
    v_max3_f32 v26, v26, v164, v165
    v_mfma_f32_16x16x32_bf16 v[176:179], a[244:247], a[40:43], v[176:179]
    ds_read_b128 a[236:239], v13 offset:18432
    v_max3_f32 v27, v27, v172, v173
    v_max3_f32 v26, v26, v166, v167
    v_max3_f32 v27, v27, v174, v175
    v_mul_f32 v28, s56, v26
    v_mul_f32 v29, s56, v27
    v_mfma_f32_16x16x32_bf16 v[184:187], a[244:247], a[44:47], v[184:187]
    v_ceil_f32 v28, v28
    v_ceil_f32 v29, v29
    v_accvgpr_write_b32 a114, v28
    v_accvgpr_write_b32 a115, v29
    v_fma_f32 v160, v160, s56, -v28
    s_waitcnt lgkmcnt(5)
    v_mfma_f32_16x16x32_bf16 v[180:183], a[248:251], a[32:35], v[180:183]
    ds_read_b128 a[240:243], v12 offset:20480
    v_fma_f32 v161, v161, s56, -v28
    v_exp_f32 v160, v160
    v_fma_f32 v162, v162, s56, -v28
    v_exp_f32 v161, v161
    v_mfma_f32_16x16x32_bf16 v[188:191], a[248:251], a[36:39], v[188:191]
    v_fma_f32 v163, v163, s56, -v28
    v_exp_f32 v162, v162
    v_fma_f32 v164, v164, s56, -v28
    v_mfma_f32_16x16x32_bf16 v[180:183], a[252:255], a[40:43], v[180:183]
    ds_read_b128 a[244:247], v13 offset:20480
    v_exp_f32 v163, v163
    v_fma_f32 v165, v165, s56, -v28
    v_exp_f32 v164, v164
    v_mfma_f32_16x16x32_bf16 v[188:191], a[252:255], a[44:47], v[188:191]
    v_fma_f32 v166, v166, s56, -v28
    v_exp_f32 v165, v165
    v_fma_f32 v167, v167, s56, -v28
    v_exp_f32 v166, v166
    s_waitcnt lgkmcnt(4)
    v_mfma_f32_16x16x32_bf16 v[64:67], a[224:227], a[32:35], v[64:67]
    ds_read_b128 a[248:251], v12 offset:22528
    v_exp_f32 v167, v167
    v_cvt_pk_bf16_f32 v40, v160, v161
    v_cvt_pk_bf16_f32 v41, v162, v163
    v_mfma_f32_16x16x32_bf16 v[72:75], a[224:227], a[36:39], v[72:75]
    v_cvt_pk_bf16_f32 v42, v164, v165
    v_cvt_pk_bf16_f32 v43, v166, v167
    v_fma_f32 v168, v168, s56, -v29
    v_fma_f32 v169, v169, s56, -v29
    v_exp_f32 v168, v168
    v_mfma_f32_16x16x32_bf16 v[64:67], a[228:231], a[40:43], v[64:67]
    ds_read_b128 a[252:255], v13 offset:22528
    v_fma_f32 v170, v170, s56, -v29
    v_exp_f32 v169, v169
    v_fma_f32 v171, v171, s56, -v29
    v_mfma_f32_16x16x32_bf16 v[72:75], a[228:231], a[44:47], v[72:75]
    v_exp_f32 v170, v170
    v_fma_f32 v172, v172, s56, -v29
    v_exp_f32 v171, v171
    s_waitcnt lgkmcnt(4)
    v_mfma_f32_16x16x32_bf16 v[68:71], a[232:235], a[32:35], v[68:71]
    ds_read_b128 a[224:227], v8 offset:40960
    v_fma_f32 v173, v173, s56, -v29
    v_exp_f32 v172, v172
    v_fma_f32 v174, v174, s56, -v29
    v_exp_f32 v173, v173
    v_mfma_f32_16x16x32_bf16 v[76:79], a[232:235], a[36:39], v[76:79]
    v_fma_f32 v175, v175, s56, -v29
    v_exp_f32 v174, v174
    v_exp_f32 v175, v175
    v_mfma_f32_16x16x32_bf16 v[68:71], a[236:239], a[40:43], v[68:71]
    ds_read_b128 a[228:231], v9 offset:40960
    v_cvt_pk_bf16_f32 v44, v168, v169
    v_cvt_pk_bf16_f32 v45, v170, v171
    v_cvt_pk_bf16_f32 v46, v172, v173
    v_cvt_pk_bf16_f32 v47, v174, v175
    v_mfma_f32_16x16x32_bf16 v[76:79], a[236:239], a[44:47], v[76:79]
    v_max3_f32 v26, v26, v48, v49
    v_max3_f32 v27, v27, v56, v57
    v_max3_f32 v26, v26, v50, v51
    v_max3_f32 v27, v27, v58, v59
    v_max3_f32 v26, v26, v52, v53
    s_waitcnt lgkmcnt(4)
    v_mfma_f32_16x16x32_bf16 v[192:195], a[240:243], a[32:35], v[192:195]
    ds_read_b128 a[232:235], v8 offset:43008
    v_max3_f32 v27, v27, v60, v61
    v_max3_f32 v26, v26, v54, v55
    v_max3_f32 v27, v27, v62, v63
    v_mul_f32 v28, s56, v26
    v_mul_f32 v29, s56, v27
    v_mfma_f32_16x16x32_bf16 v[200:203], a[240:243], a[36:39], v[200:203]
    v_ceil_f32 v28, v28
    v_ceil_f32 v29, v29
    v_accvgpr_write_b32 a116, v28
    v_accvgpr_write_b32 a117, v29
    v_fma_f32 v48, v48, s56, -v28
    v_mfma_f32_16x16x32_bf16 v[192:195], a[244:247], a[40:43], v[192:195]
    ds_read_b128 a[236:239], v9 offset:43008
    v_fma_f32 v49, v49, s56, -v28
    v_exp_f32 v48, v48
    v_fma_f32 v50, v50, s56, -v28
    v_exp_f32 v49, v49
    v_mfma_f32_16x16x32_bf16 v[200:203], a[244:247], a[44:47], v[200:203]
    ds_read_b32 v1, v31 offset:4
    v_fma_f32 v51, v51, s56, -v28
    v_exp_f32 v50, v50
    s_waitcnt lgkmcnt(5)
    v_mfma_f32_16x16x32_bf16 v[196:199], a[248:251], a[32:35], v[196:199]
    ds_read_b128 a[240:243], v8 offset:45056
    v_fma_f32 v52, v52, s56, -v28
    v_exp_f32 v51, v51
    v_fma_f32 v53, v53, s56, -v28
    v_exp_f32 v52, v52
    v_mfma_f32_16x16x32_bf16 v[204:207], a[248:251], a[36:39], v[204:207]
    v_fma_f32 v54, v54, s56, -v28
    v_exp_f32 v53, v53
    v_fma_f32 v55, v55, s56, -v28
    v_mfma_f32_16x16x32_bf16 v[196:199], a[252:255], a[40:43], v[196:199]
    ds_read_b128 a[244:247], v9 offset:45056
    v_exp_f32 v54, v54
    v_exp_f32 v55, v55
    v_cvt_pk_bf16_f32 v48, v48, v49
    v_mfma_f32_16x16x32_bf16 v[204:207], a[252:255], a[44:47], v[204:207]
    v_cvt_pk_bf16_f32 v49, v50, v51
    v_cvt_pk_bf16_f32 v50, v52, v53
    v_cvt_pk_bf16_f32 v51, v54, v55
    v_fma_f32 v56, v56, s56, -v29
    v_fma_f32 v57, v57, s56, -v29
    s_waitcnt lgkmcnt(5)
    v_mfma_f32_16x16x32_bf16 v[80:83], a[224:227], a[32:35], v[80:83]
    ds_read_b128 a[248:251], v8 offset:47104
    v_exp_f32 v56, v56
    v_fma_f32 v58, v58, s56, -v29
    v_exp_f32 v57, v57
    v_mfma_f32_16x16x32_bf16 v[88:91], a[224:227], a[36:39], v[88:91]
    s_waitcnt lgkmcnt(3)
    v_cmp_ne_u32 vcc, 0, v1
    v_fma_f32 v59, v59, s56, -v29
    v_exp_f32 v58, v58
    v_fma_f32 v60, v60, s56, -v29
    v_mfma_f32_16x16x32_bf16 v[80:83], a[228:231], a[40:43], v[80:83]
    ds_read_b128 a[252:255], v9 offset:47104
    v_exp_f32 v59, v59
    v_fma_f32 v61, v61, s56, -v29
    v_exp_f32 v60, v60
    v_mfma_f32_16x16x32_bf16 v[88:91], a[228:231], a[44:47], v[88:91]
    ds_write_b32 v2, v31
    v_fma_f32 v62, v62, s56, -v29
    v_exp_f32 v61, v61
    v_fma_f32 v63, v63, s56, -v29
    v_mfma_f32_16x16x32_bf16 v[84:87], a[232:235], a[32:35], v[84:87]
    s_getpc_b64 s[62:63]
    s_cbranch_vccnz L_cslow
    v_exp_f32 v62, v62
    v_exp_f32 v63, v63
    v_mfma_f32_16x16x32_bf16 v[92:95], a[232:235], a[36:39], v[92:95]
    ds_read_b128 a[224:227], v10 offset:57344
    v_cvt_pk_bf16_f32 v52, v56, v57
    v_cvt_pk_bf16_f32 v53, v58, v59
    v_cvt_pk_bf16_f32 v54, v60, v61
    v_cvt_pk_bf16_f32 v55, v62, v63
    v_max3_f32 v26, v26, v176, v177
    v_mfma_f32_16x16x32_bf16 v[84:87], a[236:239], a[40:43], v[84:87]
    ds_read_b128 a[228:231], v11 offset:57344
    v_max3_f32 v27, v27, v184, v185
    v_max3_f32 v26, v26, v178, v179
    v_max3_f32 v27, v27, v186, v187
    v_max3_f32 v26, v26, v180, v181
    v_max3_f32 v27, v27, v188, v189
    v_mfma_f32_16x16x32_bf16 v[92:95], a[236:239], a[44:47], v[92:95]
    v_add_u32 v31, 4, v31
    v_max3_f32 v26, v26, v182, v183
    v_max3_f32 v27, v27, v190, v191
    v_mul_f32 v28, s56, v26
    v_mul_f32 v29, s56, v27
    s_waitcnt lgkmcnt(5)
    v_mfma_f32_16x16x32_bf16 v[208:211], a[240:243], a[32:35], v[208:211]
    ds_read_b128 a[232:235], v10 offset:59392
    v_ceil_f32 v28, v28
    v_ceil_f32 v29, v29
    v_accvgpr_write_b32 a118, v28
    v_accvgpr_write_b32 a119, v29
    v_fma_f32 v176, v176, s56, -v28
    v_mfma_f32_16x16x32_bf16 v[216:219], a[240:243], a[36:39], v[216:219]
    v_fma_f32 v177, v177, s56, -v28
    v_exp_f32 v176, v176
    v_fma_f32 v178, v178, s56, -v28
    v_exp_f32 v177, v177
    v_mfma_f32_16x16x32_bf16 v[208:211], a[244:247], a[40:43], v[208:211]
    ds_read_b128 a[236:239], v11 offset:59392
    v_fma_f32 v179, v179, s56, -v28
    v_exp_f32 v178, v178
    v_fma_f32 v180, v180, s56, -v28
    v_mfma_f32_16x16x32_bf16 v[216:219], a[244:247], a[44:47], v[216:219]
    v_exp_f32 v179, v179
    v_fma_f32 v181, v181, s56, -v28
    v_exp_f32 v180, v180
    s_waitcnt lgkmcnt(5)
    v_mfma_f32_16x16x32_bf16 v[212:215], a[248:251], a[32:35], v[212:215]
    ds_read_b128 a[240:243], v10 offset:61440
    v_fma_f32 v182, v182, s56, -v28
    v_exp_f32 v181, v181
    v_fma_f32 v183, v183, s56, -v28
    v_exp_f32 v182, v182
    v_mfma_f32_16x16x32_bf16 v[220:223], a[248:251], a[36:39], v[220:223]
    v_exp_f32 v183, v183
    v_cvt_pk_bf16_f32 v56, v176, v177
    v_cvt_pk_bf16_f32 v57, v178, v179
    v_mfma_f32_16x16x32_bf16 v[212:215], a[252:255], a[40:43], v[212:215]
    ds_read_b128 a[244:247], v11 offset:61440
    v_cvt_pk_bf16_f32 v58, v180, v181
    v_cvt_pk_bf16_f32 v59, v182, v183
    v_fma_f32 v184, v184, s56, -v29
    v_fma_f32 v185, v185, s56, -v29
    v_exp_f32 v184, v184
    v_mfma_f32_16x16x32_bf16 v[220:223], a[252:255], a[44:47], v[220:223]
    v_fma_f32 v186, v186, s56, -v29
    v_exp_f32 v185, v185
    v_fma_f32 v187, v187, s56, -v29
    s_waitcnt lgkmcnt(4)
    v_mfma_f32_16x16x32_bf16 v[96:99], a[224:227], a[32:35], v[96:99]
    ds_read_b128 a[248:251], v10 offset:63488
    v_exp_f32 v186, v186
    v_fma_f32 v188, v188, s56, -v29
    v_exp_f32 v187, v187
    v_mfma_f32_16x16x32_bf16 v[104:107], a[224:227], a[36:39], v[104:107]
    v_fma_f32 v189, v189, s56, -v29
    v_exp_f32 v188, v188
    v_fma_f32 v190, v190, s56, -v29
    v_exp_f32 v189, v189
    v_mfma_f32_16x16x32_bf16 v[96:99], a[228:231], a[40:43], v[96:99]
    ds_read_b128 a[252:255], v11 offset:63488
    v_fma_f32 v191, v191, s56, -v29
    v_exp_f32 v190, v190
    v_exp_f32 v191, v191
    v_mfma_f32_16x16x32_bf16 v[104:107], a[228:231], a[44:47], v[104:107]
    v_cvt_pk_bf16_f32 v60, v184, v185
    v_cvt_pk_bf16_f32 v61, v186, v187
    v_cvt_pk_bf16_f32 v62, v188, v189
    v_cvt_pk_bf16_f32 v63, v190, v191
    s_waitcnt lgkmcnt(4)
    v_mfma_f32_16x16x32_bf16 v[100:103], a[232:235], a[32:35], v[100:103]
    ds_read_b128 a[224:227], v10 offset:8192
    v_max3_f32 v26, v26, v64, v65
    v_max3_f32 v27, v27, v72, v73
    v_max3_f32 v26, v26, v66, v67
    v_max3_f32 v27, v27, v74, v75
    v_max3_f32 v26, v26, v68, v69
    v_mfma_f32_16x16x32_bf16 v[108:111], a[232:235], a[36:39], v[108:111]
    v_max3_f32 v27, v27, v76, v77
    v_max3_f32 v26, v26, v70, v71
    v_max3_f32 v27, v27, v78, v79
    v_max3_f32 v26, v26, v192, v193
    v_max3_f32 v27, v27, v200, v201
    v_mfma_f32_16x16x32_bf16 v[100:103], a[236:239], a[40:43], v[100:103]
    ds_read_b128 a[228:231], v11 offset:8192
    v_max3_f32 v26, v26, v194, v195
    v_max3_f32 v27, v27, v202, v203
    v_max3_f32 v26, v26, v196, v197
    v_max3_f32 v27, v27, v204, v205
    v_max3_f32 v26, v26, v198, v199
    v_mfma_f32_16x16x32_bf16 v[108:111], a[236:239], a[44:47], v[108:111]
    v_max3_f32 v27, v27, v206, v207
    v_max3_f32 v26, v26, v80, v81
    v_max3_f32 v27, v27, v88, v89
    v_max3_f32 v26, v26, v82, v83
    v_max3_f32 v27, v27, v90, v91
    s_waitcnt lgkmcnt(4)
    v_mfma_f32_16x16x32_bf16 v[224:227], a[240:243], a[32:35], v[224:227]
    ds_read_b128 a[232:235], v10 offset:10240
    v_max3_f32 v26, v26, v84, v85
    v_max3_f32 v27, v27, v92, v93
    v_max3_f32 v26, v26, v86, v87
    v_max3_f32 v27, v27, v94, v95
    v_max3_f32 v26, v26, v208, v209
    v_mfma_f32_16x16x32_bf16 v[232:235], a[240:243], a[36:39], v[232:235]
    v_max3_f32 v27, v27, v216, v217
    v_max3_f32 v26, v26, v210, v211
    v_max3_f32 v27, v27, v218, v219
    v_max3_f32 v26, v26, v212, v213
    v_max3_f32 v27, v27, v220, v221
    v_mfma_f32_16x16x32_bf16 v[224:227], a[244:247], a[40:43], v[224:227]
    ds_read_b128 a[236:239], v11 offset:10240
    v_max3_f32 v26, v26, v214, v215
    v_max3_f32 v27, v27, v222, v223
    v_max3_f32 v26, v26, v96, v97
    v_max3_f32 v27, v27, v104, v105
    v_max3_f32 v26, v26, v98, v99
    v_mfma_f32_16x16x32_bf16 v[232:235], a[244:247], a[44:47], v[232:235]
    ds_read_b32 v1, v31 offset:4
    v_max3_f32 v27, v27, v106, v107
    v_max3_f32 v26, v26, v100, v101
    v_max3_f32 v27, v27, v108, v109
    v_max3_f32 v26, v26, v102, v103
    s_waitcnt lgkmcnt(5)
    v_mfma_f32_16x16x32_bf16 v[228:231], a[248:251], a[32:35], v[228:231]
    ds_read_b128 a[240:243], v10 offset:12288
    v_max3_f32 v27, v27, v110, v111
    v_mfma_f32_16x16x32_bf16 v[236:239], a[248:251], a[36:39], v[236:239]
    v_mfma_f32_16x16x32_bf16 v[228:231], a[252:255], a[40:43], v[228:231]
    ds_read_b128 a[244:247], v11 offset:12288
    v_mfma_f32_16x16x32_bf16 v[236:239], a[252:255], a[44:47], v[236:239]
    s_waitcnt lgkmcnt(5)
    v_mfma_f32_16x16x32_bf16 v[112:115], a[224:227], a[32:35], v[112:115]
    ds_read_b128 a[248:251], v10 offset:14336
    v_mfma_f32_16x16x32_bf16 v[120:123], a[224:227], a[36:39], v[120:123]
    s_waitcnt lgkmcnt(3)
    v_cmp_ne_u32 vcc, 0, v1
    v_mfma_f32_16x16x32_bf16 v[112:115], a[228:231], a[40:43], v[112:115]
    ds_read_b128 a[252:255], v11 offset:14336
    v_max3_f32 v26, v26, v224, v225
    v_max3_f32 v27, v27, v232, v233
    v_max3_f32 v26, v26, v226, v227
    v_max3_f32 v27, v27, v234, v235
    v_max3_f32 v26, v26, v228, v229
    v_mfma_f32_16x16x32_bf16 v[120:123], a[228:231], a[44:47], v[120:123]
    ds_write_b32 v2, v31
    v_max3_f32 v27, v27, v236, v237
    v_max3_f32 v26, v26, v230, v231
    v_max3_f32 v27, v27, v238, v239
    v_mfma_f32_16x16x32_bf16 v[116:119], a[232:235], a[32:35], v[116:119]
    s_getpc_b64 s[62:63]
    s_cbranch_vccnz L_cslow
    v_mfma_f32_16x16x32_bf16 v[124:127], a[232:235], a[36:39], v[124:127]
    ds_read_b128 a[224:227], v12 offset:0
    v_mfma_f32_16x16x32_bf16 v[116:119], a[236:239], a[40:43], v[116:119]
    ds_read_b128 a[228:231], v13 offset:0
    v_mfma_f32_16x16x32_bf16 v[124:127], a[236:239], a[44:47], v[124:127]
    v_add_u32 v31, 4, v31
    s_waitcnt lgkmcnt(5)
    v_mfma_f32_16x16x32_bf16 v[240:243], a[240:243], a[32:35], v[240:243]
    ds_read_b128 a[232:235], v12 offset:2048
    v_mfma_f32_16x16x32_bf16 v[248:251], a[240:243], a[36:39], v[248:251]
    v_mfma_f32_16x16x32_bf16 v[240:243], a[244:247], a[40:43], v[240:243]
    ds_read_b128 a[236:239], v13 offset:2048
    v_max3_f32 v26, v26, v112, v113
    v_max3_f32 v27, v27, v120, v121
    v_max3_f32 v26, v26, v114, v115
    v_max3_f32 v27, v27, v122, v123
    v_max3_f32 v26, v26, v116, v117
    v_mfma_f32_16x16x32_bf16 v[248:251], a[244:247], a[44:47], v[248:251]
    v_max3_f32 v27, v27, v124, v125
    v_max3_f32 v26, v26, v118, v119
    v_max3_f32 v27, v27, v126, v127
    s_waitcnt lgkmcnt(5)
    v_mfma_f32_16x16x32_bf16 v[244:247], a[248:251], a[32:35], v[244:247]
    ds_read_b128 a[240:243], v12 offset:4096
    v_mfma_f32_16x16x32_bf16 v[252:255], a[248:251], a[36:39], v[252:255]
    v_mfma_f32_16x16x32_bf16 v[244:247], a[252:255], a[40:43], v[244:247]
    ds_read_b128 a[244:247], v13 offset:4096
    v_mfma_f32_16x16x32_bf16 v[252:255], a[252:255], a[44:47], v[252:255]
    s_waitcnt lgkmcnt(4)
    v_mfma_f32_16x16x32_bf16 v[128:131], a[224:227], a[32:35], v[128:131]
    ds_read_b128 a[248:251], v12 offset:6144
    v_mfma_f32_16x16x32_bf16 v[136:139], a[224:227], a[36:39], v[136:139]
    v_mfma_f32_16x16x32_bf16 v[128:131], a[228:231], a[40:43], v[128:131]
    ds_read_b128 a[252:255], v13 offset:6144
    v_max3_f32 v26, v26, v240, v241
    v_max3_f32 v27, v27, v248, v249
    v_max3_f32 v26, v26, v242, v243
    v_max3_f32 v27, v27, v250, v251
    v_max3_f32 v26, v26, v244, v245
    v_mfma_f32_16x16x32_bf16 v[136:139], a[228:231], a[44:47], v[136:139]
    v_max3_f32 v27, v27, v252, v253
    v_max3_f32 v26, v26, v246, v247
    v_max3_f32 v27, v27, v254, v255
    s_waitcnt lgkmcnt(4)
    v_mfma_f32_16x16x32_bf16 v[132:135], a[232:235], a[32:35], v[132:135]
    ds_read_b128 a[224:227], v10 offset:24576
    v_mfma_f32_16x16x32_bf16 v[140:143], a[232:235], a[36:39], v[140:143]
    v_mfma_f32_16x16x32_bf16 v[132:135], a[236:239], a[40:43], v[132:135]
    ds_read_b128 a[228:231], v11 offset:24576
    v_mfma_f32_16x16x32_bf16 v[140:143], a[236:239], a[44:47], v[140:143]
    s_waitcnt lgkmcnt(4)
    v_mfma_f32_16x16x32_bf16 a[64:67], a[240:243], a[32:35], a[64:67]
    ds_read_b128 a[232:235], v10 offset:26624
    v_mfma_f32_16x16x32_bf16 a[72:75], a[240:243], a[36:39], a[72:75]
    v_mfma_f32_16x16x32_bf16 a[64:67], a[244:247], a[40:43], a[64:67]
    ds_read_b128 a[236:239], v11 offset:26624
    v_max3_f32 v26, v26, v128, v129
    v_max3_f32 v27, v27, v136, v137
    v_max3_f32 v26, v26, v130, v131
    v_max3_f32 v27, v27, v138, v139
    v_max3_f32 v26, v26, v132, v133
    v_mfma_f32_16x16x32_bf16 a[72:75], a[244:247], a[44:47], a[72:75]
    ds_read_b32 v1, v31 offset:4
    v_max3_f32 v27, v27, v140, v141
    v_max3_f32 v26, v26, v134, v135
    v_max3_f32 v27, v27, v142, v143
    s_waitcnt lgkmcnt(5)
    v_mfma_f32_16x16x32_bf16 a[68:71], a[248:251], a[32:35], a[68:71]
    ds_read_b128 a[240:243], v10 offset:28672
    v_mfma_f32_16x16x32_bf16 a[76:79], a[248:251], a[36:39], a[76:79]
    v_mfma_f32_16x16x32_bf16 a[68:71], a[252:255], a[40:43], a[68:71]
    ds_read_b128 a[244:247], v11 offset:28672
    v_mfma_f32_16x16x32_bf16 a[76:79], a[252:255], a[44:47], a[76:79]
    s_waitcnt lgkmcnt(5)
    v_mfma_f32_16x16x32_bf16 v[144:147], a[224:227], a[32:35], v[144:147]
    ds_read_b128 a[248:251], v10 offset:30720
    v_mfma_f32_16x16x32_bf16 v[152:155], a[224:227], a[36:39], v[152:155]
    s_waitcnt lgkmcnt(3)
    v_cmp_ne_u32 vcc, 0, v1
    v_mfma_f32_16x16x32_bf16 v[144:147], a[228:231], a[40:43], v[144:147]
    ds_read_b128 a[252:255], v11 offset:30720
    v_accvgpr_read_b32 v160, a64
    v_accvgpr_read_b32 v161, a65
    v_max3_f32 v26, v26, v160, v161
    v_accvgpr_read_b32 v168, a72
    v_accvgpr_read_b32 v169, a73
    v_mfma_f32_16x16x32_bf16 v[152:155], a[228:231], a[44:47], v[152:155]
    ds_write_b32 v2, v31
    v_max3_f32 v27, v27, v168, v169
    v_accvgpr_read_b32 v162, a66
    v_accvgpr_read_b32 v163, a67
    v_max3_f32 v26, v26, v162, v163
    v_mfma_f32_16x16x32_bf16 v[148:151], a[232:235], a[32:35], v[148:151]
    s_getpc_b64 s[62:63]
    s_cbranch_vccnz L_cslow
    v_accvgpr_read_b32 v170, a74
    v_accvgpr_read_b32 v171, a75
    v_max3_f32 v27, v27, v170, v171
    v_accvgpr_read_b32 v164, a68
    v_mfma_f32_16x16x32_bf16 v[156:159], a[232:235], a[36:39], v[156:159]
    ds_read_b64_tr_b16 a[224:225], v18 offset:32768
    ds_read_b64_tr_b16 a[226:227], v18 offset:34816
    v_accvgpr_read_b32 v165, a69
    v_max3_f32 v26, v26, v164, v165
    v_accvgpr_read_b32 v172, a76
    v_accvgpr_read_b32 v173, a77
    v_mfma_f32_16x16x32_bf16 v[148:151], a[236:239], a[40:43], v[148:151]
    ds_read_b64_tr_b16 a[228:229], v19 offset:32768
    ds_read_b64_tr_b16 a[230:231], v19 offset:34816
    v_max3_f32 v27, v27, v172, v173
    v_accvgpr_read_b32 v166, a70
    v_accvgpr_read_b32 v167, a71
    v_max3_f32 v26, v26, v166, v167
    v_mfma_f32_16x16x32_bf16 v[156:159], a[236:239], a[44:47], v[156:159]
    v_add_u32 v31, 4, v31
    v_accvgpr_read_b32 v174, a78
    v_accvgpr_read_b32 v175, a79
    v_max3_f32 v27, v27, v174, v175
    s_waitcnt lgkmcnt(7)
    v_mfma_f32_16x16x32_bf16 a[80:83], a[240:243], a[32:35], a[80:83]
    ds_read_b64_tr_b16 a[232:233], v20 offset:32768
    v_mfma_f32_16x16x32_bf16 a[88:91], a[240:243], a[36:39], a[88:91]
    ds_read_b64_tr_b16 a[234:235], v20 offset:34816
    v_mfma_f32_16x16x32_bf16 a[80:83], a[244:247], a[40:43], a[80:83]
    ds_read_b64_tr_b16 a[236:237], v21 offset:32768
    v_max3_f32 v26, v26, v144, v145
    v_max3_f32 v27, v27, v152, v153
    v_max3_f32 v26, v26, v146, v147
    v_max3_f32 v27, v27, v154, v155
    v_max3_f32 v26, v26, v148, v149
    v_mfma_f32_16x16x32_bf16 a[88:91], a[244:247], a[44:47], a[88:91]
    ds_read_b64_tr_b16 a[238:239], v21 offset:34816
    v_max3_f32 v27, v27, v156, v157
    v_max3_f32 v26, v26, v150, v151
    v_max3_f32 v27, v27, v158, v159
    s_waitcnt lgkmcnt(9)
    v_mfma_f32_16x16x32_bf16 a[84:87], a[248:251], a[32:35], a[84:87]
    ds_read_b64_tr_b16 a[240:241], v18 offset:36864
    v_mfma_f32_16x16x32_bf16 a[92:95], a[248:251], a[36:39], a[92:95]
    ds_read_b64_tr_b16 a[242:243], v18 offset:38912
    v_mfma_f32_16x16x32_bf16 a[84:87], a[252:255], a[40:43], a[84:87]
    ds_read_b64_tr_b16 a[244:245], v19 offset:36864
    v_mfma_f32_16x16x32_bf16 a[92:95], a[252:255], a[44:47], a[92:95]
    ds_read_b64_tr_b16 a[246:247], v19 offset:38912
    v_accvgpr_read_b32 v176, a80
    v_accvgpr_read_b32 v177, a81
    v_max3_f32 v26, v26, v176, v177
    v_accvgpr_read_b32 v184, a88
    v_accvgpr_read_b32 v185, a89
    v_max3_f32 v27, v27, v184, v185
    v_accvgpr_read_b32 v178, a82
    v_accvgpr_read_b32 v179, a83
    v_max3_f32 v26, v26, v178, v179
    v_accvgpr_read_b32 v186, a90
    v_accvgpr_read_b32 v187, a91
    v_max3_f32 v27, v27, v186, v187
    v_accvgpr_read_b32 v180, a84
    v_accvgpr_read_b32 v181, a85
    v_max3_f32 v26, v26, v180, v181
    v_accvgpr_read_b32 v188, a92
    v_accvgpr_read_b32 v189, a93
    v_max3_f32 v27, v27, v188, v189
    v_accvgpr_read_b32 v182, a86
    v_accvgpr_read_b32 v183, a87
    v_max3_f32 v26, v26, v182, v183
    v_accvgpr_read_b32 v190, a94
    v_accvgpr_read_b32 v191, a95
    v_max3_f32 v27, v27, v190, v191
    v_add_u32 v8, 14336, v30
    v_accvgpr_read_b32 v6, a112
    v_permlane16_swap_b32 v26, v27
    v_max_f32 v26, v26, v27
    v_mov_b32 v27, v26
    v_accvgpr_read_b32 v7, a113
    s_nop 0
    v_permlane32_swap_b32 v26, v27
    v_max_f32 v26, v26, v27
    v_mul_f32 v26, s56, v26
    v_ceil_f32 v28, v26
    v_ceil_f32 v29, v26
    s_nop 1
    v_permlane16_swap_b32 v28, v29
    v_sub_f32 v6, v28, v6
    v_sub_f32 v7, v29, v7
    v_cvt_u32_f32 v6, v6
    v_cvt_u32_f32 v7, v7
    v_min_u32 v6, 255, v6
    v_min_u32 v7, 255, v7
    v_mul_u32_u24 v6, s57, v6
    v_mul_u32_u24 v7, s57, v7
    v_pk_sub_u16 v32, v32, v6 clamp
    v_pk_sub_u16 v33, v33, v6 clamp
    v_pk_sub_u16 v34, v34, v6 clamp
    v_pk_sub_u16 v35, v35, v6 clamp
    v_pk_sub_u16 v36, v36, v7 clamp
    v_pk_sub_u16 v37, v37, v7 clamp
    v_pk_sub_u16 v38, v38, v7 clamp
    v_mfma_f32_16x16x32_bf16 a[100:103], a[108:111], v[32:35], 0
    v_pk_sub_u16 v39, v39, v7 clamp
    s_waitcnt lgkmcnt(8)
    v_mfma_f32_16x16x32_bf16 a[0:3], a[224:227], v[32:35], 0
    ds_read_b64_tr_b16 a[248:249], v20 offset:36864
    v_mfma_f32_16x16x32_bf16 a[8:11], a[224:227], v[36:39], 0
    ds_read_b64_tr_b16 a[250:251], v20 offset:38912
    v_mfma_f32_16x16x32_bf16 a[4:7], a[228:231], v[32:35], 0
    ds_read_b64_tr_b16 a[252:253], v21 offset:36864
    v_accvgpr_read_b32 v6, a114
    v_accvgpr_read_b32 v7, a115
    v_sub_f32 v6, v28, v6
    v_mfma_f32_16x16x32_bf16 a[104:107], a[108:111], v[36:39], 0
    v_sub_f32 v7, v29, v7
    v_cvt_u32_f32 v6, v6
    v_cvt_u32_f32 v7, v7
    v_min_u32 v6, 255, v6
    v_min_u32 v7, 255, v7
    v_mfma_f32_16x16x32_bf16 a[12:15], a[228:231], v[36:39], 0
    ds_read_b64_tr_b16 a[254:255], v21 offset:38912
    v_mul_u32_u24 v6, s57, v6
    v_mul_u32_u24 v7, s57, v7
    v_pk_sub_u16 v40, v40, v6 clamp
    v_pk_sub_u16 v41, v41, v6 clamp
    s_waitcnt lgkmcnt(8)
    v_mfma_f32_16x16x32_bf16 a[16:19], a[232:235], v[32:35], 0
    ds_read_b64_tr_b16 a[224:225], v14 offset:8192
    v_pk_sub_u16 v42, v42, v6 clamp
    v_pk_sub_u16 v43, v43, v6 clamp
    v_pk_sub_u16 v44, v44, v7 clamp
    v_pk_sub_u16 v45, v45, v7 clamp
    v_pk_sub_u16 v46, v46, v7 clamp
    v_mfma_f32_16x16x32_bf16 a[100:103], a[108:111], v[40:43], a[100:103]
    v_pk_sub_u16 v47, v47, v7 clamp
    v_accvgpr_read_b32 v6, a116
    v_accvgpr_read_b32 v7, a117
    v_sub_f32 v6, v28, v6
    v_mfma_f32_16x16x32_bf16 a[104:107], a[108:111], v[44:47], a[104:107]
    v_sub_f32 v7, v29, v7
    v_cvt_u32_f32 v6, v6
    v_cvt_u32_f32 v7, v7
    v_min_u32 v6, 255, v6
    v_min_u32 v7, 255, v7
    v_mfma_f32_16x16x32_bf16 a[24:27], a[232:235], v[36:39], 0
    ds_read_b64_tr_b16 a[226:227], v14 offset:10240
    v_mul_u32_u24 v6, s57, v6
    v_mul_u32_u24 v7, s57, v7
    v_pk_sub_u16 v48, v48, v6 clamp
    v_pk_sub_u16 v49, v49, v6 clamp
    v_pk_sub_u16 v50, v50, v6 clamp
    v_mfma_f32_16x16x32_bf16 a[20:23], a[236:239], v[32:35], 0
    ds_read_b64_tr_b16 a[228:229], v15 offset:8192
    v_pk_sub_u16 v51, v51, v6 clamp
    v_pk_sub_u16 v52, v52, v7 clamp
    v_pk_sub_u16 v53, v53, v7 clamp
    v_pk_sub_u16 v54, v54, v7 clamp
    v_mfma_f32_16x16x32_bf16 a[100:103], a[108:111], v[48:51], a[100:103]
    v_pk_sub_u16 v55, v55, v7 clamp
    v_accvgpr_read_b32 v6, a118
    v_accvgpr_read_b32 v7, a119
    v_sub_f32 v6, v28, v6
    v_mfma_f32_16x16x32_bf16 a[104:107], a[108:111], v[52:55], a[104:107]
    v_sub_f32 v7, v29, v7
    v_cvt_u32_f32 v6, v6
    v_cvt_u32_f32 v7, v7
    v_min_u32 v6, 255, v6
    v_min_u32 v7, 255, v7
    v_mfma_f32_16x16x32_bf16 a[28:31], a[236:239], v[36:39], 0
    ds_read_b64_tr_b16 a[230:231], v15 offset:10240
    v_mul_u32_u24 v6, s57, v6
    v_mul_u32_u24 v7, s57, v7
    v_pk_sub_u16 v56, v56, v6 clamp
    v_pk_sub_u16 v57, v57, v6 clamp
    s_waitcnt lgkmcnt(8)
    v_mfma_f32_16x16x32_bf16 a[0:3], a[240:243], v[40:43], a[0:3]
    ds_read_b64_tr_b16 a[232:233], v16 offset:8192
    v_pk_sub_u16 v58, v58, v6 clamp
    v_pk_sub_u16 v59, v59, v6 clamp
    v_pk_sub_u16 v60, v60, v7 clamp
    v_pk_sub_u16 v61, v61, v7 clamp
    v_pk_sub_u16 v62, v62, v7 clamp
    v_mfma_f32_16x16x32_bf16 a[100:103], a[108:111], v[56:59], a[100:103]
    v_pk_sub_u16 v63, v63, v7 clamp
    v_fma_f32 v64, v64, s56, -v28
    v_fma_f32 v65, v65, s56, -v28
    v_exp_f32 v64, v64
    v_mfma_f32_16x16x32_bf16 a[104:107], a[108:111], v[60:63], a[104:107]
    v_fma_f32 v66, v66, s56, -v28
    v_exp_f32 v65, v65
    v_fma_f32 v67, v67, s56, -v28
    v_exp_f32 v66, v66
    v_mfma_f32_16x16x32_bf16 a[8:11], a[240:243], v[44:47], a[8:11]
    ds_read_b64_tr_b16 a[234:235], v16 offset:10240
    v_fma_f32 v68, v68, s56, -v28
    v_exp_f32 v67, v67
    v_fma_f32 v69, v69, s56, -v28
    v_mfma_f32_16x16x32_bf16 a[4:7], a[244:247], v[40:43], a[4:7]
    ds_read_b64_tr_b16 a[236:237], v17 offset:8192
    ds_read_b64_tr_b16 a[238:239], v17 offset:10240
    v_exp_f32 v68, v68
    v_fma_f32 v70, v70, s56, -v28
    v_exp_f32 v69, v69
    v_mfma_f32_16x16x32_bf16 a[12:15], a[244:247], v[44:47], a[12:15]
    ds_read_b32 v1, v31 offset:4
    v_fma_f32 v71, v71, s56, -v28
    v_exp_f32 v70, v70
    s_waitcnt lgkmcnt(9)
    v_mfma_f32_16x16x32_bf16 a[16:19], a[248:251], v[40:43], a[16:19]
    ds_read_b64_tr_b16 a[240:241], v14 offset:12288
    v_exp_f32 v71, v71
    v_cvt_pk_bf16_f32 v64, v64, v65
    v_cvt_pk_bf16_f32 v65, v66, v67
    v_cvt_pk_bf16_f32 v66, v68, v69
    v_mfma_f32_16x16x32_bf16 a[24:27], a[248:251], v[44:47], a[24:27]
    ds_read_b64_tr_b16 a[242:243], v14 offset:14336
    v_cvt_pk_bf16_f32 v67, v70, v71
    v_fma_f32 v72, v72, s56, -v29
    v_fma_f32 v73, v73, s56, -v29
    v_exp_f32 v72, v72
    v_mfma_f32_16x16x32_bf16 a[20:23], a[252:255], v[40:43], a[20:23]
    ds_read_b64_tr_b16 a[244:245], v15 offset:12288
    v_fma_f32 v74, v74, s56, -v29
    v_exp_f32 v73, v73
    v_fma_f32 v75, v75, s56, -v29
    v_exp_f32 v74, v74
    v_mfma_f32_16x16x32_bf16 a[28:31], a[252:255], v[44:47], a[28:31]
    ds_read_b64_tr_b16 a[246:247], v15 offset:14336
    v_mfma_f32_16x16x32_bf16 a[100:103], a[108:111], v[64:67], a[100:103]
    v_fma_f32 v76, v76, s56, -v29
    v_exp_f32 v75, v75
    v_fma_f32 v77, v77, s56, -v29
    v_exp_f32 v76, v76
    s_waitcnt lgkmcnt(9)
    v_mfma_f32_16x16x32_bf16 a[0:3], a[224:227], v[48:51], a[0:3]
    ds_read_b64_tr_b16 a[248:249], v16 offset:12288
    v_fma_f32 v78, v78, s56, -v29
    v_exp_f32 v77, v77
    v_fma_f32 v79, v79, s56, -v29
    v_mfma_f32_16x16x32_bf16 a[8:11], a[224:227], v[52:55], a[8:11]
    ds_read_b64_tr_b16 a[250:251], v16 offset:14336
    s_waitcnt lgkmcnt(6)
    v_cmp_ne_u32 vcc, 0, v1
    v_exp_f32 v78, v78
    v_exp_f32 v79, v79
    v_mfma_f32_16x16x32_bf16 a[4:7], a[228:231], v[48:51], a[4:7]
    ds_read_b64_tr_b16 a[252:253], v17 offset:12288
    ds_read_b64_tr_b16 a[254:255], v17 offset:14336
    v_cvt_pk_bf16_f32 v68, v72, v73
    v_cvt_pk_bf16_f32 v69, v74, v75
    v_cvt_pk_bf16_f32 v70, v76, v77
    v_cvt_pk_bf16_f32 v71, v78, v79
    v_mfma_f32_16x16x32_bf16 a[12:15], a[228:231], v[52:55], a[12:15]
    ds_write_b32 v2, v31
    v_fma_f32 v192, v192, s56, -v28
    v_fma_f32 v193, v193, s56, -v28
    v_exp_f32 v192, v192
    v_mfma_f32_16x16x32_bf16 a[104:107], a[108:111], v[68:71], a[104:107]
    v_fma_f32 v194, v194, s56, -v28
    v_exp_f32 v193, v193
    v_fma_f32 v195, v195, s56, -v28
    v_exp_f32 v194, v194
    v_mfma_f32_16x16x32_bf16 a[16:19], a[232:235], v[48:51], a[16:19]
    s_getpc_b64 s[62:63]
    s_cbranch_vccnz L_cslow
    v_fma_f32 v196, v196, s56, -v28
    v_exp_f32 v195, v195
    v_mfma_f32_16x16x32_bf16 a[24:27], a[232:235], v[52:55], a[24:27]
    ds_read_b64_tr_b16 a[224:225], v18 offset:40960
    ds_read_b64_tr_b16 a[226:227], v18 offset:43008
    v_fma_f32 v197, v197, s56, -v28
    v_exp_f32 v196, v196
    v_fma_f32 v198, v198, s56, -v28
    v_mfma_f32_16x16x32_bf16 a[20:23], a[236:239], v[48:51], a[20:23]
    ds_read_b64_tr_b16 a[228:229], v19 offset:40960
    ds_read_b64_tr_b16 a[230:231], v19 offset:43008
    v_exp_f32 v197, v197
    v_fma_f32 v199, v199, s56, -v28
    v_exp_f32 v198, v198
    v_mfma_f32_16x16x32_bf16 a[28:31], a[236:239], v[52:55], a[28:31]
    v_add_u32 v31, 4, v31
    v_exp_f32 v199, v199
    v_cvt_pk_bf16_f32 v72, v192, v193
    s_waitcnt lgkmcnt(9)
    v_mfma_f32_16x16x32_bf16 a[0:3], a[240:243], v[56:59], a[0:3]
    ds_read_b64_tr_b16 a[232:233], v20 offset:40960
    v_cvt_pk_bf16_f32 v73, v194, v195
    v_cvt_pk_bf16_f32 v74, v196, v197
    v_cvt_pk_bf16_f32 v75, v198, v199
    v_fma_f32 v200, v200, s56, -v29
    v_fma_f32 v201, v201, s56, -v29
    v_mfma_f32_16x16x32_bf16 a[8:11], a[240:243], v[60:63], a[8:11]
    ds_read_b64_tr_b16 a[234:235], v20 offset:43008
    v_exp_f32 v200, v200
    v_fma_f32 v202, v202, s56, -v29
    v_exp_f32 v201, v201
    v_mfma_f32_16x16x32_bf16 a[4:7], a[244:247], v[56:59], a[4:7]
    ds_read_b64_tr_b16 a[236:237], v21 offset:40960
    v_fma_f32 v203, v203, s56, -v29
    v_exp_f32 v202, v202
    v_mfma_f32_16x16x32_bf16 a[100:103], a[108:111], v[72:75], a[100:103]
    v_fma_f32 v204, v204, s56, -v29
    v_exp_f32 v203, v203
    v_fma_f32 v205, v205, s56, -v29
    v_exp_f32 v204, v204
    v_mfma_f32_16x16x32_bf16 a[12:15], a[244:247], v[60:63], a[12:15]
    ds_read_b64_tr_b16 a[238:239], v21 offset:43008
    v_fma_f32 v206, v206, s56, -v29
    v_exp_f32 v205, v205
    s_waitcnt lgkmcnt(9)
    v_mfma_f32_16x16x32_bf16 a[16:19], a[248:251], v[56:59], a[16:19]
    ds_read_b64_tr_b16 a[240:241], v18 offset:45056
    v_fma_f32 v207, v207, s56, -v29
    v_exp_f32 v206, v206
    v_exp_f32 v207, v207
    v_mfma_f32_16x16x32_bf16 a[24:27], a[248:251], v[60:63], a[24:27]
    ds_read_b64_tr_b16 a[242:243], v18 offset:47104
    v_cvt_pk_bf16_f32 v76, v200, v201
    v_cvt_pk_bf16_f32 v77, v202, v203
    v_cvt_pk_bf16_f32 v78, v204, v205
    v_cvt_pk_bf16_f32 v79, v206, v207
    v_fma_f32 v80, v80, s56, -v28
    v_mfma_f32_16x16x32_bf16 a[20:23], a[252:255], v[56:59], a[20:23]
    ds_read_b64_tr_b16 a[244:245], v19 offset:45056
    v_fma_f32 v81, v81, s56, -v28
    v_exp_f32 v80, v80
    v_mfma_f32_16x16x32_bf16 a[104:107], a[108:111], v[76:79], a[104:107]
    v_fma_f32 v82, v82, s56, -v28
    v_exp_f32 v81, v81
    v_fma_f32 v83, v83, s56, -v28
    v_exp_f32 v82, v82
    v_mfma_f32_16x16x32_bf16 a[28:31], a[252:255], v[60:63], a[28:31]
    ds_read_b64_tr_b16 a[246:247], v19 offset:47104
    v_fma_f32 v84, v84, s56, -v28
    v_exp_f32 v83, v83
    s_waitcnt lgkmcnt(8)
    v_mfma_f32_16x16x32_bf16 a[0:3], a[224:227], v[64:67], a[0:3]
    ds_read_b64_tr_b16 a[248:249], v20 offset:45056
    v_fma_f32 v85, v85, s56, -v28
    v_exp_f32 v84, v84
    v_fma_f32 v86, v86, s56, -v28
    v_exp_f32 v85, v85
    v_mfma_f32_16x16x32_bf16 a[8:11], a[224:227], v[68:71], a[8:11]
    ds_read_b64_tr_b16 a[250:251], v20 offset:47104
    v_fma_f32 v87, v87, s56, -v28
    v_exp_f32 v86, v86
    v_exp_f32 v87, v87
    v_mfma_f32_16x16x32_bf16 a[4:7], a[228:231], v[64:67], a[4:7]
    ds_read_b64_tr_b16 a[252:253], v21 offset:45056
    v_cvt_pk_bf16_f32 v80, v80, v81
    v_cvt_pk_bf16_f32 v81, v82, v83
    v_cvt_pk_bf16_f32 v82, v84, v85
    v_cvt_pk_bf16_f32 v83, v86, v87
    v_mfma_f32_16x16x32_bf16 a[12:15], a[228:231], v[68:71], a[12:15]
    ds_read_b64_tr_b16 a[254:255], v21 offset:47104
    v_fma_f32 v88, v88, s56, -v29
    v_fma_f32 v89, v89, s56, -v29
    v_exp_f32 v88, v88
    s_waitcnt lgkmcnt(8)
    v_mfma_f32_16x16x32_bf16 a[16:19], a[232:235], v[64:67], a[16:19]
    ds_read_b64_tr_b16 a[224:225], v14 offset:49152
    v_fma_f32 v90, v90, s56, -v29
    v_exp_f32 v89, v89
    v_fma_f32 v91, v91, s56, -v29
    v_exp_f32 v90, v90
    v_mfma_f32_16x16x32_bf16 a[24:27], a[232:235], v[68:71], a[24:27]
    ds_read_b64_tr_b16 a[226:227], v14 offset:51200
    v_mfma_f32_16x16x32_bf16 a[100:103], a[108:111], v[80:83], a[100:103]
    v_fma_f32 v92, v92, s56, -v29
    v_exp_f32 v91, v91
    v_fma_f32 v93, v93, s56, -v29
    v_exp_f32 v92, v92
    v_mfma_f32_16x16x32_bf16 a[20:23], a[236:239], v[64:67], a[20:23]
    ds_read_b64_tr_b16 a[228:229], v15 offset:49152
    v_fma_f32 v94, v94, s56, -v29
    v_exp_f32 v93, v93
    v_fma_f32 v95, v95, s56, -v29
    v_mfma_f32_16x16x32_bf16 a[28:31], a[236:239], v[68:71], a[28:31]
    ds_read_b64_tr_b16 a[230:231], v15 offset:51200
    v_exp_f32 v94, v94
    v_exp_f32 v95, v95
    s_waitcnt lgkmcnt(8)
    v_mfma_f32_16x16x32_bf16 a[0:3], a[240:243], v[72:75], a[0:3]
    ds_read_b64_tr_b16 a[232:233], v16 offset:49152
    v_cvt_pk_bf16_f32 v84, v88, v89
    v_cvt_pk_bf16_f32 v85, v90, v91
    v_cvt_pk_bf16_f32 v86, v92, v93
    v_cvt_pk_bf16_f32 v87, v94, v95
    v_fma_f32 v208, v208, s56, -v28
    v_mfma_f32_16x16x32_bf16 a[8:11], a[240:243], v[76:79], a[8:11]
    ds_read_b64_tr_b16 a[234:235], v16 offset:51200
    v_fma_f32 v209, v209, s56, -v28
    v_exp_f32 v208, v208
    v_mfma_f32_16x16x32_bf16 a[104:107], a[108:111], v[84:87], a[104:107]
    v_fma_f32 v210, v210, s56, -v28
    v_exp_f32 v209, v209
    v_fma_f32 v211, v211, s56, -v28
    v_exp_f32 v210, v210
    v_mfma_f32_16x16x32_bf16 a[4:7], a[244:247], v[72:75], a[4:7]
    ds_read_b64_tr_b16 a[236:237], v17 offset:49152
    ds_read_b64_tr_b16 a[238:239], v17 offset:51200
    v_fma_f32 v212, v212, s56, -v28
    v_exp_f32 v211, v211
    v_mfma_f32_16x16x32_bf16 a[12:15], a[244:247], v[76:79], a[12:15]
    ds_read_b32 v1, v31 offset:4
    v_fma_f32 v213, v213, s56, -v28
    v_exp_f32 v212, v212
    v_fma_f32 v214, v214, s56, -v28
    s_waitcnt lgkmcnt(9)
    v_mfma_f32_16x16x32_bf16 a[16:19], a[248:251], v[72:75], a[16:19]
    ds_read_b64_tr_b16 a[240:241], v14 offset:53248
    v_exp_f32 v213, v213
    v_fma_f32 v215, v215, s56, -v28
    v_exp_f32 v214, v214
    v_mfma_f32_16x16x32_bf16 a[24:27], a[248:251], v[76:79], a[24:27]
    ds_read_b64_tr_b16 a[242:243], v14 offset:55296
    v_exp_f32 v215, v215
    v_cvt_pk_bf16_f32 v88, v208, v209
    v_cvt_pk_bf16_f32 v89, v210, v211
    v_cvt_pk_bf16_f32 v90, v212, v213
    v_mfma_f32_16x16x32_bf16 a[20:23], a[252:255], v[72:75], a[20:23]
    ds_read_b64_tr_b16 a[244:245], v15 offset:53248
    v_cvt_pk_bf16_f32 v91, v214, v215
    v_fma_f32 v216, v216, s56, -v29
    v_fma_f32 v217, v217, s56, -v29
    v_exp_f32 v216, v216
    v_mfma_f32_16x16x32_bf16 a[28:31], a[252:255], v[76:79], a[28:31]
    ds_read_b64_tr_b16 a[246:247], v15 offset:55296
    v_fma_f32 v218, v218, s56, -v29
    v_exp_f32 v217, v217
    v_fma_f32 v219, v219, s56, -v29
    s_waitcnt lgkmcnt(9)
    v_mfma_f32_16x16x32_bf16 a[0:3], a[224:227], v[80:83], a[0:3]
    ds_read_b64_tr_b16 a[248:249], v16 offset:53248
    v_exp_f32 v218, v218
    v_mfma_f32_16x16x32_bf16 a[100:103], a[108:111], v[88:91], a[100:103]
    v_fma_f32 v220, v220, s56, -v29
    v_exp_f32 v219, v219
    v_fma_f32 v221, v221, s56, -v29
    v_exp_f32 v220, v220
    v_mfma_f32_16x16x32_bf16 a[8:11], a[224:227], v[84:87], a[8:11]
    ds_read_b64_tr_b16 a[250:251], v16 offset:55296
    s_waitcnt lgkmcnt(6)
    v_cmp_ne_u32 vcc, 0, v1
    v_fma_f32 v222, v222, s56, -v29
    v_exp_f32 v221, v221
    v_mfma_f32_16x16x32_bf16 a[4:7], a[228:231], v[80:83], a[4:7]
    ds_read_b64_tr_b16 a[252:253], v17 offset:53248
    ds_read_b64_tr_b16 a[254:255], v17 offset:55296
    v_fma_f32 v223, v223, s56, -v29
    v_exp_f32 v222, v222
    v_exp_f32 v223, v223
    v_mfma_f32_16x16x32_bf16 a[12:15], a[228:231], v[84:87], a[12:15]
    ds_write_b32 v2, v31
    v_cvt_pk_bf16_f32 v92, v216, v217
    v_cvt_pk_bf16_f32 v93, v218, v219
    v_cvt_pk_bf16_f32 v94, v220, v221
    v_mfma_f32_16x16x32_bf16 a[16:19], a[232:235], v[80:83], a[16:19]
    s_getpc_b64 s[62:63]
    s_cbranch_vccnz L_cslow
    v_cvt_pk_bf16_f32 v95, v222, v223
    v_fma_f32 v96, v96, s56, -v28
    v_fma_f32 v97, v97, s56, -v28
    v_exp_f32 v96, v96
    v_mfma_f32_16x16x32_bf16 a[24:27], a[232:235], v[84:87], a[24:27]
    ds_read_b64_tr_b16 a[224:225], v14 offset:57344
    ds_read_b64_tr_b16 a[226:227], v14 offset:59392
    v_mfma_f32_16x16x32_bf16 a[104:107], a[108:111], v[92:95], a[104:107]
    v_fma_f32 v98, v98, s56, -v28
    v_exp_f32 v97, v97
    v_fma_f32 v99, v99, s56, -v28
    v_exp_f32 v98, v98
    v_mfma_f32_16x16x32_bf16 a[20:23], a[236:239], v[80:83], a[20:23]
    ds_read_b64_tr_b16 a[228:229], v15 offset:57344
    ds_read_b64_tr_b16 a[230:231], v15 offset:59392
    v_fma_f32 v100, v100, s56, -v28
    v_exp_f32 v99, v99
    v_mfma_f32_16x16x32_bf16 a[28:31], a[236:239], v[84:87], a[28:31]
    v_add_u32 v31, 4, v31
    v_fma_f32 v101, v101, s56, -v28
    v_exp_f32 v100, v100
    v_fma_f32 v102, v102, s56, -v28
    s_waitcnt lgkmcnt(9)
    v_mfma_f32_16x16x32_bf16 a[0:3], a[240:243], v[88:91], a[0:3]
    ds_read_b64_tr_b16 a[232:233], v16 offset:57344
    v_exp_f32 v101, v101
    v_fma_f32 v103, v103, s56, -v28
    v_exp_f32 v102, v102
    v_mfma_f32_16x16x32_bf16 a[8:11], a[240:243], v[92:95], a[8:11]
    ds_read_b64_tr_b16 a[234:235], v16 offset:59392
    v_exp_f32 v103, v103
    v_cvt_pk_bf16_f32 v96, v96, v97
    v_cvt_pk_bf16_f32 v97, v98, v99
    v_cvt_pk_bf16_f32 v98, v100, v101
    v_mfma_f32_16x16x32_bf16 a[4:7], a[244:247], v[88:91], a[4:7]
    ds_read_b64_tr_b16 a[236:237], v17 offset:57344
    v_cvt_pk_bf16_f32 v99, v102, v103
    v_fma_f32 v104, v104, s56, -v29
    v_fma_f32 v105, v105, s56, -v29
    v_exp_f32 v104, v104
    v_mfma_f32_16x16x32_bf16 a[12:15], a[244:247], v[92:95], a[12:15]
    ds_read_b64_tr_b16 a[238:239], v17 offset:59392
    v_fma_f32 v106, v106, s56, -v29
    v_exp_f32 v105, v105
    v_fma_f32 v107, v107, s56, -v29
    s_waitcnt lgkmcnt(9)
    v_mfma_f32_16x16x32_bf16 a[16:19], a[248:251], v[88:91], a[16:19]
    ds_read_b64_tr_b16 a[240:241], v14 offset:61440
    v_exp_f32 v106, v106
    v_mfma_f32_16x16x32_bf16 a[100:103], a[108:111], v[96:99], a[100:103]
    v_fma_f32 v108, v108, s56, -v29
    v_exp_f32 v107, v107
    v_fma_f32 v109, v109, s56, -v29
    v_exp_f32 v108, v108
    v_mfma_f32_16x16x32_bf16 a[24:27], a[248:251], v[92:95], a[24:27]
    ds_read_b64_tr_b16 a[242:243], v14 offset:63488
    v_fma_f32 v110, v110, s56, -v29
    v_exp_f32 v109, v109
    v_fma_f32 v111, v111, s56, -v29
    v_mfma_f32_16x16x32_bf16 a[20:23], a[252:255], v[88:91], a[20:23]
    ds_read_b64_tr_b16 a[244:245], v15 offset:61440
    v_exp_f32 v110, v110
    v_exp_f32 v111, v111
    v_cvt_pk_bf16_f32 v100, v104, v105
    v_mfma_f32_16x16x32_bf16 a[28:31], a[252:255], v[92:95], a[28:31]
    ds_read_b64_tr_b16 a[246:247], v15 offset:63488
    v_cvt_pk_bf16_f32 v101, v106, v107
    v_cvt_pk_bf16_f32 v102, v108, v109
    v_cvt_pk_bf16_f32 v103, v110, v111
    v_fma_f32 v224, v224, s56, -v28
    s_waitcnt lgkmcnt(8)
    v_mfma_f32_16x16x32_bf16 a[0:3], a[224:227], v[96:99], a[0:3]
    ds_read_b64_tr_b16 a[248:249], v16 offset:61440
    v_fma_f32 v225, v225, s56, -v28
    v_exp_f32 v224, v224
    v_mfma_f32_16x16x32_bf16 a[104:107], a[108:111], v[100:103], a[104:107]
    v_fma_f32 v226, v226, s56, -v28
    v_exp_f32 v225, v225
    v_fma_f32 v227, v227, s56, -v28
    v_exp_f32 v226, v226
    v_mfma_f32_16x16x32_bf16 a[8:11], a[224:227], v[100:103], a[8:11]
    ds_read_b64_tr_b16 a[250:251], v16 offset:63488
    v_fma_f32 v228, v228, s56, -v28
    v_exp_f32 v227, v227
    v_fma_f32 v229, v229, s56, -v28
    v_mfma_f32_16x16x32_bf16 a[4:7], a[228:231], v[96:99], a[4:7]
    ds_read_b64_tr_b16 a[252:253], v17 offset:61440
    v_exp_f32 v228, v228
    v_fma_f32 v230, v230, s56, -v28
    v_exp_f32 v229, v229
    v_mfma_f32_16x16x32_bf16 a[12:15], a[228:231], v[100:103], a[12:15]
    ds_read_b64_tr_b16 a[254:255], v17 offset:63488
    v_fma_f32 v231, v231, s56, -v28
    v_exp_f32 v230, v230
    v_exp_f32 v231, v231
    s_waitcnt lgkmcnt(8)
    v_mfma_f32_16x16x32_bf16 a[16:19], a[232:235], v[96:99], a[16:19]
    ds_read_b64_tr_b16 a[224:225], v18 offset:16384
    v_cvt_pk_bf16_f32 v104, v224, v225
    v_cvt_pk_bf16_f32 v105, v226, v227
    v_cvt_pk_bf16_f32 v106, v228, v229
    v_cvt_pk_bf16_f32 v107, v230, v231
    v_mfma_f32_16x16x32_bf16 a[24:27], a[232:235], v[100:103], a[24:27]
    ds_read_b64_tr_b16 a[226:227], v18 offset:18432
    v_fma_f32 v232, v232, s56, -v29
    v_fma_f32 v233, v233, s56, -v29
    v_exp_f32 v232, v232
    v_fma_f32 v234, v234, s56, -v29
    v_mfma_f32_16x16x32_bf16 a[20:23], a[236:239], v[96:99], a[20:23]
    ds_read_b64_tr_b16 a[228:229], v19 offset:16384
    v_exp_f32 v233, v233
    v_fma_f32 v235, v235, s56, -v29
    v_exp_f32 v234, v234
    v_mfma_f32_16x16x32_bf16 a[100:103], a[108:111], v[104:107], a[100:103]
    v_fma_f32 v236, v236, s56, -v29
    v_exp_f32 v235, v235
    v_fma_f32 v237, v237, s56, -v29
    v_exp_f32 v236, v236
    v_mfma_f32_16x16x32_bf16 a[28:31], a[236:239], v[100:103], a[28:31]
    ds_read_b64_tr_b16 a[230:231], v19 offset:18432
    v_fma_f32 v238, v238, s56, -v29
    v_exp_f32 v237, v237
    v_fma_f32 v239, v239, s56, -v29
    v_exp_f32 v238, v238
    v_exp_f32 v239, v239
    v_cvt_pk_bf16_f32 v108, v232, v233
    v_cvt_pk_bf16_f32 v109, v234, v235
    v_cvt_pk_bf16_f32 v110, v236, v237
    v_cvt_pk_bf16_f32 v111, v238, v239
    s_waitcnt lgkmcnt(8)
    v_mfma_f32_16x16x32_bf16 a[0:3], a[240:243], v[104:107], a[0:3]
    ds_read_b64_tr_b16 a[232:233], v20 offset:16384
    v_fma_f32 v112, v112, s56, -v28
    v_fma_f32 v113, v113, s56, -v28
    v_exp_f32 v112, v112
    v_mfma_f32_16x16x32_bf16 a[104:107], a[108:111], v[108:111], a[104:107]
    v_fma_f32 v114, v114, s56, -v28
    v_exp_f32 v113, v113
    v_fma_f32 v115, v115, s56, -v28
    v_exp_f32 v114, v114
    v_mfma_f32_16x16x32_bf16 a[8:11], a[240:243], v[108:111], a[8:11]
    ds_read_b64_tr_b16 a[234:235], v20 offset:18432
    v_fma_f32 v116, v116, s56, -v28
    v_exp_f32 v115, v115
    v_fma_f32 v117, v117, s56, -v28
    v_mfma_f32_16x16x32_bf16 a[4:7], a[244:247], v[104:107], a[4:7]
    ds_read_b64_tr_b16 a[236:237], v21 offset:16384
    ds_read_b64_tr_b16 a[238:239], v21 offset:18432
    v_exp_f32 v116, v116
    v_fma_f32 v118, v118, s56, -v28
    v_exp_f32 v117, v117
    v_mfma_f32_16x16x32_bf16 a[12:15], a[244:247], v[108:111], a[12:15]
    ds_read_b32 v1, v31 offset:4
    v_fma_f32 v119, v119, s56, -v28
    v_exp_f32 v118, v118
    s_waitcnt lgkmcnt(9)
    v_mfma_f32_16x16x32_bf16 a[16:19], a[248:251], v[104:107], a[16:19]
    ds_read_b64_tr_b16 a[240:241], v18 offset:20480
    v_exp_f32 v119, v119
    v_cvt_pk_bf16_f32 v112, v112, v113
    v_cvt_pk_bf16_f32 v113, v114, v115
    v_cvt_pk_bf16_f32 v114, v116, v117
    v_mfma_f32_16x16x32_bf16 a[24:27], a[248:251], v[108:111], a[24:27]
    ds_read_b64_tr_b16 a[242:243], v18 offset:22528
    v_cvt_pk_bf16_f32 v115, v118, v119
    v_fma_f32 v120, v120, s56, -v29
    v_fma_f32 v121, v121, s56, -v29
    v_exp_f32 v120, v120
    v_mfma_f32_16x16x32_bf16 a[20:23], a[252:255], v[104:107], a[20:23]
    ds_read_b64_tr_b16 a[244:245], v19 offset:20480
    v_fma_f32 v122, v122, s56, -v29
    v_exp_f32 v121, v121
    v_fma_f32 v123, v123, s56, -v29
    v_exp_f32 v122, v122
    v_mfma_f32_16x16x32_bf16 a[28:31], a[252:255], v[108:111], a[28:31]
    ds_read_b64_tr_b16 a[246:247], v19 offset:22528
    v_mfma_f32_16x16x32_bf16 a[100:103], a[108:111], v[112:115], a[100:103]
    v_fma_f32 v124, v124, s56, -v29
    v_exp_f32 v123, v123
    v_fma_f32 v125, v125, s56, -v29
    v_exp_f32 v124, v124
    v_fma_f32 v126, v126, s56, -v29
    v_exp_f32 v125, v125
    v_fma_f32 v127, v127, s56, -v29
    v_exp_f32 v126, v126
    v_exp_f32 v127, v127
    v_cvt_pk_bf16_f32 v116, v120, v121
    v_cvt_pk_bf16_f32 v117, v122, v123
    v_cvt_pk_bf16_f32 v118, v124, v125
    v_cvt_pk_bf16_f32 v119, v126, v127
    s_waitcnt lgkmcnt(9)
    v_mfma_f32_16x16x32_bf16 a[0:3], a[224:227], v[112:115], a[0:3]
    ds_read_b64_tr_b16 a[248:249], v20 offset:20480
    v_fma_f32 v240, v240, s56, -v28
    v_fma_f32 v241, v241, s56, -v28
    v_exp_f32 v240, v240
    v_mfma_f32_16x16x32_bf16 a[104:107], a[108:111], v[116:119], a[104:107]
    v_fma_f32 v242, v242, s56, -v28
    v_exp_f32 v241, v241
    v_fma_f32 v243, v243, s56, -v28
    v_exp_f32 v242, v242
    v_mfma_f32_16x16x32_bf16 a[8:11], a[224:227], v[116:119], a[8:11]
    ds_read_b64_tr_b16 a[250:251], v20 offset:22528
    s_waitcnt lgkmcnt(6)
    v_cmp_ne_u32 vcc, 0, v1
    v_fma_f32 v244, v244, s56, -v28
    v_exp_f32 v243, v243
    v_mfma_f32_16x16x32_bf16 a[4:7], a[228:231], v[112:115], a[4:7]
    ds_read_b64_tr_b16 a[252:253], v21 offset:20480
    ds_read_b64_tr_b16 a[254:255], v21 offset:22528
    v_fma_f32 v245, v245, s56, -v28
    v_exp_f32 v244, v244
    v_fma_f32 v246, v246, s56, -v28
    v_mfma_f32_16x16x32_bf16 a[12:15], a[228:231], v[116:119], a[12:15]
    ds_write_b32 v2, v31
    v_exp_f32 v245, v245
    v_fma_f32 v247, v247, s56, -v28
    v_exp_f32 v246, v246
    v_mfma_f32_16x16x32_bf16 a[16:19], a[232:235], v[112:115], a[16:19]
    s_getpc_b64 s[62:63]
    s_cbranch_vccnz L_cslow
    v_exp_f32 v247, v247
    v_cvt_pk_bf16_f32 v120, v240, v241
    v_mfma_f32_16x16x32_bf16 a[24:27], a[232:235], v[116:119], a[24:27]
    ds_read_b64_tr_b16 a[224:225], v22 offset:8192
    ds_read_b64_tr_b16 a[226:227], v22 offset:10240
    v_cvt_pk_bf16_f32 v121, v242, v243
    v_cvt_pk_bf16_f32 v122, v244, v245
    v_cvt_pk_bf16_f32 v123, v246, v247
    v_fma_f32 v248, v248, s56, -v29
    v_mfma_f32_16x16x32_bf16 a[20:23], a[236:239], v[112:115], a[20:23]
    ds_read_b64_tr_b16 a[228:229], v23 offset:8192
    ds_read_b64_tr_b16 a[230:231], v23 offset:10240
    v_fma_f32 v249, v249, s56, -v29
    v_exp_f32 v248, v248
    v_fma_f32 v250, v250, s56, -v29
    v_mfma_f32_16x16x32_bf16 a[28:31], a[236:239], v[116:119], a[28:31]
    v_add_u32 v31, 4, v31
    v_exp_f32 v249, v249
    v_fma_f32 v251, v251, s56, -v29
    v_exp_f32 v250, v250
    v_mfma_f32_16x16x32_bf16 a[100:103], a[108:111], v[120:123], a[100:103]
    v_fma_f32 v252, v252, s56, -v29
    v_exp_f32 v251, v251
    v_fma_f32 v253, v253, s56, -v29
    v_exp_f32 v252, v252
    v_fma_f32 v254, v254, s56, -v29
    v_exp_f32 v253, v253
    v_fma_f32 v255, v255, s56, -v29
    v_exp_f32 v254, v254
    v_exp_f32 v255, v255
    v_cvt_pk_bf16_f32 v124, v248, v249
    v_cvt_pk_bf16_f32 v125, v250, v251
    v_cvt_pk_bf16_f32 v126, v252, v253
    v_cvt_pk_bf16_f32 v127, v254, v255
    s_waitcnt lgkmcnt(9)
    v_mfma_f32_16x16x32_bf16 a[0:3], a[240:243], v[120:123], a[0:3]
    ds_read_b64_tr_b16 a[232:233], v24 offset:8192
    v_fma_f32 v128, v128, s56, -v28
    v_fma_f32 v129, v129, s56, -v28
    v_exp_f32 v128, v128
    v_mfma_f32_16x16x32_bf16 a[104:107], a[108:111], v[124:127], a[104:107]
    v_fma_f32 v130, v130, s56, -v28
    v_exp_f32 v129, v129
    v_fma_f32 v131, v131, s56, -v28
    v_exp_f32 v130, v130
    v_mfma_f32_16x16x32_bf16 a[8:11], a[240:243], v[124:127], a[8:11]
    ds_read_b64_tr_b16 a[234:235], v24 offset:10240
    v_fma_f32 v132, v132, s56, -v28
    v_exp_f32 v131, v131
    v_fma_f32 v133, v133, s56, -v28
    v_mfma_f32_16x16x32_bf16 a[4:7], a[244:247], v[120:123], a[4:7]
    ds_read_b64_tr_b16 a[236:237], v25 offset:8192
    v_exp_f32 v132, v132
    v_fma_f32 v134, v134, s56, -v28
    v_exp_f32 v133, v133
    v_mfma_f32_16x16x32_bf16 a[12:15], a[244:247], v[124:127], a[12:15]
    ds_read_b64_tr_b16 a[238:239], v25 offset:10240
    v_fma_f32 v135, v135, s56, -v28
    v_exp_f32 v134, v134
    v_exp_f32 v135, v135
    s_waitcnt lgkmcnt(9)
    v_mfma_f32_16x16x32_bf16 a[16:19], a[248:251], v[120:123], a[16:19]
    ds_read_b64_tr_b16 a[240:241], v22 offset:12288
    v_cvt_pk_bf16_f32 v128, v128, v129
    v_cvt_pk_bf16_f32 v129, v130, v131
    v_cvt_pk_bf16_f32 v130, v132, v133
    v_cvt_pk_bf16_f32 v131, v134, v135
    v_mfma_f32_16x16x32_bf16 a[24:27], a[248:251], v[124:127], a[24:27]
    ds_read_b64_tr_b16 a[242:243], v22 offset:14336
    v_fma_f32 v136, v136, s56, -v29
    v_fma_f32 v137, v137, s56, -v29
    v_exp_f32 v136, v136
    v_fma_f32 v138, v138, s56, -v29
    v_mfma_f32_16x16x32_bf16 a[20:23], a[252:255], v[120:123], a[20:23]
    ds_read_b64_tr_b16 a[244:245], v23 offset:12288
    v_exp_f32 v137, v137
    v_fma_f32 v139, v139, s56, -v29
    v_exp_f32 v138, v138
    v_mfma_f32_16x16x32_bf16 a[100:103], a[108:111], v[128:131], a[100:103]
    v_fma_f32 v140, v140, s56, -v29
    v_exp_f32 v139, v139
    v_fma_f32 v141, v141, s56, -v29
    v_exp_f32 v140, v140
    v_mfma_f32_16x16x32_bf16 a[28:31], a[252:255], v[124:127], a[28:31]
    ds_read_b64_tr_b16 a[246:247], v23 offset:14336
    v_fma_f32 v142, v142, s56, -v29
    v_exp_f32 v141, v141
    v_fma_f32 v143, v143, s56, -v29
    v_exp_f32 v142, v142
    v_exp_f32 v143, v143
    v_cvt_pk_bf16_f32 v132, v136, v137
    v_cvt_pk_bf16_f32 v133, v138, v139
    v_cvt_pk_bf16_f32 v134, v140, v141
    v_cvt_pk_bf16_f32 v135, v142, v143
    s_waitcnt lgkmcnt(8)
    v_mfma_f32_16x16x32_bf16 a[0:3], a[224:227], v[128:131], a[0:3]
    ds_read_b64_tr_b16 a[248:249], v24 offset:12288
    v_fma_f32 v160, v160, s56, -v28
    v_fma_f32 v161, v161, s56, -v28
    v_exp_f32 v160, v160
    v_mfma_f32_16x16x32_bf16 a[104:107], a[108:111], v[132:135], a[104:107]
    v_fma_f32 v162, v162, s56, -v28
    v_exp_f32 v161, v161
    v_fma_f32 v163, v163, s56, -v28
    v_exp_f32 v162, v162
    v_mfma_f32_16x16x32_bf16 a[8:11], a[224:227], v[132:135], a[8:11]
    ds_read_b64_tr_b16 a[250:251], v24 offset:14336
    v_fma_f32 v164, v164, s56, -v28
    v_exp_f32 v163, v163
    v_fma_f32 v165, v165, s56, -v28
    v_mfma_f32_16x16x32_bf16 a[4:7], a[228:231], v[128:131], a[4:7]
    ds_read_b64_tr_b16 a[252:253], v25 offset:12288
    v_exp_f32 v164, v164
    v_fma_f32 v166, v166, s56, -v28
    v_exp_f32 v165, v165
    v_mfma_f32_16x16x32_bf16 a[12:15], a[228:231], v[132:135], a[12:15]
    ds_read_b64_tr_b16 a[254:255], v25 offset:14336
    v_fma_f32 v167, v167, s56, -v28
    v_exp_f32 v166, v166
    v_exp_f32 v167, v167
    s_waitcnt lgkmcnt(8)
    v_mfma_f32_16x16x32_bf16 a[16:19], a[232:235], v[128:131], a[16:19]
    ds_read_b64_tr_b16 a[224:225], v14 offset:0
    v_cvt_pk_bf16_f32 v136, v160, v161
    v_cvt_pk_bf16_f32 v137, v162, v163
    v_cvt_pk_bf16_f32 v138, v164, v165
    v_cvt_pk_bf16_f32 v139, v166, v167
    v_mfma_f32_16x16x32_bf16 a[24:27], a[232:235], v[132:135], a[24:27]
    ds_read_b64_tr_b16 a[226:227], v14 offset:2048
    v_fma_f32 v168, v168, s56, -v29
    v_fma_f32 v169, v169, s56, -v29
    v_exp_f32 v168, v168
    v_fma_f32 v170, v170, s56, -v29
    v_mfma_f32_16x16x32_bf16 a[20:23], a[236:239], v[128:131], a[20:23]
    ds_read_b64_tr_b16 a[228:229], v15 offset:0
    v_exp_f32 v169, v169
    v_fma_f32 v171, v171, s56, -v29
    v_exp_f32 v170, v170
    v_mfma_f32_16x16x32_bf16 a[100:103], a[108:111], v[136:139], a[100:103]
    v_fma_f32 v172, v172, s56, -v29
    v_exp_f32 v171, v171
    v_fma_f32 v173, v173, s56, -v29
    v_exp_f32 v172, v172
    v_mfma_f32_16x16x32_bf16 a[28:31], a[236:239], v[132:135], a[28:31]
    ds_read_b64_tr_b16 a[230:231], v15 offset:2048
    v_fma_f32 v174, v174, s56, -v29
    v_exp_f32 v173, v173
    v_fma_f32 v175, v175, s56, -v29
    v_exp_f32 v174, v174
    v_exp_f32 v175, v175
    v_cvt_pk_bf16_f32 v140, v168, v169
    v_cvt_pk_bf16_f32 v141, v170, v171
    v_cvt_pk_bf16_f32 v142, v172, v173
    v_cvt_pk_bf16_f32 v143, v174, v175
    s_waitcnt lgkmcnt(8)
    v_mfma_f32_16x16x32_bf16 a[0:3], a[240:243], v[136:139], a[0:3]
    ds_read_b64_tr_b16 a[232:233], v14 offset:4096
    v_fma_f32 v144, v144, s56, -v28
    v_fma_f32 v145, v145, s56, -v28
    v_exp_f32 v144, v144
    v_mfma_f32_16x16x32_bf16 a[104:107], a[108:111], v[140:143], a[104:107]
    v_fma_f32 v146, v146, s56, -v28
    v_exp_f32 v145, v145
    v_fma_f32 v147, v147, s56, -v28
    v_exp_f32 v146, v146
    v_mfma_f32_16x16x32_bf16 a[8:11], a[240:243], v[140:143], a[8:11]
    ds_read_b64_tr_b16 a[234:235], v14 offset:6144
    v_fma_f32 v148, v148, s56, -v28
    v_exp_f32 v147, v147
    v_fma_f32 v149, v149, s56, -v28
    v_mfma_f32_16x16x32_bf16 a[4:7], a[244:247], v[136:139], a[4:7]
    ds_read_b64_tr_b16 a[236:237], v15 offset:4096
    ds_read_b64_tr_b16 a[238:239], v15 offset:6144
    v_exp_f32 v148, v148
    v_fma_f32 v150, v150, s56, -v28
    v_exp_f32 v149, v149
    v_mfma_f32_16x16x32_bf16 a[12:15], a[244:247], v[140:143], a[12:15]
    ds_read_b32 v1, v31 offset:4
    v_fma_f32 v151, v151, s56, -v28
    v_exp_f32 v150, v150
    s_waitcnt lgkmcnt(9)
    v_mfma_f32_16x16x32_bf16 a[16:19], a[248:251], v[136:139], a[16:19]
    ds_read_b64_tr_b16 a[240:241], v16 offset:0
    v_exp_f32 v151, v151
    v_cvt_pk_bf16_f32 v144, v144, v145
    v_cvt_pk_bf16_f32 v145, v146, v147
    v_cvt_pk_bf16_f32 v146, v148, v149
    v_mfma_f32_16x16x32_bf16 a[24:27], a[248:251], v[140:143], a[24:27]
    ds_read_b64_tr_b16 a[242:243], v16 offset:2048
    v_cvt_pk_bf16_f32 v147, v150, v151
    v_fma_f32 v152, v152, s56, -v29
    v_fma_f32 v153, v153, s56, -v29
    v_exp_f32 v152, v152
    v_mfma_f32_16x16x32_bf16 a[20:23], a[252:255], v[136:139], a[20:23]
    ds_read_b64_tr_b16 a[244:245], v17 offset:0
    v_fma_f32 v154, v154, s56, -v29
    v_exp_f32 v153, v153
    v_fma_f32 v155, v155, s56, -v29
    v_exp_f32 v154, v154
    v_mfma_f32_16x16x32_bf16 a[28:31], a[252:255], v[140:143], a[28:31]
    ds_read_b64_tr_b16 a[246:247], v17 offset:2048
    v_mfma_f32_16x16x32_bf16 a[100:103], a[108:111], v[144:147], a[100:103]
    v_fma_f32 v156, v156, s56, -v29
    v_exp_f32 v155, v155
    v_fma_f32 v157, v157, s56, -v29
    v_exp_f32 v156, v156
    v_fma_f32 v158, v158, s56, -v29
    v_exp_f32 v157, v157
    v_fma_f32 v159, v159, s56, -v29
    v_exp_f32 v158, v158
    v_exp_f32 v159, v159
    v_cvt_pk_bf16_f32 v148, v152, v153
    v_cvt_pk_bf16_f32 v149, v154, v155
    v_cvt_pk_bf16_f32 v150, v156, v157
    v_cvt_pk_bf16_f32 v151, v158, v159
    s_waitcnt lgkmcnt(9)
    v_mfma_f32_16x16x32_bf16 a[0:3], a[224:227], v[144:147], a[0:3]
    ds_read_b64_tr_b16 a[248:249], v16 offset:4096
    v_fma_f32 v176, v176, s56, -v28
    v_fma_f32 v177, v177, s56, -v28
    v_exp_f32 v176, v176
    v_mfma_f32_16x16x32_bf16 a[104:107], a[108:111], v[148:151], a[104:107]
    v_fma_f32 v178, v178, s56, -v28
    v_exp_f32 v177, v177
    v_fma_f32 v179, v179, s56, -v28
    v_exp_f32 v178, v178
    v_mfma_f32_16x16x32_bf16 a[8:11], a[224:227], v[148:151], a[8:11]
    ds_read_b64_tr_b16 a[250:251], v16 offset:6144
    s_waitcnt lgkmcnt(6)
    v_cmp_ne_u32 vcc, 0, v1
    v_fma_f32 v180, v180, s56, -v28
    v_exp_f32 v179, v179
    v_mfma_f32_16x16x32_bf16 a[4:7], a[228:231], v[144:147], a[4:7]
    ds_read_b64_tr_b16 a[252:253], v17 offset:4096
    ds_read_b64_tr_b16 a[254:255], v17 offset:6144
    v_fma_f32 v181, v181, s56, -v28
    v_exp_f32 v180, v180
    v_fma_f32 v182, v182, s56, -v28
    v_mfma_f32_16x16x32_bf16 a[12:15], a[228:231], v[148:151], a[12:15]
    ds_write_b32 v2, v31
    v_exp_f32 v181, v181
    v_fma_f32 v183, v183, s56, -v28
    v_exp_f32 v182, v182
    v_exp_f32 v183, v183
    v_cvt_pk_bf16_f32 v152, v176, v177
    v_cvt_pk_bf16_f32 v153, v178, v179
    v_cvt_pk_bf16_f32 v154, v180, v181
    v_cvt_pk_bf16_f32 v155, v182, v183
    v_fma_f32 v184, v184, s56, -v29
    v_fma_f32 v185, v185, s56, -v29
    v_exp_f32 v184, v184
    v_fma_f32 v186, v186, s56, -v29
    v_exp_f32 v185, v185
    v_fma_f32 v187, v187, s56, -v29
    v_exp_f32 v186, v186
    v_mfma_f32_16x16x32_bf16 a[100:103], a[108:111], v[152:155], a[100:103]
    v_fma_f32 v188, v188, s56, -v29
    v_exp_f32 v187, v187
    v_fma_f32 v189, v189, s56, -v29
    v_exp_f32 v188, v188
    v_fma_f32 v190, v190, s56, -v29
    v_exp_f32 v189, v189
    v_fma_f32 v191, v191, s56, -v29
    v_exp_f32 v190, v190
    v_exp_f32 v191, v191
    v_cvt_pk_bf16_f32 v156, v184, v185
    v_cvt_pk_bf16_f32 v157, v186, v187
    v_cvt_pk_bf16_f32 v158, v188, v189
    v_cvt_pk_bf16_f32 v159, v190, v191
    v_mfma_f32_16x16x32_bf16 a[0:3], a[232:235], v[152:155], a[0:3]
    s_getpc_b64 s[62:63]
    s_cbranch_vccnz L_cslow
    v_mfma_f32_16x16x32_bf16 a[104:107], a[108:111], v[156:159], a[104:107]
    v_mfma_f32_16x16x32_bf16 a[8:11], a[232:235], v[156:159], a[8:11]
    ds_read_b64_tr_b16 a[224:225], v14 offset:24576
    ds_read_b64_tr_b16 a[226:227], v14 offset:26624
    v_mfma_f32_16x16x32_bf16 a[4:7], a[236:239], v[152:155], a[4:7]
    ds_read_b64_tr_b16 a[228:229], v15 offset:24576
    ds_read_b64_tr_b16 a[230:231], v15 offset:26624
    v_accvgpr_read_b32 v26, a100
    v_mfma_f32_16x16x32_bf16 a[12:15], a[236:239], v[156:159], a[12:15]
    v_add_u32 v31, 4, v31
    v_accvgpr_read_b32 v27, a104
    s_waitcnt lgkmcnt(9)
    v_mfma_f32_16x16x32_bf16 a[16:19], a[240:243], v[144:147], a[16:19]
    ds_read_b64_tr_b16 a[232:233], v16 offset:24576
    v_rcp_f32 v26, v26
    v_mfma_f32_16x16x32_bf16 a[24:27], a[240:243], v[148:151], a[24:27]
    ds_read_b64_tr_b16 a[234:235], v16 offset:26624
    v_rcp_f32 v27, v27
    v_mfma_f32_16x16x32_bf16 a[20:23], a[244:247], v[144:147], a[20:23]
    ds_read_b64_tr_b16 a[236:237], v17 offset:24576
    v_accvgpr_read_b32 v224, a0
    v_accvgpr_read_b32 v225, a1
    v_mfma_f32_16x16x32_bf16 a[28:31], a[244:247], v[148:151], a[28:31]
    ds_read_b64_tr_b16 a[238:239], v17 offset:26624
    v_accvgpr_read_b32 v226, a2
    s_waitcnt lgkmcnt(9)
    v_mfma_f32_16x16x32_bf16 a[16:19], a[248:251], v[152:155], a[16:19]
    ds_read_b64_tr_b16 a[240:241], v14 offset:28672
    v_accvgpr_read_b32 v227, a3
    v_accvgpr_read_b32 v228, a4
    v_mfma_f32_16x16x32_bf16 a[24:27], a[248:251], v[156:159], a[24:27]
    ds_read_b64_tr_b16 a[242:243], v14 offset:30720
    v_accvgpr_read_b32 v229, a5
    v_accvgpr_read_b32 v230, a6
    v_mfma_f32_16x16x32_bf16 a[20:23], a[252:255], v[152:155], a[20:23]
    ds_read_b64_tr_b16 a[244:245], v15 offset:28672
    v_accvgpr_read_b32 v231, a7
    v_mul_f32 v224, v26, v224
    v_mfma_f32_16x16x32_bf16 a[28:31], a[252:255], v[156:159], a[28:31]
    ds_read_b64_tr_b16 a[246:247], v15 offset:30720
    v_mul_f32 v225, v26, v225
    s_waitcnt lgkmcnt(8)
    v_mfma_f32_16x16x32_bf16 v[192:195], a[224:227], v[32:35], 0
    ds_read_b64_tr_b16 a[248:249], v16 offset:28672
    v_mul_f32 v226, v26, v226
    v_mul_f32 v227, v26, v227
    v_mfma_f32_16x16x32_bf16 v[200:203], a[224:227], v[36:39], 0
    ds_read_b64_tr_b16 a[250:251], v16 offset:30720
    v_mul_f32 v228, v26, v228
    v_mul_f32 v229, v26, v229
    v_mfma_f32_16x16x32_bf16 v[196:199], a[228:231], v[32:35], 0
    ds_read_b64_tr_b16 a[252:253], v17 offset:28672
    v_mul_f32 v230, v26, v230
    v_mul_f32 v231, v26, v231
    v_mfma_f32_16x16x32_bf16 v[204:207], a[228:231], v[36:39], 0
    ds_read_b64_tr_b16 a[254:255], v17 offset:30720
    v_cvt_pk_bf16_f32 v224, v224, v225
    s_waitcnt lgkmcnt(8)
    v_mfma_f32_16x16x32_bf16 v[208:211], a[232:235], v[32:35], 0
    ds_read_b64_tr_b16 a[224:225], v14 offset:16384
    v_cvt_pk_bf16_f32 v225, v226, v227
    v_cvt_pk_bf16_f32 v226, v228, v229
    v_mfma_f32_16x16x32_bf16 v[216:219], a[232:235], v[36:39], 0
    ds_read_b64_tr_b16 a[226:227], v14 offset:18432
    v_cvt_pk_bf16_f32 v227, v230, v231
    v_accvgpr_read_b32 v232, a8
    v_mfma_f32_16x16x32_bf16 v[212:215], a[236:239], v[32:35], 0
    ds_read_b64_tr_b16 a[228:229], v15 offset:16384
    v_accvgpr_read_b32 v233, a9
    v_accvgpr_read_b32 v234, a10
    v_mfma_f32_16x16x32_bf16 v[220:223], a[236:239], v[36:39], 0
    ds_read_b64_tr_b16 a[230:231], v15 offset:18432
    v_accvgpr_read_b32 v235, a11
    s_waitcnt lgkmcnt(8)
    v_mfma_f32_16x16x32_bf16 v[192:195], a[240:243], v[40:43], v[192:195]
    ds_read_b64_tr_b16 a[232:233], v16 offset:16384
    v_accvgpr_read_b32 v236, a12
    v_accvgpr_read_b32 v237, a13
    v_mfma_f32_16x16x32_bf16 v[200:203], a[240:243], v[44:47], v[200:203]
    ds_read_b64_tr_b16 a[234:235], v16 offset:18432
    v_accvgpr_read_b32 v238, a14
    v_accvgpr_read_b32 v239, a15
    v_mfma_f32_16x16x32_bf16 v[196:199], a[244:247], v[40:43], v[196:199]
    ds_read_b64_tr_b16 a[236:237], v17 offset:16384
    ds_read_b64_tr_b16 a[238:239], v17 offset:18432
    v_mul_f32 v232, v27, v232
    v_mfma_f32_16x16x32_bf16 v[204:207], a[244:247], v[44:47], v[204:207]
    ds_read_b32 v1, v31 offset:4
    v_mul_f32 v233, v27, v233
    s_waitcnt lgkmcnt(9)
    v_mfma_f32_16x16x32_bf16 v[208:211], a[248:251], v[40:43], v[208:211]
    ds_read_b64_tr_b16 a[240:241], v14 offset:20480
    v_mul_f32 v234, v27, v234
    v_mul_f32 v235, v27, v235
    v_mfma_f32_16x16x32_bf16 v[216:219], a[248:251], v[44:47], v[216:219]
    ds_read_b64_tr_b16 a[242:243], v14 offset:22528
    v_mul_f32 v236, v27, v236
    v_mul_f32 v237, v27, v237
    v_mfma_f32_16x16x32_bf16 v[212:215], a[252:255], v[40:43], v[212:215]
    ds_read_b64_tr_b16 a[244:245], v15 offset:20480
    v_mul_f32 v238, v27, v238
    v_mul_f32 v239, v27, v239
    v_mfma_f32_16x16x32_bf16 v[220:223], a[252:255], v[44:47], v[220:223]
    ds_read_b64_tr_b16 a[246:247], v15 offset:22528
    v_cvt_pk_bf16_f32 v228, v232, v233
    s_waitcnt lgkmcnt(9)
    v_mfma_f32_16x16x32_bf16 v[192:195], a[224:227], v[48:51], v[192:195]
    ds_read_b64_tr_b16 a[248:249], v16 offset:20480
    v_cvt_pk_bf16_f32 v229, v234, v235
    v_cvt_pk_bf16_f32 v230, v236, v237
    v_mfma_f32_16x16x32_bf16 v[200:203], a[224:227], v[52:55], v[200:203]
    ds_read_b64_tr_b16 a[250:251], v16 offset:22528
    s_waitcnt lgkmcnt(6)
    v_cmp_ne_u32 vcc, 0, v1
    v_cvt_pk_bf16_f32 v231, v238, v239
    v_mfma_f32_16x16x32_bf16 v[196:199], a[228:231], v[48:51], v[196:199]
    ds_read_b64_tr_b16 a[252:253], v17 offset:20480
    ds_read_b64_tr_b16 a[254:255], v17 offset:22528
    v_accvgpr_read_b32 v240, a16
    v_mfma_f32_16x16x32_bf16 v[204:207], a[228:231], v[52:55], v[204:207]
    ds_write_b32 v2, v31
    v_accvgpr_read_b32 v241, a17
    v_mfma_f32_16x16x32_bf16 v[208:211], a[232:235], v[48:51], v[208:211]
    s_getpc_b64 s[62:63]
    s_cbranch_vccnz L_cslow
    v_accvgpr_read_b32 v242, a18
    v_mfma_f32_16x16x32_bf16 v[216:219], a[232:235], v[52:55], v[216:219]
    ds_read_b64_tr_b16 a[224:225], v18 offset:0
    ds_read_b64_tr_b16 a[226:227], v18 offset:2048
    v_accvgpr_read_b32 v243, a19
    v_mfma_f32_16x16x32_bf16 v[212:215], a[236:239], v[48:51], v[212:215]
    ds_read_b64_tr_b16 a[228:229], v19 offset:0
    ds_read_b64_tr_b16 a[230:231], v19 offset:2048
    v_accvgpr_read_b32 v244, a20
    v_mfma_f32_16x16x32_bf16 v[220:223], a[236:239], v[52:55], v[220:223]
    v_add_u32 v31, 4, v31
    v_accvgpr_read_b32 v245, a21
    s_waitcnt lgkmcnt(9)
    v_mfma_f32_16x16x32_bf16 v[192:195], a[240:243], v[56:59], v[192:195]
    ds_read_b64_tr_b16 a[232:233], v20 offset:0
    v_accvgpr_read_b32 v246, a22
    v_accvgpr_read_b32 v247, a23
    v_mfma_f32_16x16x32_bf16 v[200:203], a[240:243], v[60:63], v[200:203]
    ds_read_b64_tr_b16 a[234:235], v20 offset:2048
    v_mul_f32 v240, v26, v240
    v_mul_f32 v241, v26, v241
    v_mfma_f32_16x16x32_bf16 v[196:199], a[244:247], v[56:59], v[196:199]
    ds_read_b64_tr_b16 a[236:237], v21 offset:0
    v_mul_f32 v242, v26, v242
    v_mul_f32 v243, v26, v243
    v_mfma_f32_16x16x32_bf16 v[204:207], a[244:247], v[60:63], v[204:207]
    ds_read_b64_tr_b16 a[238:239], v21 offset:2048
    v_mul_f32 v244, v26, v244
    s_waitcnt lgkmcnt(9)
    v_mfma_f32_16x16x32_bf16 v[208:211], a[248:251], v[56:59], v[208:211]
    ds_read_b64_tr_b16 a[240:241], v18 offset:4096
    v_mul_f32 v245, v26, v245
    v_mul_f32 v246, v26, v246
    v_mfma_f32_16x16x32_bf16 v[216:219], a[248:251], v[60:63], v[216:219]
    ds_read_b64_tr_b16 a[242:243], v18 offset:6144
    v_mul_f32 v247, v26, v247
    v_cvt_pk_bf16_f32 v232, v240, v241
    v_mfma_f32_16x16x32_bf16 v[212:215], a[252:255], v[56:59], v[212:215]
    ds_read_b64_tr_b16 a[244:245], v19 offset:4096
    v_cvt_pk_bf16_f32 v233, v242, v243
    v_cvt_pk_bf16_f32 v234, v244, v245
    v_mfma_f32_16x16x32_bf16 v[220:223], a[252:255], v[60:63], v[220:223]
    ds_read_b64_tr_b16 a[246:247], v19 offset:6144
    v_cvt_pk_bf16_f32 v235, v246, v247
    s_waitcnt lgkmcnt(8)
    v_mfma_f32_16x16x32_bf16 a[112:115], a[224:227], v[224:227], 0
    ds_read_b64_tr_b16 a[248:249], v20 offset:4096
    v_accvgpr_read_b32 v248, a24
    v_accvgpr_read_b32 v249, a25
    v_mfma_f32_16x16x32_bf16 a[120:123], a[224:227], v[228:231], 0
    ds_read_b64_tr_b16 a[250:251], v20 offset:6144
    v_accvgpr_read_b32 v250, a26
    v_accvgpr_read_b32 v251, a27
    v_mfma_f32_16x16x32_bf16 a[116:119], a[228:231], v[224:227], 0
    ds_read_b64_tr_b16 a[252:253], v21 offset:4096
    v_accvgpr_read_b32 v252, a28
    v_accvgpr_read_b32 v253, a29
    v_mfma_f32_16x16x32_bf16 a[124:127], a[228:231], v[228:231], 0
    ds_read_b64_tr_b16 a[254:255], v21 offset:6144
    v_accvgpr_read_b32 v254, a30
    s_waitcnt lgkmcnt(8)
    v_mfma_f32_16x16x32_bf16 a[128:131], a[232:235], v[224:227], 0
    ds_read_b64_tr_b16 a[224:225], v18 offset:49152
    v_accvgpr_read_b32 v255, a31
    v_mul_f32 v248, v27, v248
    v_mfma_f32_16x16x32_bf16 a[136:139], a[232:235], v[228:231], 0
    ds_read_b64_tr_b16 a[226:227], v18 offset:51200
    v_mul_f32 v249, v27, v249
    v_mul_f32 v250, v27, v250
    v_mfma_f32_16x16x32_bf16 a[132:135], a[236:239], v[224:227], 0
    ds_read_b64_tr_b16 a[228:229], v19 offset:49152
    v_mul_f32 v251, v27, v251
    v_mul_f32 v252, v27, v252
    v_mfma_f32_16x16x32_bf16 a[140:143], a[236:239], v[228:231], 0
    ds_read_b64_tr_b16 a[230:231], v19 offset:51200
    v_mul_f32 v253, v27, v253
    v_mul_f32 v254, v27, v254
    v_mul_f32 v255, v27, v255
    v_cvt_pk_bf16_f32 v236, v248, v249
    v_cvt_pk_bf16_f32 v237, v250, v251
    v_cvt_pk_bf16_f32 v238, v252, v253
    v_cvt_pk_bf16_f32 v239, v254, v255
    s_waitcnt lgkmcnt(8)
    v_mfma_f32_16x16x32_bf16 a[112:115], a[240:243], v[232:235], a[112:115]
    ds_read_b64_tr_b16 a[232:233], v20 offset:49152
    v_mfma_f32_16x16x32_bf16 a[120:123], a[240:243], v[236:239], a[120:123]
    ds_read_b64_tr_b16 a[234:235], v20 offset:51200
    v_mfma_f32_16x16x32_bf16 a[116:119], a[244:247], v[232:235], a[116:119]
    ds_read_b64_tr_b16 a[236:237], v21 offset:49152
    ds_read_b64_tr_b16 a[238:239], v21 offset:51200
    v_mfma_f32_16x16x32_bf16 a[124:127], a[244:247], v[236:239], a[124:127]
    ds_read_b32 v1, v31 offset:4
    s_waitcnt lgkmcnt(9)
    v_mfma_f32_16x16x32_bf16 a[128:131], a[248:251], v[232:235], a[128:131]
    ds_read_b64_tr_b16 a[240:241], v18 offset:53248
    v_mfma_f32_16x16x32_bf16 a[136:139], a[248:251], v[236:239], a[136:139]
    ds_read_b64_tr_b16 a[242:243], v18 offset:55296
    v_mfma_f32_16x16x32_bf16 a[132:135], a[252:255], v[232:235], a[132:135]
    ds_read_b64_tr_b16 a[244:245], v19 offset:53248
    v_mfma_f32_16x16x32_bf16 a[140:143], a[252:255], v[236:239], a[140:143]
    ds_read_b64_tr_b16 a[246:247], v19 offset:55296
    s_waitcnt lgkmcnt(9)
    v_mfma_f32_16x16x32_bf16 v[192:195], a[224:227], v[64:67], v[192:195]
    ds_read_b64_tr_b16 a[248:249], v20 offset:53248
    v_mfma_f32_16x16x32_bf16 v[200:203], a[224:227], v[68:71], v[200:203]
    ds_read_b64_tr_b16 a[250:251], v20 offset:55296
    s_waitcnt lgkmcnt(6)
    v_cmp_ne_u32 vcc, 0, v1
    v_mfma_f32_16x16x32_bf16 v[196:199], a[228:231], v[64:67], v[196:199]
    ds_read_b64_tr_b16 a[252:253], v21 offset:53248
    ds_read_b64_tr_b16 a[254:255], v21 offset:55296
    v_mfma_f32_16x16x32_bf16 v[204:207], a[228:231], v[68:71], v[204:207]
    ds_write_b32 v2, v31
    v_mfma_f32_16x16x32_bf16 v[208:211], a[232:235], v[64:67], v[208:211]
    s_getpc_b64 s[62:63]
    s_cbranch_vccnz L_cslow
    v_mfma_f32_16x16x32_bf16 v[216:219], a[232:235], v[68:71], v[216:219]
    ds_read_b64_tr_b16 a[224:225], v14 offset:32768
    ds_read_b64_tr_b16 a[226:227], v14 offset:34816
    v_mfma_f32_16x16x32_bf16 v[212:215], a[236:239], v[64:67], v[212:215]
    ds_read_b64_tr_b16 a[228:229], v14 offset:36864
    ds_read_b64_tr_b16 a[230:231], v14 offset:38912
    v_mfma_f32_16x16x32_bf16 v[220:223], a[236:239], v[68:71], v[220:223]
    v_add_u32 v31, 4, v31
    s_waitcnt lgkmcnt(9)
    v_mfma_f32_16x16x32_bf16 v[192:195], a[240:243], v[72:75], v[192:195]
    ds_read_b64_tr_b16 a[232:233], v15 offset:32768
    v_mfma_f32_16x16x32_bf16 v[200:203], a[240:243], v[76:79], v[200:203]
    ds_read_b64_tr_b16 a[234:235], v15 offset:34816
    v_mfma_f32_16x16x32_bf16 v[196:199], a[244:247], v[72:75], v[196:199]
    ds_read_b64_tr_b16 a[236:237], v15 offset:36864
    v_mfma_f32_16x16x32_bf16 v[204:207], a[244:247], v[76:79], v[204:207]
    ds_read_b64_tr_b16 a[238:239], v15 offset:38912
    s_waitcnt lgkmcnt(9)
    v_mfma_f32_16x16x32_bf16 v[208:211], a[248:251], v[72:75], v[208:211]
    ds_read_b64_tr_b16 a[240:241], v16 offset:32768
    v_mfma_f32_16x16x32_bf16 v[216:219], a[248:251], v[76:79], v[216:219]
    ds_read_b64_tr_b16 a[242:243], v16 offset:34816
    v_mfma_f32_16x16x32_bf16 v[212:215], a[252:255], v[72:75], v[212:215]
    ds_read_b64_tr_b16 a[244:245], v16 offset:36864
    v_mfma_f32_16x16x32_bf16 v[220:223], a[252:255], v[76:79], v[220:223]
    ds_read_b64_tr_b16 a[246:247], v16 offset:38912
    s_waitcnt lgkmcnt(8)
    v_mfma_f32_16x16x32_bf16 a[144:147], a[224:227], v[224:227], 0
    ds_read_b64_tr_b16 a[248:249], v17 offset:32768
    v_mfma_f32_16x16x32_bf16 a[152:155], a[224:227], v[228:231], 0
    ds_read_b64_tr_b16 a[250:251], v17 offset:34816
    v_mfma_f32_16x16x32_bf16 a[144:147], a[228:231], v[232:235], a[144:147]
    ds_read_b64_tr_b16 a[252:253], v17 offset:36864
    v_mfma_f32_16x16x32_bf16 a[152:155], a[228:231], v[236:239], a[152:155]
    ds_read_b64_tr_b16 a[254:255], v17 offset:38912
    s_waitcnt lgkmcnt(8)
    v_mfma_f32_16x16x32_bf16 a[148:151], a[232:235], v[224:227], 0
    ds_read_b64_tr_b16 a[224:225], v14 offset:40960
    v_mfma_f32_16x16x32_bf16 a[156:159], a[232:235], v[228:231], 0
    ds_read_b64_tr_b16 a[226:227], v14 offset:43008
    v_mfma_f32_16x16x32_bf16 a[148:151], a[236:239], v[232:235], a[148:151]
    ds_read_b64_tr_b16 a[228:229], v15 offset:40960
    v_mfma_f32_16x16x32_bf16 a[156:159], a[236:239], v[236:239], a[156:159]
    ds_read_b64_tr_b16 a[230:231], v15 offset:43008
    s_waitcnt lgkmcnt(8)
    v_mfma_f32_16x16x32_bf16 a[160:163], a[240:243], v[224:227], 0
    ds_read_b64_tr_b16 a[232:233], v16 offset:40960
    v_mfma_f32_16x16x32_bf16 a[168:171], a[240:243], v[228:231], 0
    ds_read_b64_tr_b16 a[234:235], v16 offset:43008
    v_mfma_f32_16x16x32_bf16 a[160:163], a[244:247], v[232:235], a[160:163]
    ds_read_b64_tr_b16 a[236:237], v17 offset:40960
    ds_read_b64_tr_b16 a[238:239], v17 offset:43008
    v_mfma_f32_16x16x32_bf16 a[168:171], a[244:247], v[236:239], a[168:171]
    ds_read_b32 v1, v31 offset:4
    s_waitcnt lgkmcnt(9)
    v_mfma_f32_16x16x32_bf16 a[164:167], a[248:251], v[224:227], 0
    ds_read_b64_tr_b16 a[240:241], v14 offset:45056
    v_mfma_f32_16x16x32_bf16 a[172:175], a[248:251], v[228:231], 0
    ds_read_b64_tr_b16 a[242:243], v14 offset:47104
    v_mfma_f32_16x16x32_bf16 a[164:167], a[252:255], v[232:235], a[164:167]
    ds_read_b64_tr_b16 a[244:245], v15 offset:45056
    v_mfma_f32_16x16x32_bf16 a[172:175], a[252:255], v[236:239], a[172:175]
    ds_read_b64_tr_b16 a[246:247], v15 offset:47104
    s_waitcnt lgkmcnt(9)
    v_mfma_f32_16x16x32_bf16 v[192:195], a[224:227], v[80:83], v[192:195]
    ds_read_b64_tr_b16 a[248:249], v16 offset:45056
    v_mfma_f32_16x16x32_bf16 v[200:203], a[224:227], v[84:87], v[200:203]
    ds_read_b64_tr_b16 a[250:251], v16 offset:47104
    s_waitcnt lgkmcnt(6)
    v_cmp_ne_u32 vcc, 0, v1
    v_mfma_f32_16x16x32_bf16 v[196:199], a[228:231], v[80:83], v[196:199]
    ds_read_b64_tr_b16 a[252:253], v17 offset:45056
    ds_read_b64_tr_b16 a[254:255], v17 offset:47104
    v_mfma_f32_16x16x32_bf16 v[204:207], a[228:231], v[84:87], v[204:207]
    ds_write_b32 v2, v31
    v_mfma_f32_16x16x32_bf16 v[208:211], a[232:235], v[80:83], v[208:211]
    s_getpc_b64 s[62:63]
    s_cbranch_vccnz L_cslow
    v_mfma_f32_16x16x32_bf16 v[216:219], a[232:235], v[84:87], v[216:219]
    ds_read_b64_tr_b16 a[224:225], v22 offset:16384
    ds_read_b64_tr_b16 a[226:227], v22 offset:18432
    v_mfma_f32_16x16x32_bf16 v[212:215], a[236:239], v[80:83], v[212:215]
    ds_read_b64_tr_b16 a[228:229], v22 offset:20480
    ds_read_b64_tr_b16 a[230:231], v22 offset:22528
    v_mfma_f32_16x16x32_bf16 v[220:223], a[236:239], v[84:87], v[220:223]
    v_add_u32 v31, 4, v31
    s_waitcnt lgkmcnt(9)
    v_mfma_f32_16x16x32_bf16 v[192:195], a[240:243], v[88:91], v[192:195]
    ds_read_b64_tr_b16 a[232:233], v23 offset:16384
    v_mfma_f32_16x16x32_bf16 v[200:203], a[240:243], v[92:95], v[200:203]
    ds_read_b64_tr_b16 a[234:235], v23 offset:18432
    v_mfma_f32_16x16x32_bf16 v[196:199], a[244:247], v[88:91], v[196:199]
    ds_read_b64_tr_b16 a[236:237], v23 offset:20480
    v_mfma_f32_16x16x32_bf16 v[204:207], a[244:247], v[92:95], v[204:207]
    ds_read_b64_tr_b16 a[238:239], v23 offset:22528
    s_waitcnt lgkmcnt(9)
    v_mfma_f32_16x16x32_bf16 v[208:211], a[248:251], v[88:91], v[208:211]
    ds_read_b64_tr_b16 a[240:241], v24 offset:16384
    v_mfma_f32_16x16x32_bf16 v[216:219], a[248:251], v[92:95], v[216:219]
    ds_read_b64_tr_b16 a[242:243], v24 offset:18432
    v_mfma_f32_16x16x32_bf16 v[212:215], a[252:255], v[88:91], v[212:215]
    ds_read_b64_tr_b16 a[244:245], v24 offset:20480
    v_mfma_f32_16x16x32_bf16 v[220:223], a[252:255], v[92:95], v[220:223]
    ds_read_b64_tr_b16 a[246:247], v24 offset:22528
    s_waitcnt lgkmcnt(8)
    v_mfma_f32_16x16x32_bf16 a[176:179], a[224:227], v[224:227], 0
    ds_read_b64_tr_b16 a[248:249], v25 offset:16384
    v_mfma_f32_16x16x32_bf16 a[184:187], a[224:227], v[228:231], 0
    ds_read_b64_tr_b16 a[250:251], v25 offset:18432
    v_mfma_f32_16x16x32_bf16 a[176:179], a[228:231], v[232:235], a[176:179]
    ds_read_b64_tr_b16 a[252:253], v25 offset:20480
    v_mfma_f32_16x16x32_bf16 a[184:187], a[228:231], v[236:239], a[184:187]
    ds_read_b64_tr_b16 a[254:255], v25 offset:22528
    s_waitcnt lgkmcnt(8)
    v_mfma_f32_16x16x32_bf16 a[180:183], a[232:235], v[224:227], 0
    ds_read_b64_tr_b16 a[224:225], v18 offset:57344
    v_mfma_f32_16x16x32_bf16 a[188:191], a[232:235], v[228:231], 0
    ds_read_b64_tr_b16 a[226:227], v18 offset:59392
    v_mfma_f32_16x16x32_bf16 a[180:183], a[236:239], v[232:235], a[180:183]
    ds_read_b64_tr_b16 a[228:229], v19 offset:57344
    v_mfma_f32_16x16x32_bf16 a[188:191], a[236:239], v[236:239], a[188:191]
    ds_read_b64_tr_b16 a[230:231], v19 offset:59392
    s_waitcnt lgkmcnt(8)
    v_mfma_f32_16x16x32_bf16 a[192:195], a[240:243], v[224:227], 0
    ds_read_b64_tr_b16 a[232:233], v20 offset:57344
    v_mfma_f32_16x16x32_bf16 a[200:203], a[240:243], v[228:231], 0
    ds_read_b64_tr_b16 a[234:235], v20 offset:59392
    v_mfma_f32_16x16x32_bf16 a[192:195], a[244:247], v[232:235], a[192:195]
    ds_read_b64_tr_b16 a[236:237], v21 offset:57344
    ds_read_b64_tr_b16 a[238:239], v21 offset:59392
    v_mfma_f32_16x16x32_bf16 a[200:203], a[244:247], v[236:239], a[200:203]
    ds_read_b32 v1, v31 offset:4
    s_waitcnt lgkmcnt(9)
    v_mfma_f32_16x16x32_bf16 a[196:199], a[248:251], v[224:227], 0
    ds_read_b64_tr_b16 a[240:241], v18 offset:61440
    v_mfma_f32_16x16x32_bf16 a[204:207], a[248:251], v[228:231], 0
    ds_read_b64_tr_b16 a[242:243], v18 offset:63488
    v_mfma_f32_16x16x32_bf16 a[196:199], a[252:255], v[232:235], a[196:199]
    ds_read_b64_tr_b16 a[244:245], v19 offset:61440
    v_mfma_f32_16x16x32_bf16 a[204:207], a[252:255], v[236:239], a[204:207]
    ds_read_b64_tr_b16 a[246:247], v19 offset:63488
    s_waitcnt lgkmcnt(9)
    v_mfma_f32_16x16x32_bf16 v[192:195], a[224:227], v[96:99], v[192:195]
    ds_read_b64_tr_b16 a[248:249], v20 offset:61440
    v_mfma_f32_16x16x32_bf16 v[200:203], a[224:227], v[100:103], v[200:203]
    ds_read_b64_tr_b16 a[250:251], v20 offset:63488
    s_waitcnt lgkmcnt(6)
    v_cmp_ne_u32 vcc, 0, v1
    v_mfma_f32_16x16x32_bf16 v[196:199], a[228:231], v[96:99], v[196:199]
    ds_read_b64_tr_b16 a[252:253], v21 offset:61440
    ds_read_b64_tr_b16 a[254:255], v21 offset:63488
    v_mfma_f32_16x16x32_bf16 v[204:207], a[228:231], v[100:103], v[204:207]
    ds_write_b32 v2, v31
    v_mfma_f32_16x16x32_bf16 v[208:211], a[232:235], v[96:99], v[208:211]
    s_getpc_b64 s[62:63]
    s_cbranch_vccnz L_cslow
    v_mfma_f32_16x16x32_bf16 v[216:219], a[232:235], v[100:103], v[216:219]
    ds_read_b64_tr_b16 a[224:225], v18 offset:8192
    ds_read_b64_tr_b16 a[226:227], v18 offset:10240
    v_mfma_f32_16x16x32_bf16 v[212:215], a[236:239], v[96:99], v[212:215]
    ds_read_b64_tr_b16 a[228:229], v18 offset:12288
    ds_read_b64_tr_b16 a[230:231], v18 offset:14336
    v_mfma_f32_16x16x32_bf16 v[220:223], a[236:239], v[100:103], v[220:223]
    v_add_u32 v31, 4, v31
    s_waitcnt lgkmcnt(9)
    v_mfma_f32_16x16x32_bf16 v[192:195], a[240:243], v[104:107], v[192:195]
    ds_read_b64_tr_b16 a[232:233], v19 offset:8192
    v_mfma_f32_16x16x32_bf16 v[200:203], a[240:243], v[108:111], v[200:203]
    ds_read_b64_tr_b16 a[234:235], v19 offset:10240
    v_mfma_f32_16x16x32_bf16 v[196:199], a[244:247], v[104:107], v[196:199]
    ds_read_b64_tr_b16 a[236:237], v19 offset:12288
    v_mfma_f32_16x16x32_bf16 v[204:207], a[244:247], v[108:111], v[204:207]
    ds_read_b64_tr_b16 a[238:239], v19 offset:14336
    s_waitcnt lgkmcnt(9)
    v_mfma_f32_16x16x32_bf16 v[208:211], a[248:251], v[104:107], v[208:211]
    ds_read_b64_tr_b16 a[240:241], v20 offset:8192
    v_mfma_f32_16x16x32_bf16 v[216:219], a[248:251], v[108:111], v[216:219]
    ds_read_b64_tr_b16 a[242:243], v20 offset:10240
    v_mfma_f32_16x16x32_bf16 v[212:215], a[252:255], v[104:107], v[212:215]
    ds_read_b64_tr_b16 a[244:245], v20 offset:12288
    v_mfma_f32_16x16x32_bf16 v[220:223], a[252:255], v[108:111], v[220:223]
    ds_read_b64_tr_b16 a[246:247], v20 offset:14336
    s_waitcnt lgkmcnt(8)
    v_mfma_f32_16x16x32_bf16 a[208:211], a[224:227], v[224:227], 0
    ds_read_b64_tr_b16 a[248:249], v21 offset:8192
    v_mfma_f32_16x16x32_bf16 a[216:219], a[224:227], v[228:231], 0
    ds_read_b64_tr_b16 a[250:251], v21 offset:10240
    v_mfma_f32_16x16x32_bf16 a[208:211], a[228:231], v[232:235], a[208:211]
    ds_read_b64_tr_b16 a[252:253], v21 offset:12288
    v_mfma_f32_16x16x32_bf16 a[216:219], a[228:231], v[236:239], a[216:219]
    ds_read_b64_tr_b16 a[254:255], v21 offset:14336
    s_waitcnt lgkmcnt(8)
    v_mfma_f32_16x16x32_bf16 a[212:215], a[232:235], v[224:227], 0
    ds_read_b64_tr_b16 a[224:225], v18 offset:24576
    v_mfma_f32_16x16x32_bf16 a[220:223], a[232:235], v[228:231], 0
    ds_read_b64_tr_b16 a[226:227], v18 offset:26624
    v_mfma_f32_16x16x32_bf16 a[212:215], a[236:239], v[232:235], a[212:215]
    ds_read_b64_tr_b16 a[228:229], v19 offset:24576
    v_mfma_f32_16x16x32_bf16 a[220:223], a[236:239], v[236:239], a[220:223]
    ds_read_b64_tr_b16 a[230:231], v19 offset:26624
    s_waitcnt lgkmcnt(8)
    v_mfma_f32_16x16x32_bf16 a[0:3], a[240:243], v[224:227], 0
    ds_read_b64_tr_b16 a[232:233], v20 offset:24576
    v_mfma_f32_16x16x32_bf16 a[8:11], a[240:243], v[228:231], 0
    ds_read_b64_tr_b16 a[234:235], v20 offset:26624
    v_mfma_f32_16x16x32_bf16 a[0:3], a[244:247], v[232:235], a[0:3]
    ds_read_b64_tr_b16 a[236:237], v21 offset:24576
    ds_read_b64_tr_b16 a[238:239], v21 offset:26624
    v_mfma_f32_16x16x32_bf16 a[8:11], a[244:247], v[236:239], a[8:11]
    ds_read_b32 v1, v31 offset:4
    s_waitcnt lgkmcnt(9)
    v_mfma_f32_16x16x32_bf16 a[4:7], a[248:251], v[224:227], 0
    ds_read_b64_tr_b16 a[240:241], v18 offset:28672
    v_mfma_f32_16x16x32_bf16 a[12:15], a[248:251], v[228:231], 0
    ds_read_b64_tr_b16 a[242:243], v18 offset:30720
    v_mfma_f32_16x16x32_bf16 a[4:7], a[252:255], v[232:235], a[4:7]
    ds_read_b64_tr_b16 a[244:245], v19 offset:28672
    v_mfma_f32_16x16x32_bf16 a[12:15], a[252:255], v[236:239], a[12:15]
    ds_read_b64_tr_b16 a[246:247], v19 offset:30720
    s_waitcnt lgkmcnt(9)
    v_mfma_f32_16x16x32_bf16 v[192:195], a[224:227], v[112:115], v[192:195]
    ds_read_b64_tr_b16 a[248:249], v20 offset:28672
    v_mfma_f32_16x16x32_bf16 v[200:203], a[224:227], v[116:119], v[200:203]
    ds_read_b64_tr_b16 a[250:251], v20 offset:30720
    s_waitcnt lgkmcnt(6)
    v_cmp_ne_u32 vcc, 0, v1
    v_mfma_f32_16x16x32_bf16 v[196:199], a[228:231], v[112:115], v[196:199]
    ds_read_b64_tr_b16 a[252:253], v21 offset:28672
    ds_read_b64_tr_b16 a[254:255], v21 offset:30720
    v_mfma_f32_16x16x32_bf16 v[204:207], a[228:231], v[116:119], v[204:207]
    ds_write_b32 v2, v31
    v_mfma_f32_16x16x32_bf16 v[208:211], a[232:235], v[112:115], v[208:211]
    s_getpc_b64 s[62:63]
    s_cbranch_vccnz L_cslow
    v_mfma_f32_16x16x32_bf16 v[216:219], a[232:235], v[116:119], v[216:219]
    ds_read_b64_tr_b16 a[224:225], v22 offset:0
    ds_read_b64_tr_b16 a[226:227], v22 offset:2048
    v_mfma_f32_16x16x32_bf16 v[212:215], a[236:239], v[112:115], v[212:215]
    ds_read_b64_tr_b16 a[228:229], v22 offset:4096
    ds_read_b64_tr_b16 a[230:231], v22 offset:6144
    v_mfma_f32_16x16x32_bf16 v[220:223], a[236:239], v[116:119], v[220:223]
    v_add_u32 v31, 4, v31
    s_waitcnt lgkmcnt(9)
    v_mfma_f32_16x16x32_bf16 v[192:195], a[240:243], v[120:123], v[192:195]
    ds_read_b64_tr_b16 a[232:233], v23 offset:0
    v_mfma_f32_16x16x32_bf16 v[200:203], a[240:243], v[124:127], v[200:203]
    ds_read_b64_tr_b16 a[234:235], v23 offset:2048
    v_mfma_f32_16x16x32_bf16 v[196:199], a[244:247], v[120:123], v[196:199]
    ds_read_b64_tr_b16 a[236:237], v23 offset:4096
    v_mfma_f32_16x16x32_bf16 v[204:207], a[244:247], v[124:127], v[204:207]
    ds_read_b64_tr_b16 a[238:239], v23 offset:6144
    s_waitcnt lgkmcnt(9)
    v_mfma_f32_16x16x32_bf16 v[208:211], a[248:251], v[120:123], v[208:211]
    ds_read_b64_tr_b16 a[240:241], v24 offset:0
    v_mfma_f32_16x16x32_bf16 v[216:219], a[248:251], v[124:127], v[216:219]
    ds_read_b64_tr_b16 a[242:243], v24 offset:2048
    v_mfma_f32_16x16x32_bf16 v[212:215], a[252:255], v[120:123], v[212:215]
    ds_read_b64_tr_b16 a[244:245], v24 offset:4096
    v_mfma_f32_16x16x32_bf16 v[220:223], a[252:255], v[124:127], v[220:223]
    ds_read_b64_tr_b16 a[246:247], v24 offset:6144
    s_waitcnt lgkmcnt(8)
    v_mfma_f32_16x16x32_bf16 a[16:19], a[224:227], v[224:227], 0
    ds_read_b64_tr_b16 a[248:249], v25 offset:0
    v_mfma_f32_16x16x32_bf16 a[24:27], a[224:227], v[228:231], 0
    ds_read_b64_tr_b16 a[250:251], v25 offset:2048
    v_mfma_f32_16x16x32_bf16 a[16:19], a[228:231], v[232:235], a[16:19]
    ds_read_b64_tr_b16 a[252:253], v25 offset:4096
    v_mfma_f32_16x16x32_bf16 a[24:27], a[228:231], v[236:239], a[24:27]
    ds_read_b64_tr_b16 a[254:255], v25 offset:6144
    s_waitcnt lgkmcnt(8)
    v_mfma_f32_16x16x32_bf16 a[20:23], a[232:235], v[224:227], 0
    ds_read_b64_tr_b16 a[224:225], v18 offset:32768
    v_mfma_f32_16x16x32_bf16 a[28:31], a[232:235], v[228:231], 0
    ds_read_b64_tr_b16 a[226:227], v18 offset:34816
    v_mfma_f32_16x16x32_bf16 a[20:23], a[236:239], v[232:235], a[20:23]
    ds_read_b64_tr_b16 a[228:229], v19 offset:32768
    v_mfma_f32_16x16x32_bf16 a[28:31], a[236:239], v[236:239], a[28:31]
    ds_read_b64_tr_b16 a[230:231], v19 offset:34816
    s_waitcnt lgkmcnt(8)
    v_mfma_f32_16x16x32_bf16 a[32:35], a[240:243], v[224:227], 0
    ds_read_b64_tr_b16 a[232:233], v20 offset:32768
    v_mfma_f32_16x16x32_bf16 a[40:43], a[240:243], v[228:231], 0
    ds_read_b64_tr_b16 a[234:235], v20 offset:34816
    v_mfma_f32_16x16x32_bf16 a[32:35], a[244:247], v[232:235], a[32:35]
    ds_read_b64_tr_b16 a[236:237], v21 offset:32768
    ds_read_b64_tr_b16 a[238:239], v21 offset:34816
    v_mfma_f32_16x16x32_bf16 a[40:43], a[244:247], v[236:239], a[40:43]
    ds_read_b32 v1, v31 offset:4
    s_waitcnt lgkmcnt(9)
    v_mfma_f32_16x16x32_bf16 a[36:39], a[248:251], v[224:227], 0
    ds_read_b64_tr_b16 a[240:241], v18 offset:36864
    v_mfma_f32_16x16x32_bf16 a[44:47], a[248:251], v[228:231], 0
    ds_read_b64_tr_b16 a[242:243], v18 offset:38912
    v_mfma_f32_16x16x32_bf16 a[36:39], a[252:255], v[232:235], a[36:39]
    ds_read_b64_tr_b16 a[244:245], v19 offset:36864
    v_mfma_f32_16x16x32_bf16 a[44:47], a[252:255], v[236:239], a[44:47]
    ds_read_b64_tr_b16 a[246:247], v19 offset:38912
    s_waitcnt lgkmcnt(9)
    v_mfma_f32_16x16x32_bf16 v[192:195], a[224:227], v[128:131], v[192:195]
    ds_read_b64_tr_b16 a[248:249], v20 offset:36864
    v_mfma_f32_16x16x32_bf16 v[200:203], a[224:227], v[132:135], v[200:203]
    ds_read_b64_tr_b16 a[250:251], v20 offset:38912
    s_waitcnt lgkmcnt(6)
    v_cmp_ne_u32 vcc, 0, v1
    v_mfma_f32_16x16x32_bf16 v[196:199], a[228:231], v[128:131], v[196:199]
    ds_read_b64_tr_b16 a[252:253], v21 offset:36864
    ds_read_b64_tr_b16 a[254:255], v21 offset:38912
    v_mfma_f32_16x16x32_bf16 v[204:207], a[228:231], v[132:135], v[204:207]
    ds_write_b32 v2, v31
    v_mfma_f32_16x16x32_bf16 v[208:211], a[232:235], v[128:131], v[208:211]
    s_getpc_b64 s[62:63]
    s_cbranch_vccnz L_cslow
    v_mfma_f32_16x16x32_bf16 v[216:219], a[232:235], v[132:135], v[216:219]
    ds_read_b64_tr_b16 a[224:225], v14 offset:8192
    ds_read_b64_tr_b16 a[226:227], v14 offset:10240
    v_mfma_f32_16x16x32_bf16 v[212:215], a[236:239], v[128:131], v[212:215]
    ds_read_b64_tr_b16 a[228:229], v14 offset:12288
    ds_read_b64_tr_b16 a[230:231], v14 offset:14336
    v_mfma_f32_16x16x32_bf16 v[220:223], a[236:239], v[132:135], v[220:223]
    v_add_u32 v31, 4, v31
    s_waitcnt lgkmcnt(9)
    v_mfma_f32_16x16x32_bf16 v[192:195], a[240:243], v[136:139], v[192:195]
    ds_read_b64_tr_b16 a[232:233], v15 offset:8192
    v_mfma_f32_16x16x32_bf16 v[200:203], a[240:243], v[140:143], v[200:203]
    ds_read_b64_tr_b16 a[234:235], v15 offset:10240
    v_mfma_f32_16x16x32_bf16 v[196:199], a[244:247], v[136:139], v[196:199]
    ds_read_b64_tr_b16 a[236:237], v15 offset:12288
    v_mfma_f32_16x16x32_bf16 v[204:207], a[244:247], v[140:143], v[204:207]
    ds_read_b64_tr_b16 a[238:239], v15 offset:14336
    s_waitcnt lgkmcnt(9)
    v_mfma_f32_16x16x32_bf16 v[208:211], a[248:251], v[136:139], v[208:211]
    ds_read_b64_tr_b16 a[240:241], v16 offset:8192
    v_mfma_f32_16x16x32_bf16 v[216:219], a[248:251], v[140:143], v[216:219]
    ds_read_b64_tr_b16 a[242:243], v16 offset:10240
    v_mfma_f32_16x16x32_bf16 v[212:215], a[252:255], v[136:139], v[212:215]
    ds_read_b64_tr_b16 a[244:245], v16 offset:12288
    v_mfma_f32_16x16x32_bf16 v[220:223], a[252:255], v[140:143], v[220:223]
    ds_read_b64_tr_b16 a[246:247], v16 offset:14336
    s_waitcnt lgkmcnt(8)
    v_mfma_f32_16x16x32_bf16 a[48:51], a[224:227], v[224:227], 0
    ds_read_b64_tr_b16 a[248:249], v17 offset:8192
    v_mfma_f32_16x16x32_bf16 a[56:59], a[224:227], v[228:231], 0
    ds_read_b64_tr_b16 a[250:251], v17 offset:10240
    v_mfma_f32_16x16x32_bf16 a[48:51], a[228:231], v[232:235], a[48:51]
    ds_read_b64_tr_b16 a[252:253], v17 offset:12288
    v_mfma_f32_16x16x32_bf16 a[56:59], a[228:231], v[236:239], a[56:59]
    ds_read_b64_tr_b16 a[254:255], v17 offset:14336
    s_waitcnt lgkmcnt(8)
    v_mfma_f32_16x16x32_bf16 a[52:55], a[232:235], v[224:227], 0
    ds_read_b64_tr_b16 a[224:225], v14 offset:49152
    v_mfma_f32_16x16x32_bf16 a[60:63], a[232:235], v[228:231], 0
    ds_read_b64_tr_b16 a[226:227], v14 offset:51200
    v_mfma_f32_16x16x32_bf16 a[52:55], a[236:239], v[232:235], a[52:55]
    ds_read_b64_tr_b16 a[228:229], v15 offset:49152
    v_mfma_f32_16x16x32_bf16 a[60:63], a[236:239], v[236:239], a[60:63]
    ds_read_b64_tr_b16 a[230:231], v15 offset:51200
    s_waitcnt lgkmcnt(8)
    v_mfma_f32_16x16x32_bf16 a[64:67], a[240:243], v[224:227], 0
    ds_read_b64_tr_b16 a[232:233], v14 offset:53248
    v_mfma_f32_16x16x32_bf16 a[72:75], a[240:243], v[228:231], 0
    ds_read_b64_tr_b16 a[234:235], v14 offset:55296
    v_mfma_f32_16x16x32_bf16 a[64:67], a[244:247], v[232:235], a[64:67]
    ds_read_b64_tr_b16 a[236:237], v15 offset:53248
    ds_read_b64_tr_b16 a[238:239], v15 offset:55296
    v_mfma_f32_16x16x32_bf16 a[72:75], a[244:247], v[236:239], a[72:75]
    ds_read_b32 v1, v31 offset:4
    s_waitcnt lgkmcnt(9)
    v_mfma_f32_16x16x32_bf16 a[68:71], a[248:251], v[224:227], 0
    ds_read_b64_tr_b16 a[240:241], v16 offset:49152
    v_mfma_f32_16x16x32_bf16 a[76:79], a[248:251], v[228:231], 0
    ds_read_b64_tr_b16 a[242:243], v16 offset:51200
    v_mfma_f32_16x16x32_bf16 a[68:71], a[252:255], v[232:235], a[68:71]
    ds_read_b64_tr_b16 a[244:245], v17 offset:49152
    v_mfma_f32_16x16x32_bf16 a[76:79], a[252:255], v[236:239], a[76:79]
    ds_read_b64_tr_b16 a[246:247], v17 offset:51200
    s_waitcnt lgkmcnt(9)
    v_mfma_f32_16x16x32_bf16 v[192:195], a[224:227], v[144:147], v[192:195]
    ds_read_b64_tr_b16 a[248:249], v16 offset:53248
    v_mfma_f32_16x16x32_bf16 v[200:203], a[224:227], v[148:151], v[200:203]
    ds_read_b64_tr_b16 a[250:251], v16 offset:55296
    s_waitcnt lgkmcnt(6)
    v_cmp_ne_u32 vcc, 0, v1
    v_mfma_f32_16x16x32_bf16 v[196:199], a[228:231], v[144:147], v[196:199]
    ds_read_b64_tr_b16 a[252:253], v17 offset:53248
    ds_read_b64_tr_b16 a[254:255], v17 offset:55296
    v_mfma_f32_16x16x32_bf16 v[204:207], a[228:231], v[148:151], v[204:207]
    ds_write_b32 v2, v31
    v_mfma_f32_16x16x32_bf16 v[192:195], a[232:235], v[152:155], v[192:195]
    s_getpc_b64 s[62:63]
    s_cbranch_vccnz L_cslow
    v_mfma_f32_16x16x32_bf16 v[200:203], a[232:235], v[156:159], v[200:203]
    ds_read_b64_tr_b16 a[224:225], v18 offset:40960
    ds_read_b64_tr_b16 a[226:227], v18 offset:43008
    v_mfma_f32_16x16x32_bf16 v[196:199], a[236:239], v[152:155], v[196:199]
    ds_read_b64_tr_b16 a[228:229], v18 offset:45056
    ds_read_b64_tr_b16 a[230:231], v18 offset:47104
    v_mfma_f32_16x16x32_bf16 v[204:207], a[236:239], v[156:159], v[204:207]
    v_add_u32 v31, 4, v31
    s_waitcnt lgkmcnt(9)
    v_mfma_f32_16x16x32_bf16 v[208:211], a[240:243], v[144:147], v[208:211]
    ds_read_b64_tr_b16 a[232:233], v19 offset:40960
    v_mfma_f32_16x16x32_bf16 v[216:219], a[240:243], v[148:151], v[216:219]
    ds_read_b64_tr_b16 a[234:235], v19 offset:43008
    v_mfma_f32_16x16x32_bf16 v[212:215], a[244:247], v[144:147], v[212:215]
    ds_read_b64_tr_b16 a[236:237], v19 offset:45056
    v_mul_f32 v192, v26, v192
    v_mul_f32 v193, v26, v193
    v_mfma_f32_16x16x32_bf16 v[220:223], a[244:247], v[148:151], v[220:223]
    ds_read_b64_tr_b16 a[238:239], v19 offset:47104
    v_mul_f32 v194, v26, v194
    s_waitcnt lgkmcnt(9)
    v_mfma_f32_16x16x32_bf16 v[208:211], a[248:251], v[152:155], v[208:211]
    ds_read_b64_tr_b16 a[240:241], v20 offset:40960
    v_mul_f32 v195, v26, v195
    v_mul_f32 v196, v26, v196
    v_mfma_f32_16x16x32_bf16 v[216:219], a[248:251], v[156:159], v[216:219]
    ds_read_b64_tr_b16 a[242:243], v20 offset:43008
    v_mul_f32 v197, v26, v197
    v_mul_f32 v198, v26, v198
    v_mfma_f32_16x16x32_bf16 v[212:215], a[252:255], v[152:155], v[212:215]
    ds_read_b64_tr_b16 a[244:245], v20 offset:45056
    v_mul_f32 v199, v26, v199
    v_cvt_pk_bf16_f32 v192, v192, v193
    v_mfma_f32_16x16x32_bf16 v[220:223], a[252:255], v[156:159], v[220:223]
    ds_read_b64_tr_b16 a[246:247], v20 offset:47104
    v_cvt_pk_bf16_f32 v193, v194, v195
    s_waitcnt lgkmcnt(8)
    v_mfma_f32_16x16x32_bf16 a[80:83], a[224:227], v[224:227], 0
    ds_read_b64_tr_b16 a[248:249], v21 offset:40960
    v_cvt_pk_bf16_f32 v194, v196, v197
    v_cvt_pk_bf16_f32 v195, v198, v199
    v_mfma_f32_16x16x32_bf16 a[88:91], a[224:227], v[228:231], 0
    ds_read_b64_tr_b16 a[250:251], v21 offset:43008
    v_mul_f32 v200, v27, v200
    v_mul_f32 v201, v27, v201
    v_mfma_f32_16x16x32_bf16 a[80:83], a[228:231], v[232:235], a[80:83]
    ds_read_b64_tr_b16 a[252:253], v21 offset:45056
    v_mul_f32 v202, v27, v202
    v_mul_f32 v203, v27, v203
    v_mfma_f32_16x16x32_bf16 a[88:91], a[228:231], v[236:239], a[88:91]
    ds_read_b64_tr_b16 a[254:255], v21 offset:47104
    v_mul_f32 v204, v27, v204
    s_waitcnt lgkmcnt(8)
    v_mfma_f32_16x16x32_bf16 a[84:87], a[232:235], v[224:227], 0
    ds_read_b64_tr_b16 a[224:225], v18 offset:16384
    v_mul_f32 v205, v27, v205
    v_mul_f32 v206, v27, v206
    v_mfma_f32_16x16x32_bf16 a[92:95], a[232:235], v[228:231], 0
    ds_read_b64_tr_b16 a[226:227], v18 offset:18432
    v_mul_f32 v207, v27, v207
    v_cvt_pk_bf16_f32 v196, v200, v201
    v_mfma_f32_16x16x32_bf16 a[84:87], a[236:239], v[232:235], a[84:87]
    ds_read_b64_tr_b16 a[228:229], v19 offset:16384
    v_cvt_pk_bf16_f32 v197, v202, v203
    v_cvt_pk_bf16_f32 v198, v204, v205
    v_mfma_f32_16x16x32_bf16 a[92:95], a[236:239], v[236:239], a[92:95]
    ds_read_b64_tr_b16 a[230:231], v19 offset:18432
    v_cvt_pk_bf16_f32 v199, v206, v207
    s_waitcnt lgkmcnt(8)
    v_mfma_f32_16x16x32_bf16 a[96:99], a[240:243], v[224:227], 0
    ds_read_b64_tr_b16 a[232:233], v20 offset:16384
    v_mul_f32 v208, v26, v208
    v_mul_f32 v209, v26, v209
    v_mfma_f32_16x16x32_bf16 a[104:107], a[240:243], v[228:231], 0
    ds_read_b64_tr_b16 a[234:235], v20 offset:18432
    v_mul_f32 v210, v26, v210
    v_mul_f32 v211, v26, v211
    v_mfma_f32_16x16x32_bf16 a[96:99], a[244:247], v[232:235], a[96:99]
    ds_read_b64_tr_b16 a[236:237], v21 offset:16384
    ds_read_b64_tr_b16 a[238:239], v21 offset:18432
    v_mul_f32 v212, v26, v212
    v_mfma_f32_16x16x32_bf16 a[104:107], a[244:247], v[236:239], a[104:107]
    ds_read_b32 v1, v31 offset:4
    v_mul_f32 v213, v26, v213
    s_waitcnt lgkmcnt(9)
    v_mfma_f32_16x16x32_bf16 a[100:103], a[248:251], v[224:227], 0
    ds_read_b64_tr_b16 a[240:241], v18 offset:20480
    v_mul_f32 v214, v26, v214
    v_mul_f32 v215, v26, v215
    v_mfma_f32_16x16x32_bf16 a[108:111], a[248:251], v[228:231], 0
    ds_read_b64_tr_b16 a[242:243], v18 offset:22528
    v_cvt_pk_bf16_f32 v200, v208, v209
    v_cvt_pk_bf16_f32 v201, v210, v211
    v_mfma_f32_16x16x32_bf16 a[100:103], a[252:255], v[232:235], a[100:103]
    ds_read_b64_tr_b16 a[244:245], v19 offset:20480
    v_cvt_pk_bf16_f32 v202, v212, v213
    v_cvt_pk_bf16_f32 v203, v214, v215
    v_mfma_f32_16x16x32_bf16 a[108:111], a[252:255], v[236:239], a[108:111]
    ds_read_b64_tr_b16 a[246:247], v19 offset:22528
    v_mul_f32 v216, v27, v216
    s_waitcnt lgkmcnt(9)
    v_mfma_f32_16x16x32_bf16 v[160:163], a[224:227], v[32:35], 0
    ds_read_b64_tr_b16 a[248:249], v20 offset:20480
    v_mul_f32 v217, v27, v217
    v_mul_f32 v218, v27, v218
    v_mfma_f32_16x16x32_bf16 v[168:171], a[224:227], v[36:39], 0
    ds_read_b64_tr_b16 a[250:251], v20 offset:22528
    s_waitcnt lgkmcnt(6)
    v_cmp_ne_u32 vcc, 0, v1
    v_mul_f32 v219, v27, v219
    v_mfma_f32_16x16x32_bf16 v[164:167], a[228:231], v[32:35], 0
    ds_read_b64_tr_b16 a[252:253], v21 offset:20480
    ds_read_b64_tr_b16 a[254:255], v21 offset:22528
    v_mul_f32 v220, v27, v220
    v_mfma_f32_16x16x32_bf16 v[172:175], a[228:231], v[36:39], 0
    ds_write_b32 v2, v31
    v_mul_f32 v221, v27, v221
    v_mfma_f32_16x16x32_bf16 v[176:179], a[232:235], v[32:35], 0
    s_getpc_b64 s[62:63]
    s_cbranch_vccnz L_cslow
    v_mul_f32 v222, v27, v222
    v_mfma_f32_16x16x32_bf16 v[184:187], a[232:235], v[36:39], 0
    ds_read_b64_tr_b16 a[224:225], v14 offset:0
    ds_read_b64_tr_b16 a[226:227], v14 offset:2048
    v_mul_f32 v223, v27, v223
    v_mfma_f32_16x16x32_bf16 v[180:183], a[236:239], v[32:35], 0
    ds_read_b64_tr_b16 a[228:229], v15 offset:0
    ds_read_b64_tr_b16 a[230:231], v15 offset:2048
    v_cvt_pk_bf16_f32 v204, v216, v217
    v_mfma_f32_16x16x32_bf16 v[188:191], a[236:239], v[36:39], 0
    v_add_u32 v31, 4, v31
    v_cvt_pk_bf16_f32 v205, v218, v219
    s_waitcnt lgkmcnt(9)
    v_mfma_f32_16x16x32_bf16 v[160:163], a[240:243], v[40:43], v[160:163]
    ds_read_b64_tr_b16 a[232:233], v16 offset:0
    v_cvt_pk_bf16_f32 v206, v220, v221
    v_cvt_pk_bf16_f32 v207, v222, v223
    v_mfma_f32_16x16x32_bf16 v[168:171], a[240:243], v[44:47], v[168:171]
    ds_read_b64_tr_b16 a[234:235], v16 offset:2048
    v_mfma_f32_16x16x32_bf16 v[164:167], a[244:247], v[40:43], v[164:167]
    ds_read_b64_tr_b16 a[236:237], v17 offset:0
    v_mfma_f32_16x16x32_bf16 v[172:175], a[244:247], v[44:47], v[172:175]
    ds_read_b64_tr_b16 a[238:239], v17 offset:2048
    s_waitcnt lgkmcnt(9)
    v_mfma_f32_16x16x32_bf16 v[176:179], a[248:251], v[40:43], v[176:179]
    ds_read_b64_tr_b16 a[240:241], v14 offset:4096
    v_mfma_f32_16x16x32_bf16 v[184:187], a[248:251], v[44:47], v[184:187]
    ds_read_b64_tr_b16 a[242:243], v14 offset:6144
    v_mfma_f32_16x16x32_bf16 v[180:183], a[252:255], v[40:43], v[180:183]
    ds_read_b64_tr_b16 a[244:245], v15 offset:4096
    v_mfma_f32_16x16x32_bf16 v[188:191], a[252:255], v[44:47], v[188:191]
    ds_read_b64_tr_b16 a[246:247], v15 offset:6144
    s_waitcnt lgkmcnt(8)
    v_mfma_f32_16x16x32_bf16 v[160:163], a[224:227], v[48:51], v[160:163]
    ds_read_b64_tr_b16 a[248:249], v16 offset:4096
    v_mfma_f32_16x16x32_bf16 v[168:171], a[224:227], v[52:55], v[168:171]
    ds_read_b64_tr_b16 a[250:251], v16 offset:6144
    v_mfma_f32_16x16x32_bf16 v[164:167], a[228:231], v[48:51], v[164:167]
    ds_read_b64_tr_b16 a[252:253], v17 offset:4096
    v_mfma_f32_16x16x32_bf16 v[172:175], a[228:231], v[52:55], v[172:175]
    ds_read_b64_tr_b16 a[254:255], v17 offset:6144
    s_waitcnt lgkmcnt(8)
    v_mfma_f32_16x16x32_bf16 v[176:179], a[232:235], v[48:51], v[176:179]
    ds_read_b64_tr_b16 a[224:225], v14 offset:57344
    v_mfma_f32_16x16x32_bf16 v[184:187], a[232:235], v[52:55], v[184:187]
    ds_read_b64_tr_b16 a[226:227], v14 offset:59392
    v_mfma_f32_16x16x32_bf16 v[180:183], a[236:239], v[48:51], v[180:183]
    ds_read_b64_tr_b16 a[228:229], v15 offset:57344
    v_mfma_f32_16x16x32_bf16 v[188:191], a[236:239], v[52:55], v[188:191]
    ds_read_b64_tr_b16 a[230:231], v15 offset:59392
    s_waitcnt lgkmcnt(8)
    v_mfma_f32_16x16x32_bf16 v[160:163], a[240:243], v[56:59], v[160:163]
    ds_read_b64_tr_b16 a[232:233], v16 offset:57344
    v_mfma_f32_16x16x32_bf16 v[168:171], a[240:243], v[60:63], v[168:171]
    ds_read_b64_tr_b16 a[234:235], v16 offset:59392
    v_mfma_f32_16x16x32_bf16 v[164:167], a[244:247], v[56:59], v[164:167]
    ds_read_b64_tr_b16 a[236:237], v17 offset:57344
    ds_read_b64_tr_b16 a[238:239], v17 offset:59392
    v_mfma_f32_16x16x32_bf16 v[172:175], a[244:247], v[60:63], v[172:175]
    ds_read_b32 v1, v31 offset:4
    s_waitcnt lgkmcnt(9)
    v_mfma_f32_16x16x32_bf16 v[176:179], a[248:251], v[56:59], v[176:179]
    ds_read_b64_tr_b16 a[240:241], v14 offset:61440
    v_mfma_f32_16x16x32_bf16 v[184:187], a[248:251], v[60:63], v[184:187]
    ds_read_b64_tr_b16 a[242:243], v14 offset:63488
    v_mfma_f32_16x16x32_bf16 v[180:183], a[252:255], v[56:59], v[180:183]
    ds_read_b64_tr_b16 a[244:245], v15 offset:61440
    v_mfma_f32_16x16x32_bf16 v[188:191], a[252:255], v[60:63], v[188:191]
    ds_read_b64_tr_b16 a[246:247], v15 offset:63488
    s_waitcnt lgkmcnt(9)
    v_mfma_f32_16x16x32_bf16 a[112:115], a[224:227], v[192:195], a[112:115]
    ds_read_b64_tr_b16 a[248:249], v16 offset:61440
    v_mfma_f32_16x16x32_bf16 a[120:123], a[224:227], v[196:199], a[120:123]
    ds_read_b64_tr_b16 a[250:251], v16 offset:63488
    s_waitcnt lgkmcnt(6)
    v_cmp_ne_u32 vcc, 0, v1
    v_mfma_f32_16x16x32_bf16 a[116:119], a[228:231], v[192:195], a[116:119]
    ds_read_b64_tr_b16 a[252:253], v17 offset:61440
    ds_read_b64_tr_b16 a[254:255], v17 offset:63488
    v_mfma_f32_16x16x32_bf16 a[124:127], a[228:231], v[196:199], a[124:127]
    ds_write_b32 v2, v31
    v_mfma_f32_16x16x32_bf16 a[128:131], a[232:235], v[192:195], a[128:131]
    s_getpc_b64 s[62:63]
    s_cbranch_vccnz L_cslow
    v_mfma_f32_16x16x32_bf16 a[136:139], a[232:235], v[196:199], a[136:139]
    ds_read_b64_tr_b16 a[224:225], v14 offset:24576
    ds_read_b64_tr_b16 a[226:227], v14 offset:26624
    v_mfma_f32_16x16x32_bf16 a[132:135], a[236:239], v[192:195], a[132:135]
    ds_read_b64_tr_b16 a[228:229], v15 offset:24576
    ds_read_b64_tr_b16 a[230:231], v15 offset:26624
    v_mfma_f32_16x16x32_bf16 a[140:143], a[236:239], v[196:199], a[140:143]
    v_add_u32 v31, 4, v31
    s_waitcnt lgkmcnt(9)
    v_mfma_f32_16x16x32_bf16 a[112:115], a[240:243], v[200:203], a[112:115]
    ds_read_b64_tr_b16 a[232:233], v16 offset:24576
    v_mfma_f32_16x16x32_bf16 a[120:123], a[240:243], v[204:207], a[120:123]
    ds_read_b64_tr_b16 a[234:235], v16 offset:26624
    v_mfma_f32_16x16x32_bf16 a[116:119], a[244:247], v[200:203], a[116:119]
    ds_read_b64_tr_b16 a[236:237], v17 offset:24576
    v_mfma_f32_16x16x32_bf16 a[124:127], a[244:247], v[204:207], a[124:127]
    ds_read_b64_tr_b16 a[238:239], v17 offset:26624
    s_waitcnt lgkmcnt(9)
    v_mfma_f32_16x16x32_bf16 a[128:131], a[248:251], v[200:203], a[128:131]
    ds_read_b64_tr_b16 a[240:241], v14 offset:28672
    v_mfma_f32_16x16x32_bf16 a[136:139], a[248:251], v[204:207], a[136:139]
    ds_read_b64_tr_b16 a[242:243], v14 offset:30720
    v_mfma_f32_16x16x32_bf16 a[132:135], a[252:255], v[200:203], a[132:135]
    ds_read_b64_tr_b16 a[244:245], v15 offset:28672
    v_mfma_f32_16x16x32_bf16 a[140:143], a[252:255], v[204:207], a[140:143]
    ds_read_b64_tr_b16 a[246:247], v15 offset:30720
    s_waitcnt lgkmcnt(8)
    v_mfma_f32_16x16x32_bf16 v[160:163], a[224:227], v[64:67], v[160:163]
    ds_read_b64_tr_b16 a[248:249], v16 offset:28672
    v_mfma_f32_16x16x32_bf16 v[168:171], a[224:227], v[68:71], v[168:171]
    ds_read_b64_tr_b16 a[250:251], v16 offset:30720
    v_mfma_f32_16x16x32_bf16 v[164:167], a[228:231], v[64:67], v[164:167]
    ds_read_b64_tr_b16 a[252:253], v17 offset:28672
    v_mfma_f32_16x16x32_bf16 v[172:175], a[228:231], v[68:71], v[172:175]
    ds_read_b64_tr_b16 a[254:255], v17 offset:30720
    s_waitcnt lgkmcnt(8)
    v_mfma_f32_16x16x32_bf16 v[176:179], a[232:235], v[64:67], v[176:179]
    ds_read_b64_tr_b16 a[224:225], v22 offset:8192
    v_mfma_f32_16x16x32_bf16 v[184:187], a[232:235], v[68:71], v[184:187]
    ds_read_b64_tr_b16 a[226:227], v22 offset:10240
    v_mfma_f32_16x16x32_bf16 v[180:183], a[236:239], v[64:67], v[180:183]
    ds_read_b64_tr_b16 a[228:229], v22 offset:12288
    v_mfma_f32_16x16x32_bf16 v[188:191], a[236:239], v[68:71], v[188:191]
    ds_read_b64_tr_b16 a[230:231], v22 offset:14336
    s_waitcnt lgkmcnt(8)
    v_mfma_f32_16x16x32_bf16 v[160:163], a[240:243], v[72:75], v[160:163]
    ds_read_b64_tr_b16 a[232:233], v23 offset:8192
    v_mfma_f32_16x16x32_bf16 v[168:171], a[240:243], v[76:79], v[168:171]
    ds_read_b64_tr_b16 a[234:235], v23 offset:10240
    v_mfma_f32_16x16x32_bf16 v[164:167], a[244:247], v[72:75], v[164:167]
    ds_read_b64_tr_b16 a[236:237], v23 offset:12288
    ds_read_b64_tr_b16 a[238:239], v23 offset:14336
    v_mfma_f32_16x16x32_bf16 v[172:175], a[244:247], v[76:79], v[172:175]
    ds_read_b32 v1, v31 offset:4
    s_waitcnt lgkmcnt(9)
    v_mfma_f32_16x16x32_bf16 v[176:179], a[248:251], v[72:75], v[176:179]
    ds_read_b64_tr_b16 a[240:241], v24 offset:8192
    v_mfma_f32_16x16x32_bf16 v[184:187], a[248:251], v[76:79], v[184:187]
    ds_read_b64_tr_b16 a[242:243], v24 offset:10240
    v_mfma_f32_16x16x32_bf16 v[180:183], a[252:255], v[72:75], v[180:183]
    ds_read_b64_tr_b16 a[244:245], v24 offset:12288
    v_mfma_f32_16x16x32_bf16 v[188:191], a[252:255], v[76:79], v[188:191]
    ds_read_b64_tr_b16 a[246:247], v24 offset:14336
    s_waitcnt lgkmcnt(9)
    v_mfma_f32_16x16x32_bf16 a[144:147], a[224:227], v[192:195], a[144:147]
    ds_read_b64_tr_b16 a[248:249], v25 offset:8192
    v_mfma_f32_16x16x32_bf16 a[152:155], a[224:227], v[196:199], a[152:155]
    ds_read_b64_tr_b16 a[250:251], v25 offset:10240
    s_waitcnt lgkmcnt(6)
    v_cmp_ne_u32 vcc, 0, v1
    v_mfma_f32_16x16x32_bf16 a[144:147], a[228:231], v[200:203], a[144:147]
    ds_read_b64_tr_b16 a[252:253], v25 offset:12288
    ds_read_b64_tr_b16 a[254:255], v25 offset:14336
    v_mfma_f32_16x16x32_bf16 a[152:155], a[228:231], v[204:207], a[152:155]
    ds_write_b32 v2, v31
    v_mfma_f32_16x16x32_bf16 a[148:151], a[232:235], v[192:195], a[148:151]
    s_getpc_b64 s[62:63]
    s_cbranch_vccnz L_cslow
    v_mfma_f32_16x16x32_bf16 a[156:159], a[232:235], v[196:199], a[156:159]
    ds_read_b64_tr_b16 a[224:225], v18 offset:0
    ds_read_b64_tr_b16 a[226:227], v18 offset:2048
    v_mfma_f32_16x16x32_bf16 a[148:151], a[236:239], v[200:203], a[148:151]
    ds_read_b64_tr_b16 a[228:229], v19 offset:0
    ds_read_b64_tr_b16 a[230:231], v19 offset:2048
    v_mfma_f32_16x16x32_bf16 a[156:159], a[236:239], v[204:207], a[156:159]
    v_add_u32 v31, 4, v31
    s_waitcnt lgkmcnt(9)
    v_mfma_f32_16x16x32_bf16 a[160:163], a[240:243], v[192:195], a[160:163]
    ds_read_b64_tr_b16 a[232:233], v20 offset:0
    v_mfma_f32_16x16x32_bf16 a[168:171], a[240:243], v[196:199], a[168:171]
    ds_read_b64_tr_b16 a[234:235], v20 offset:2048
    v_mfma_f32_16x16x32_bf16 a[160:163], a[244:247], v[200:203], a[160:163]
    ds_read_b64_tr_b16 a[236:237], v21 offset:0
    v_mfma_f32_16x16x32_bf16 a[168:171], a[244:247], v[204:207], a[168:171]
    ds_read_b64_tr_b16 a[238:239], v21 offset:2048
    s_waitcnt lgkmcnt(9)
    v_mfma_f32_16x16x32_bf16 a[164:167], a[248:251], v[192:195], a[164:167]
    ds_read_b64_tr_b16 a[240:241], v18 offset:4096
    v_mfma_f32_16x16x32_bf16 a[172:175], a[248:251], v[196:199], a[172:175]
    ds_read_b64_tr_b16 a[242:243], v18 offset:6144
    v_mfma_f32_16x16x32_bf16 a[164:167], a[252:255], v[200:203], a[164:167]
    ds_read_b64_tr_b16 a[244:245], v19 offset:4096
    v_mfma_f32_16x16x32_bf16 a[172:175], a[252:255], v[204:207], a[172:175]
    ds_read_b64_tr_b16 a[246:247], v19 offset:6144
    s_waitcnt lgkmcnt(8)
    v_mfma_f32_16x16x32_bf16 v[160:163], a[224:227], v[80:83], v[160:163]
    ds_read_b64_tr_b16 a[248:249], v20 offset:4096
    v_mfma_f32_16x16x32_bf16 v[168:171], a[224:227], v[84:87], v[168:171]
    ds_read_b64_tr_b16 a[250:251], v20 offset:6144
    v_mfma_f32_16x16x32_bf16 v[164:167], a[228:231], v[80:83], v[164:167]
    ds_read_b64_tr_b16 a[252:253], v21 offset:4096
    v_mfma_f32_16x16x32_bf16 v[172:175], a[228:231], v[84:87], v[172:175]
    ds_read_b64_tr_b16 a[254:255], v21 offset:6144
    s_waitcnt lgkmcnt(8)
    v_mfma_f32_16x16x32_bf16 v[176:179], a[232:235], v[80:83], v[176:179]
    ds_read_b64_tr_b16 a[224:225], v14 offset:16384
    v_mfma_f32_16x16x32_bf16 v[184:187], a[232:235], v[84:87], v[184:187]
    ds_read_b64_tr_b16 a[226:227], v14 offset:18432
    v_mfma_f32_16x16x32_bf16 v[180:183], a[236:239], v[80:83], v[180:183]
    ds_read_b64_tr_b16 a[228:229], v14 offset:20480
    v_mfma_f32_16x16x32_bf16 v[188:191], a[236:239], v[84:87], v[188:191]
    ds_read_b64_tr_b16 a[230:231], v14 offset:22528
    s_waitcnt lgkmcnt(8)
    v_mfma_f32_16x16x32_bf16 v[160:163], a[240:243], v[88:91], v[160:163]
    ds_read_b64_tr_b16 a[232:233], v15 offset:16384
    v_mfma_f32_16x16x32_bf16 v[168:171], a[240:243], v[92:95], v[168:171]
    ds_read_b64_tr_b16 a[234:235], v15 offset:18432
    v_mfma_f32_16x16x32_bf16 v[164:167], a[244:247], v[88:91], v[164:167]
    ds_read_b64_tr_b16 a[236:237], v15 offset:20480
    ds_read_b64_tr_b16 a[238:239], v15 offset:22528
    v_mfma_f32_16x16x32_bf16 v[172:175], a[244:247], v[92:95], v[172:175]
    ds_read_b32 v1, v31 offset:4
    s_waitcnt lgkmcnt(9)
    v_mfma_f32_16x16x32_bf16 v[176:179], a[248:251], v[88:91], v[176:179]
    ds_read_b64_tr_b16 a[240:241], v16 offset:16384
    v_mfma_f32_16x16x32_bf16 v[184:187], a[248:251], v[92:95], v[184:187]
    ds_read_b64_tr_b16 a[242:243], v16 offset:18432
    v_mfma_f32_16x16x32_bf16 v[180:183], a[252:255], v[88:91], v[180:183]
    ds_read_b64_tr_b16 a[244:245], v16 offset:20480
    v_mfma_f32_16x16x32_bf16 v[188:191], a[252:255], v[92:95], v[188:191]
    ds_read_b64_tr_b16 a[246:247], v16 offset:22528
    s_waitcnt lgkmcnt(9)
    v_mfma_f32_16x16x32_bf16 a[176:179], a[224:227], v[192:195], a[176:179]
    ds_read_b64_tr_b16 a[248:249], v17 offset:16384
    v_mfma_f32_16x16x32_bf16 a[184:187], a[224:227], v[196:199], a[184:187]
    ds_read_b64_tr_b16 a[250:251], v17 offset:18432
    s_waitcnt lgkmcnt(6)
    v_cmp_ne_u32 vcc, 0, v1
    v_mfma_f32_16x16x32_bf16 a[176:179], a[228:231], v[200:203], a[176:179]
    ds_read_b64_tr_b16 a[252:253], v17 offset:20480
    ds_read_b64_tr_b16 a[254:255], v17 offset:22528
    v_mfma_f32_16x16x32_bf16 a[184:187], a[228:231], v[204:207], a[184:187]
    ds_write_b32 v2, v31
    v_mfma_f32_16x16x32_bf16 a[180:183], a[232:235], v[192:195], a[180:183]
    s_getpc_b64 s[62:63]
    s_cbranch_vccnz L_cslow
    v_mfma_f32_16x16x32_bf16 a[188:191], a[232:235], v[196:199], a[188:191]
    ds_read_b64_tr_b16 a[224:225], v14 offset:40960
    ds_read_b64_tr_b16 a[226:227], v14 offset:43008
    v_mfma_f32_16x16x32_bf16 a[180:183], a[236:239], v[200:203], a[180:183]
    ds_read_b64_tr_b16 a[228:229], v15 offset:40960
    ds_read_b64_tr_b16 a[230:231], v15 offset:43008
    v_mfma_f32_16x16x32_bf16 a[188:191], a[236:239], v[204:207], a[188:191]
    v_add_u32 v31, 4, v31
    s_waitcnt lgkmcnt(9)
    v_mfma_f32_16x16x32_bf16 a[192:195], a[240:243], v[192:195], a[192:195]
    ds_read_b64_tr_b16 a[232:233], v16 offset:40960
    v_mfma_f32_16x16x32_bf16 a[200:203], a[240:243], v[196:199], a[200:203]
    ds_read_b64_tr_b16 a[234:235], v16 offset:43008
    v_mfma_f32_16x16x32_bf16 a[192:195], a[244:247], v[200:203], a[192:195]
    ds_read_b64_tr_b16 a[236:237], v17 offset:40960
    v_mfma_f32_16x16x32_bf16 a[200:203], a[244:247], v[204:207], a[200:203]
    ds_read_b64_tr_b16 a[238:239], v17 offset:43008
    s_waitcnt lgkmcnt(9)
    v_mfma_f32_16x16x32_bf16 a[196:199], a[248:251], v[192:195], a[196:199]
    ds_read_b64_tr_b16 a[240:241], v14 offset:45056
    v_mfma_f32_16x16x32_bf16 a[204:207], a[248:251], v[196:199], a[204:207]
    ds_read_b64_tr_b16 a[242:243], v14 offset:47104
    v_mfma_f32_16x16x32_bf16 a[196:199], a[252:255], v[200:203], a[196:199]
    ds_read_b64_tr_b16 a[244:245], v15 offset:45056
    v_mfma_f32_16x16x32_bf16 a[204:207], a[252:255], v[204:207], a[204:207]
    ds_read_b64_tr_b16 a[246:247], v15 offset:47104
    s_waitcnt lgkmcnt(8)
    v_mfma_f32_16x16x32_bf16 v[160:163], a[224:227], v[96:99], v[160:163]
    ds_read_b64_tr_b16 a[248:249], v16 offset:45056
    v_mfma_f32_16x16x32_bf16 v[168:171], a[224:227], v[100:103], v[168:171]
    ds_read_b64_tr_b16 a[250:251], v16 offset:47104
    v_mfma_f32_16x16x32_bf16 v[164:167], a[228:231], v[96:99], v[164:167]
    ds_read_b64_tr_b16 a[252:253], v17 offset:45056
    v_mfma_f32_16x16x32_bf16 v[172:175], a[228:231], v[100:103], v[172:175]
    ds_read_b64_tr_b16 a[254:255], v17 offset:47104
    s_waitcnt lgkmcnt(8)
    v_mfma_f32_16x16x32_bf16 v[176:179], a[232:235], v[96:99], v[176:179]
    ds_read_b64_tr_b16 a[224:225], v18 offset:49152
    v_mfma_f32_16x16x32_bf16 v[184:187], a[232:235], v[100:103], v[184:187]
    ds_read_b64_tr_b16 a[226:227], v18 offset:51200
    v_mfma_f32_16x16x32_bf16 v[180:183], a[236:239], v[96:99], v[180:183]
    ds_read_b64_tr_b16 a[228:229], v18 offset:53248
    v_mfma_f32_16x16x32_bf16 v[188:191], a[236:239], v[100:103], v[188:191]
    ds_read_b64_tr_b16 a[230:231], v18 offset:55296
    s_waitcnt lgkmcnt(8)
    v_mfma_f32_16x16x32_bf16 v[160:163], a[240:243], v[104:107], v[160:163]
    ds_read_b64_tr_b16 a[232:233], v19 offset:49152
    v_mfma_f32_16x16x32_bf16 v[168:171], a[240:243], v[108:111], v[168:171]
    ds_read_b64_tr_b16 a[234:235], v19 offset:51200
    v_mfma_f32_16x16x32_bf16 v[164:167], a[244:247], v[104:107], v[164:167]
    ds_read_b64_tr_b16 a[236:237], v19 offset:53248
    ds_read_b64_tr_b16 a[238:239], v19 offset:55296
    v_mfma_f32_16x16x32_bf16 v[172:175], a[244:247], v[108:111], v[172:175]
    ds_read_b32 v1, v31 offset:4
    s_waitcnt lgkmcnt(9)
    v_mfma_f32_16x16x32_bf16 v[176:179], a[248:251], v[104:107], v[176:179]
    ds_read_b64_tr_b16 a[240:241], v20 offset:49152
    v_mfma_f32_16x16x32_bf16 v[184:187], a[248:251], v[108:111], v[184:187]
    ds_read_b64_tr_b16 a[242:243], v20 offset:51200
    v_mfma_f32_16x16x32_bf16 v[180:183], a[252:255], v[104:107], v[180:183]
    ds_read_b64_tr_b16 a[244:245], v20 offset:53248
    v_mfma_f32_16x16x32_bf16 v[188:191], a[252:255], v[108:111], v[188:191]
    ds_read_b64_tr_b16 a[246:247], v20 offset:55296
    s_waitcnt lgkmcnt(9)
    v_mfma_f32_16x16x32_bf16 a[208:211], a[224:227], v[192:195], a[208:211]
    ds_read_b64_tr_b16 a[248:249], v21 offset:49152
    v_mfma_f32_16x16x32_bf16 a[216:219], a[224:227], v[196:199], a[216:219]
    ds_read_b64_tr_b16 a[250:251], v21 offset:51200
    s_waitcnt lgkmcnt(6)
    v_cmp_ne_u32 vcc, 0, v1
    v_mfma_f32_16x16x32_bf16 a[208:211], a[228:231], v[200:203], a[208:211]
    ds_read_b64_tr_b16 a[252:253], v21 offset:53248
    ds_read_b64_tr_b16 a[254:255], v21 offset:55296
    v_mfma_f32_16x16x32_bf16 a[216:219], a[228:231], v[204:207], a[216:219]
    ds_write_b32 v2, v31
    v_mfma_f32_16x16x32_bf16 a[212:215], a[232:235], v[192:195], a[212:215]
    s_getpc_b64 s[62:63]
    s_cbranch_vccnz L_cslow
    v_mfma_f32_16x16x32_bf16 a[220:223], a[232:235], v[196:199], a[220:223]
    ds_read_b64_tr_b16 a[224:225], v18 offset:57344
    ds_read_b64_tr_b16 a[226:227], v18 offset:59392
    v_mfma_f32_16x16x32_bf16 a[212:215], a[236:239], v[200:203], a[212:215]
    ds_read_b64_tr_b16 a[228:229], v19 offset:57344
    ds_read_b64_tr_b16 a[230:231], v19 offset:59392
    v_mfma_f32_16x16x32_bf16 a[220:223], a[236:239], v[204:207], a[220:223]
    v_add_u32 v31, 4, v31
    s_waitcnt lgkmcnt(9)
    v_mfma_f32_16x16x32_bf16 a[0:3], a[240:243], v[192:195], a[0:3]
    ds_read_b64_tr_b16 a[232:233], v20 offset:57344
    v_mfma_f32_16x16x32_bf16 a[8:11], a[240:243], v[196:199], a[8:11]
    ds_read_b64_tr_b16 a[234:235], v20 offset:59392
    v_mfma_f32_16x16x32_bf16 a[0:3], a[244:247], v[200:203], a[0:3]
    ds_read_b64_tr_b16 a[236:237], v21 offset:57344
    v_mfma_f32_16x16x32_bf16 a[8:11], a[244:247], v[204:207], a[8:11]
    ds_read_b64_tr_b16 a[238:239], v21 offset:59392
    s_waitcnt lgkmcnt(9)
    v_mfma_f32_16x16x32_bf16 a[4:7], a[248:251], v[192:195], a[4:7]
    ds_read_b64_tr_b16 a[240:241], v18 offset:61440
    v_mfma_f32_16x16x32_bf16 a[12:15], a[248:251], v[196:199], a[12:15]
    ds_read_b64_tr_b16 a[242:243], v18 offset:63488
    v_mfma_f32_16x16x32_bf16 a[4:7], a[252:255], v[200:203], a[4:7]
    ds_read_b64_tr_b16 a[244:245], v19 offset:61440
    v_mfma_f32_16x16x32_bf16 a[12:15], a[252:255], v[204:207], a[12:15]
    ds_read_b64_tr_b16 a[246:247], v19 offset:63488
    s_waitcnt lgkmcnt(8)
    v_mfma_f32_16x16x32_bf16 v[160:163], a[224:227], v[112:115], v[160:163]
    ds_read_b64_tr_b16 a[248:249], v20 offset:61440
    v_mfma_f32_16x16x32_bf16 v[168:171], a[224:227], v[116:119], v[168:171]
    ds_read_b64_tr_b16 a[250:251], v20 offset:63488
    v_mfma_f32_16x16x32_bf16 v[164:167], a[228:231], v[112:115], v[164:167]
    ds_read_b64_tr_b16 a[252:253], v21 offset:61440
    v_mfma_f32_16x16x32_bf16 v[172:175], a[228:231], v[116:119], v[172:175]
    ds_read_b64_tr_b16 a[254:255], v21 offset:63488
    s_waitcnt lgkmcnt(8)
    v_mfma_f32_16x16x32_bf16 v[176:179], a[232:235], v[112:115], v[176:179]
    ds_read_b64_tr_b16 a[224:225], v14 offset:32768
    v_mfma_f32_16x16x32_bf16 v[184:187], a[232:235], v[116:119], v[184:187]
    ds_read_b64_tr_b16 a[226:227], v14 offset:34816
    v_mfma_f32_16x16x32_bf16 v[180:183], a[236:239], v[112:115], v[180:183]
    ds_read_b64_tr_b16 a[228:229], v14 offset:36864
    v_mfma_f32_16x16x32_bf16 v[188:191], a[236:239], v[116:119], v[188:191]
    ds_read_b64_tr_b16 a[230:231], v14 offset:38912
    s_waitcnt lgkmcnt(8)
    v_mfma_f32_16x16x32_bf16 v[160:163], a[240:243], v[120:123], v[160:163]
    ds_read_b64_tr_b16 a[232:233], v15 offset:32768
    v_mfma_f32_16x16x32_bf16 v[168:171], a[240:243], v[124:127], v[168:171]
    ds_read_b64_tr_b16 a[234:235], v15 offset:34816
    v_mfma_f32_16x16x32_bf16 v[164:167], a[244:247], v[120:123], v[164:167]
    ds_read_b64_tr_b16 a[236:237], v15 offset:36864
    ds_read_b64_tr_b16 a[238:239], v15 offset:38912
    v_mfma_f32_16x16x32_bf16 v[172:175], a[244:247], v[124:127], v[172:175]
    ds_read_b32 v1, v31 offset:4
    s_waitcnt lgkmcnt(9)
    v_mfma_f32_16x16x32_bf16 v[176:179], a[248:251], v[120:123], v[176:179]
    ds_read_b64_tr_b16 a[240:241], v16 offset:32768
    v_mfma_f32_16x16x32_bf16 v[184:187], a[248:251], v[124:127], v[184:187]
    ds_read_b64_tr_b16 a[242:243], v16 offset:34816
    v_mfma_f32_16x16x32_bf16 v[180:183], a[252:255], v[120:123], v[180:183]
    ds_read_b64_tr_b16 a[244:245], v16 offset:36864
    v_mfma_f32_16x16x32_bf16 v[188:191], a[252:255], v[124:127], v[188:191]
    ds_read_b64_tr_b16 a[246:247], v16 offset:38912
    s_waitcnt lgkmcnt(9)
    v_mfma_f32_16x16x32_bf16 a[16:19], a[224:227], v[192:195], a[16:19]
    ds_read_b64_tr_b16 a[248:249], v17 offset:32768
    v_mfma_f32_16x16x32_bf16 a[24:27], a[224:227], v[196:199], a[24:27]
    ds_read_b64_tr_b16 a[250:251], v17 offset:34816
    s_waitcnt lgkmcnt(6)
    v_cmp_ne_u32 vcc, 0, v1
    v_mfma_f32_16x16x32_bf16 a[16:19], a[228:231], v[200:203], a[16:19]
    ds_read_b64_tr_b16 a[252:253], v17 offset:36864
    ds_read_b64_tr_b16 a[254:255], v17 offset:38912
    v_mfma_f32_16x16x32_bf16 a[24:27], a[228:231], v[204:207], a[24:27]
    ds_write_b32 v2, v31
    v_mfma_f32_16x16x32_bf16 a[20:23], a[232:235], v[192:195], a[20:23]
    s_getpc_b64 s[62:63]
    s_cbranch_vccnz L_cslow
    v_mfma_f32_16x16x32_bf16 a[28:31], a[232:235], v[196:199], a[28:31]
    ds_read_b64_tr_b16 a[224:225], v18 offset:24576
    ds_read_b64_tr_b16 a[226:227], v18 offset:26624
    v_mfma_f32_16x16x32_bf16 a[20:23], a[236:239], v[200:203], a[20:23]
    ds_read_b64_tr_b16 a[228:229], v19 offset:24576
    ds_read_b64_tr_b16 a[230:231], v19 offset:26624
    v_mfma_f32_16x16x32_bf16 a[28:31], a[236:239], v[204:207], a[28:31]
    v_add_u32 v31, 4, v31
    s_waitcnt lgkmcnt(9)
    v_mfma_f32_16x16x32_bf16 a[32:35], a[240:243], v[192:195], a[32:35]
    ds_read_b64_tr_b16 a[232:233], v20 offset:24576
    v_mfma_f32_16x16x32_bf16 a[40:43], a[240:243], v[196:199], a[40:43]
    ds_read_b64_tr_b16 a[234:235], v20 offset:26624
    v_mfma_f32_16x16x32_bf16 a[32:35], a[244:247], v[200:203], a[32:35]
    ds_read_b64_tr_b16 a[236:237], v21 offset:24576
    v_mfma_f32_16x16x32_bf16 a[40:43], a[244:247], v[204:207], a[40:43]
    ds_read_b64_tr_b16 a[238:239], v21 offset:26624
    s_waitcnt lgkmcnt(9)
    v_mfma_f32_16x16x32_bf16 a[36:39], a[248:251], v[192:195], a[36:39]
    ds_read_b64_tr_b16 a[240:241], v18 offset:28672
    v_mfma_f32_16x16x32_bf16 a[44:47], a[248:251], v[196:199], a[44:47]
    ds_read_b64_tr_b16 a[242:243], v18 offset:30720
    v_mfma_f32_16x16x32_bf16 a[36:39], a[252:255], v[200:203], a[36:39]
    ds_read_b64_tr_b16 a[244:245], v19 offset:28672
    v_mfma_f32_16x16x32_bf16 a[44:47], a[252:255], v[204:207], a[44:47]
    ds_read_b64_tr_b16 a[246:247], v19 offset:30720
    s_waitcnt lgkmcnt(8)
    v_mfma_f32_16x16x32_bf16 v[160:163], a[224:227], v[128:131], v[160:163]
    ds_read_b64_tr_b16 a[248:249], v20 offset:28672
    v_mfma_f32_16x16x32_bf16 v[168:171], a[224:227], v[132:135], v[168:171]
    ds_read_b64_tr_b16 a[250:251], v20 offset:30720
    v_mfma_f32_16x16x32_bf16 v[164:167], a[228:231], v[128:131], v[164:167]
    ds_read_b64_tr_b16 a[252:253], v21 offset:28672
    v_mfma_f32_16x16x32_bf16 v[172:175], a[228:231], v[132:135], v[172:175]
    ds_read_b64_tr_b16 a[254:255], v21 offset:30720
    s_waitcnt lgkmcnt(8)
    v_mfma_f32_16x16x32_bf16 v[176:179], a[232:235], v[128:131], v[176:179]
    ds_read_b64_tr_b16 a[224:225], v22 offset:16384
    v_mfma_f32_16x16x32_bf16 v[184:187], a[232:235], v[132:135], v[184:187]
    ds_read_b64_tr_b16 a[226:227], v22 offset:18432
    v_mfma_f32_16x16x32_bf16 v[180:183], a[236:239], v[128:131], v[180:183]
    ds_read_b64_tr_b16 a[228:229], v22 offset:20480
    v_mfma_f32_16x16x32_bf16 v[188:191], a[236:239], v[132:135], v[188:191]
    ds_read_b64_tr_b16 a[230:231], v22 offset:22528
    s_waitcnt lgkmcnt(8)
    v_mfma_f32_16x16x32_bf16 v[160:163], a[240:243], v[136:139], v[160:163]
    ds_read_b64_tr_b16 a[232:233], v23 offset:16384
    v_mfma_f32_16x16x32_bf16 v[168:171], a[240:243], v[140:143], v[168:171]
    ds_read_b64_tr_b16 a[234:235], v23 offset:18432
    v_mfma_f32_16x16x32_bf16 v[164:167], a[244:247], v[136:139], v[164:167]
    ds_read_b64_tr_b16 a[236:237], v23 offset:20480
    ds_read_b64_tr_b16 a[238:239], v23 offset:22528
    v_mfma_f32_16x16x32_bf16 v[172:175], a[244:247], v[140:143], v[172:175]
    ds_read_b32 v1, v31 offset:4
    s_waitcnt lgkmcnt(9)
    v_mfma_f32_16x16x32_bf16 v[176:179], a[248:251], v[136:139], v[176:179]
    ds_read_b64_tr_b16 a[240:241], v24 offset:16384
    v_mfma_f32_16x16x32_bf16 v[184:187], a[248:251], v[140:143], v[184:187]
    ds_read_b64_tr_b16 a[242:243], v24 offset:18432
    v_mfma_f32_16x16x32_bf16 v[180:183], a[252:255], v[136:139], v[180:183]
    ds_read_b64_tr_b16 a[244:245], v24 offset:20480
    v_mfma_f32_16x16x32_bf16 v[188:191], a[252:255], v[140:143], v[188:191]
    ds_read_b64_tr_b16 a[246:247], v24 offset:22528
    s_waitcnt lgkmcnt(9)
    v_mfma_f32_16x16x32_bf16 a[48:51], a[224:227], v[192:195], a[48:51]
    ds_read_b64_tr_b16 a[248:249], v25 offset:16384
    v_mfma_f32_16x16x32_bf16 a[56:59], a[224:227], v[196:199], a[56:59]
    ds_read_b64_tr_b16 a[250:251], v25 offset:18432
    s_waitcnt lgkmcnt(6)
    v_cmp_ne_u32 vcc, 0, v1
    v_mfma_f32_16x16x32_bf16 a[48:51], a[228:231], v[200:203], a[48:51]
    ds_read_b64_tr_b16 a[252:253], v25 offset:20480
    ds_read_b64_tr_b16 a[254:255], v25 offset:22528
    v_mfma_f32_16x16x32_bf16 a[56:59], a[228:231], v[204:207], a[56:59]
    ds_write_b32 v2, v31
    v_mfma_f32_16x16x32_bf16 a[52:55], a[232:235], v[192:195], a[52:55]
    s_getpc_b64 s[62:63]
    s_cbranch_vccnz L_cslow
    v_mfma_f32_16x16x32_bf16 a[60:63], a[232:235], v[196:199], a[60:63]
    ds_read_b64_tr_b16 a[224:225], v18 offset:32768
    ds_read_b64_tr_b16 a[226:227], v18 offset:34816
    v_mfma_f32_16x16x32_bf16 a[52:55], a[236:239], v[200:203], a[52:55]
    ds_read_b64_tr_b16 a[228:229], v19 offset:32768
    ds_read_b64_tr_b16 a[230:231], v19 offset:34816
    v_mfma_f32_16x16x32_bf16 a[60:63], a[236:239], v[204:207], a[60:63]
    v_add_u32 v31, 4, v31
    s_waitcnt lgkmcnt(9)
    v_mfma_f32_16x16x32_bf16 a[64:67], a[240:243], v[192:195], a[64:67]
    ds_read_b64_tr_b16 a[232:233], v18 offset:36864
    v_mfma_f32_16x16x32_bf16 a[72:75], a[240:243], v[196:199], a[72:75]
    ds_read_b64_tr_b16 a[234:235], v18 offset:38912
    v_mfma_f32_16x16x32_bf16 a[64:67], a[244:247], v[200:203], a[64:67]
    ds_read_b64_tr_b16 a[236:237], v19 offset:36864
    v_mfma_f32_16x16x32_bf16 a[72:75], a[244:247], v[204:207], a[72:75]
    ds_read_b64_tr_b16 a[238:239], v19 offset:38912
    s_waitcnt lgkmcnt(9)
    v_mfma_f32_16x16x32_bf16 a[68:71], a[248:251], v[192:195], a[68:71]
    ds_read_b64_tr_b16 a[240:241], v20 offset:32768
    v_mfma_f32_16x16x32_bf16 a[76:79], a[248:251], v[196:199], a[76:79]
    ds_read_b64_tr_b16 a[242:243], v20 offset:34816
    v_mfma_f32_16x16x32_bf16 a[68:71], a[252:255], v[200:203], a[68:71]
    ds_read_b64_tr_b16 a[244:245], v21 offset:32768
    v_mfma_f32_16x16x32_bf16 a[76:79], a[252:255], v[204:207], a[76:79]
    ds_read_b64_tr_b16 a[246:247], v21 offset:34816
    s_waitcnt lgkmcnt(8)
    v_mfma_f32_16x16x32_bf16 v[160:163], a[224:227], v[144:147], v[160:163]
    ds_read_b64_tr_b16 a[248:249], v20 offset:36864
    v_mfma_f32_16x16x32_bf16 v[168:171], a[224:227], v[148:151], v[168:171]
    ds_read_b64_tr_b16 a[250:251], v20 offset:38912
    v_mfma_f32_16x16x32_bf16 v[164:167], a[228:231], v[144:147], v[164:167]
    ds_read_b64_tr_b16 a[252:253], v21 offset:36864
    v_mfma_f32_16x16x32_bf16 v[172:175], a[228:231], v[148:151], v[172:175]
    ds_read_b64_tr_b16 a[254:255], v21 offset:38912
    s_waitcnt lgkmcnt(8)
    v_mfma_f32_16x16x32_bf16 v[160:163], a[232:235], v[152:155], v[160:163]
    ds_read_b64_tr_b16 a[224:225], v18 offset:8192
    v_mfma_f32_16x16x32_bf16 v[168:171], a[232:235], v[156:159], v[168:171]
    ds_read_b64_tr_b16 a[226:227], v18 offset:10240
    v_mfma_f32_16x16x32_bf16 v[164:167], a[236:239], v[152:155], v[164:167]
    ds_read_b64_tr_b16 a[228:229], v18 offset:12288
    v_mfma_f32_16x16x32_bf16 v[172:175], a[236:239], v[156:159], v[172:175]
    ds_read_b64_tr_b16 a[230:231], v18 offset:14336
    s_waitcnt lgkmcnt(8)
    v_mfma_f32_16x16x32_bf16 v[176:179], a[240:243], v[144:147], v[176:179]
    ds_read_b64_tr_b16 a[232:233], v19 offset:8192
    v_mfma_f32_16x16x32_bf16 v[184:187], a[240:243], v[148:151], v[184:187]
    ds_read_b64_tr_b16 a[234:235], v19 offset:10240
    v_mfma_f32_16x16x32_bf16 v[180:183], a[244:247], v[144:147], v[180:183]
    ds_read_b64_tr_b16 a[236:237], v19 offset:12288
    ds_read_b64_tr_b16 a[238:239], v19 offset:14336
    v_mul_f32 v160, v26, v160
    v_mfma_f32_16x16x32_bf16 v[188:191], a[244:247], v[148:151], v[188:191]
    ds_read_b32 v1, v31 offset:4
    v_mul_f32 v161, v26, v161
    s_waitcnt lgkmcnt(9)
    v_mfma_f32_16x16x32_bf16 v[176:179], a[248:251], v[152:155], v[176:179]
    ds_read_b64_tr_b16 a[240:241], v20 offset:8192
    v_mul_f32 v162, v26, v162
    v_mul_f32 v163, v26, v163
    v_mfma_f32_16x16x32_bf16 v[184:187], a[248:251], v[156:159], v[184:187]
    ds_read_b64_tr_b16 a[242:243], v20 offset:10240
    v_mul_f32 v164, v26, v164
    v_mul_f32 v165, v26, v165
    v_mfma_f32_16x16x32_bf16 v[180:183], a[252:255], v[152:155], v[180:183]
    ds_read_b64_tr_b16 a[244:245], v20 offset:12288
    v_mul_f32 v166, v26, v166
    v_mul_f32 v167, v26, v167
    v_mfma_f32_16x16x32_bf16 v[188:191], a[252:255], v[156:159], v[188:191]
    ds_read_b64_tr_b16 a[246:247], v20 offset:14336
    v_cvt_pk_bf16_f32 v160, v160, v161
    s_waitcnt lgkmcnt(9)
    v_mfma_f32_16x16x32_bf16 a[80:83], a[224:227], v[192:195], a[80:83]
    ds_read_b64_tr_b16 a[248:249], v21 offset:8192
    v_cvt_pk_bf16_f32 v161, v162, v163
    v_cvt_pk_bf16_f32 v162, v164, v165
    v_mfma_f32_16x16x32_bf16 a[88:91], a[224:227], v[196:199], a[88:91]
    ds_read_b64_tr_b16 a[250:251], v21 offset:10240
    s_waitcnt lgkmcnt(6)
    v_cmp_ne_u32 vcc, 0, v1
    v_cvt_pk_bf16_f32 v163, v166, v167
    v_mfma_f32_16x16x32_bf16 a[80:83], a[228:231], v[200:203], a[80:83]
    ds_read_b64_tr_b16 a[252:253], v21 offset:12288
    ds_read_b64_tr_b16 a[254:255], v21 offset:14336
    v_mul_f32 v168, v27, v168
    v_mfma_f32_16x16x32_bf16 a[88:91], a[228:231], v[204:207], a[88:91]
    ds_write_b32 v2, v31
    v_mul_f32 v169, v27, v169
    v_mfma_f32_16x16x32_bf16 a[84:87], a[232:235], v[192:195], a[84:87]
    s_getpc_b64 s[62:63]
    s_cbranch_vccnz L_cslow
    v_mul_f32 v170, v27, v170
    v_mfma_f32_16x16x32_bf16 a[92:95], a[232:235], v[196:199], a[92:95]
    ds_read_b64_tr_b16 a[224:225], v22 offset:0
    ds_read_b64_tr_b16 a[226:227], v22 offset:2048
    v_mul_f32 v171, v27, v171
    v_mfma_f32_16x16x32_bf16 a[84:87], a[236:239], v[200:203], a[84:87]
    ds_read_b64_tr_b16 a[228:229], v23 offset:0
    ds_read_b64_tr_b16 a[230:231], v23 offset:2048
    v_mul_f32 v172, v27, v172
    v_mfma_f32_16x16x32_bf16 a[92:95], a[236:239], v[204:207], a[92:95]
    v_add_u32 v31, 4, v31
    v_mul_f32 v173, v27, v173
    s_waitcnt lgkmcnt(9)
    v_mfma_f32_16x16x32_bf16 a[96:99], a[240:243], v[192:195], a[96:99]
    ds_read_b64_tr_b16 a[232:233], v24 offset:0
    v_mul_f32 v174, v27, v174
    v_mul_f32 v175, v27, v175
    v_mfma_f32_16x16x32_bf16 a[104:107], a[240:243], v[196:199], a[104:107]
    ds_read_b64_tr_b16 a[234:235], v24 offset:2048
    v_cvt_pk_bf16_f32 v164, v168, v169
    v_cvt_pk_bf16_f32 v165, v170, v171
    v_mfma_f32_16x16x32_bf16 a[96:99], a[244:247], v[200:203], a[96:99]
    ds_read_b64_tr_b16 a[236:237], v25 offset:0
    v_cvt_pk_bf16_f32 v166, v172, v173
    v_cvt_pk_bf16_f32 v167, v174, v175
    v_mfma_f32_16x16x32_bf16 a[104:107], a[244:247], v[204:207], a[104:107]
    ds_read_b64_tr_b16 a[238:239], v25 offset:2048
    v_mul_f32 v176, v26, v176
    s_waitcnt lgkmcnt(9)
    v_mfma_f32_16x16x32_bf16 a[100:103], a[248:251], v[192:195], a[100:103]
    ds_read_b64_tr_b16 a[240:241], v22 offset:4096
    v_mul_f32 v177, v26, v177
    v_mul_f32 v178, v26, v178
    v_mfma_f32_16x16x32_bf16 a[108:111], a[248:251], v[196:199], a[108:111]
    ds_read_b64_tr_b16 a[242:243], v22 offset:6144
    v_mul_f32 v179, v26, v179
    v_mul_f32 v180, v26, v180
    v_mfma_f32_16x16x32_bf16 a[100:103], a[252:255], v[200:203], a[100:103]
    ds_read_b64_tr_b16 a[244:245], v23 offset:4096
    v_mul_f32 v181, v26, v181
    v_mul_f32 v182, v26, v182
    v_mfma_f32_16x16x32_bf16 a[108:111], a[252:255], v[204:207], a[108:111]
    ds_read_b64_tr_b16 a[246:247], v23 offset:6144
    v_mul_f32 v183, v26, v183
    s_waitcnt lgkmcnt(8)
    v_mfma_f32_16x16x32_bf16 v[224:227], a[224:227], v[32:35], 0
    ds_read_b64_tr_b16 a[248:249], v24 offset:4096
    v_cvt_pk_bf16_f32 v168, v176, v177
    v_cvt_pk_bf16_f32 v169, v178, v179
    v_mfma_f32_16x16x32_bf16 v[232:235], a[224:227], v[36:39], 0
    ds_read_b64_tr_b16 a[250:251], v24 offset:6144
    v_cvt_pk_bf16_f32 v170, v180, v181
    v_cvt_pk_bf16_f32 v171, v182, v183
    v_mfma_f32_16x16x32_bf16 v[228:231], a[228:231], v[32:35], 0
    ds_read_b64_tr_b16 a[252:253], v25 offset:4096
    v_mul_f32 v184, v27, v184
    v_mul_f32 v185, v27, v185
    v_mfma_f32_16x16x32_bf16 v[236:239], a[228:231], v[36:39], 0
    ds_read_b64_tr_b16 a[254:255], v25 offset:6144
    v_mul_f32 v186, v27, v186
    s_waitcnt lgkmcnt(8)
    v_mfma_f32_16x16x32_bf16 v[240:243], a[232:235], v[32:35], 0
    ds_read_b64_tr_b16 a[224:225], v14 offset:8192
    v_mul_f32 v187, v27, v187
    v_mul_f32 v188, v27, v188
    v_mfma_f32_16x16x32_bf16 v[248:251], a[232:235], v[36:39], 0
    ds_read_b64_tr_b16 a[226:227], v14 offset:10240
    v_mul_f32 v189, v27, v189
    v_mul_f32 v190, v27, v190
    v_mfma_f32_16x16x32_bf16 v[244:247], a[236:239], v[32:35], 0
    ds_read_b64_tr_b16 a[228:229], v15 offset:8192
    v_mul_f32 v191, v27, v191
    v_cvt_pk_bf16_f32 v172, v184, v185
    v_mfma_f32_16x16x32_bf16 v[252:255], a[236:239], v[36:39], 0
    ds_read_b64_tr_b16 a[230:231], v15 offset:10240
    v_cvt_pk_bf16_f32 v173, v186, v187
    s_waitcnt lgkmcnt(8)
    v_mfma_f32_16x16x32_bf16 v[224:227], a[240:243], v[40:43], v[224:227]
    ds_read_b64_tr_b16 a[232:233], v16 offset:8192
    v_cvt_pk_bf16_f32 v174, v188, v189
    v_cvt_pk_bf16_f32 v175, v190, v191
    v_mfma_f32_16x16x32_bf16 v[232:235], a[240:243], v[44:47], v[232:235]
    ds_read_b64_tr_b16 a[234:235], v16 offset:10240
    v_mfma_f32_16x16x32_bf16 v[228:231], a[244:247], v[40:43], v[228:231]
    ds_read_b64_tr_b16 a[236:237], v17 offset:8192
    ds_read_b64_tr_b16 a[238:239], v17 offset:10240
    v_mfma_f32_16x16x32_bf16 v[236:239], a[244:247], v[44:47], v[236:239]
    ds_read_b32 v1, v31 offset:4
    s_waitcnt lgkmcnt(9)
    v_mfma_f32_16x16x32_bf16 v[240:243], a[248:251], v[40:43], v[240:243]
    ds_read_b64_tr_b16 a[240:241], v14 offset:12288
    v_mfma_f32_16x16x32_bf16 v[248:251], a[248:251], v[44:47], v[248:251]
    ds_read_b64_tr_b16 a[242:243], v14 offset:14336
    v_mfma_f32_16x16x32_bf16 v[244:247], a[252:255], v[40:43], v[244:247]
    ds_read_b64_tr_b16 a[244:245], v15 offset:12288
    v_mfma_f32_16x16x32_bf16 v[252:255], a[252:255], v[44:47], v[252:255]
    ds_read_b64_tr_b16 a[246:247], v15 offset:14336
    s_waitcnt lgkmcnt(9)
    v_mfma_f32_16x16x32_bf16 v[224:227], a[224:227], v[48:51], v[224:227]
    ds_read_b64_tr_b16 a[248:249], v16 offset:12288
    v_mfma_f32_16x16x32_bf16 v[232:235], a[224:227], v[52:55], v[232:235]
    ds_read_b64_tr_b16 a[250:251], v16 offset:14336
    s_waitcnt lgkmcnt(6)
    v_cmp_ne_u32 vcc, 0, v1
    v_mfma_f32_16x16x32_bf16 v[228:231], a[228:231], v[48:51], v[228:231]
    ds_read_b64_tr_b16 a[252:253], v17 offset:12288
    ds_read_b64_tr_b16 a[254:255], v17 offset:14336
    v_mfma_f32_16x16x32_bf16 v[236:239], a[228:231], v[52:55], v[236:239]
    ds_write_b32 v2, v31
    v_mfma_f32_16x16x32_bf16 v[240:243], a[232:235], v[48:51], v[240:243]
    s_getpc_b64 s[62:63]
    s_cbranch_vccnz L_cslow
    v_mfma_f32_16x16x32_bf16 v[248:251], a[232:235], v[52:55], v[248:251]
    ds_read_b64_tr_b16 a[224:225], v14 offset:49152
    ds_read_b64_tr_b16 a[226:227], v14 offset:51200
    v_mfma_f32_16x16x32_bf16 v[244:247], a[236:239], v[48:51], v[244:247]
    ds_read_b64_tr_b16 a[228:229], v15 offset:49152
    ds_read_b64_tr_b16 a[230:231], v15 offset:51200
    v_mfma_f32_16x16x32_bf16 v[252:255], a[236:239], v[52:55], v[252:255]
    v_add_u32 v31, 4, v31
    s_waitcnt lgkmcnt(9)
    v_mfma_f32_16x16x32_bf16 v[224:227], a[240:243], v[56:59], v[224:227]
    ds_read_b64_tr_b16 a[232:233], v16 offset:49152
    v_mfma_f32_16x16x32_bf16 v[232:235], a[240:243], v[60:63], v[232:235]
    ds_read_b64_tr_b16 a[234:235], v16 offset:51200
    v_mfma_f32_16x16x32_bf16 v[228:231], a[244:247], v[56:59], v[228:231]
    ds_read_b64_tr_b16 a[236:237], v17 offset:49152
    v_mfma_f32_16x16x32_bf16 v[236:239], a[244:247], v[60:63], v[236:239]
    ds_read_b64_tr_b16 a[238:239], v17 offset:51200
    s_waitcnt lgkmcnt(9)
    v_mfma_f32_16x16x32_bf16 v[240:243], a[248:251], v[56:59], v[240:243]
    ds_read_b64_tr_b16 a[240:241], v14 offset:53248
    v_mfma_f32_16x16x32_bf16 v[248:251], a[248:251], v[60:63], v[248:251]
    ds_read_b64_tr_b16 a[242:243], v14 offset:55296
    v_mfma_f32_16x16x32_bf16 v[244:247], a[252:255], v[56:59], v[244:247]
    ds_read_b64_tr_b16 a[244:245], v15 offset:53248
    v_mfma_f32_16x16x32_bf16 v[252:255], a[252:255], v[60:63], v[252:255]
    ds_read_b64_tr_b16 a[246:247], v15 offset:55296
    s_waitcnt lgkmcnt(8)
    v_mfma_f32_16x16x32_bf16 v[224:227], a[224:227], v[64:67], v[224:227]
    ds_read_b64_tr_b16 a[248:249], v16 offset:53248
    v_mfma_f32_16x16x32_bf16 v[232:235], a[224:227], v[68:71], v[232:235]
    ds_read_b64_tr_b16 a[250:251], v16 offset:55296
    v_mfma_f32_16x16x32_bf16 v[228:231], a[228:231], v[64:67], v[228:231]
    ds_read_b64_tr_b16 a[252:253], v17 offset:53248
    v_mfma_f32_16x16x32_bf16 v[236:239], a[228:231], v[68:71], v[236:239]
    ds_read_b64_tr_b16 a[254:255], v17 offset:55296
    s_waitcnt lgkmcnt(8)
    v_mfma_f32_16x16x32_bf16 v[240:243], a[232:235], v[64:67], v[240:243]
    ds_read_b64_tr_b16 a[224:225], v18 offset:16384
    v_mfma_f32_16x16x32_bf16 v[248:251], a[232:235], v[68:71], v[248:251]
    ds_read_b64_tr_b16 a[226:227], v18 offset:18432
    v_mfma_f32_16x16x32_bf16 v[244:247], a[236:239], v[64:67], v[244:247]
    ds_read_b64_tr_b16 a[228:229], v19 offset:16384
    v_mfma_f32_16x16x32_bf16 v[252:255], a[236:239], v[68:71], v[252:255]
    ds_read_b64_tr_b16 a[230:231], v19 offset:18432
    s_waitcnt lgkmcnt(8)
    v_mfma_f32_16x16x32_bf16 v[224:227], a[240:243], v[72:75], v[224:227]
    ds_read_b64_tr_b16 a[232:233], v20 offset:16384
    v_mfma_f32_16x16x32_bf16 v[232:235], a[240:243], v[76:79], v[232:235]
    ds_read_b64_tr_b16 a[234:235], v20 offset:18432
    v_mfma_f32_16x16x32_bf16 v[228:231], a[244:247], v[72:75], v[228:231]
    ds_read_b64_tr_b16 a[236:237], v21 offset:16384
    ds_read_b64_tr_b16 a[238:239], v21 offset:18432
    v_mfma_f32_16x16x32_bf16 v[236:239], a[244:247], v[76:79], v[236:239]
    ds_read_b32 v1, v31 offset:4
    s_waitcnt lgkmcnt(9)
    v_mfma_f32_16x16x32_bf16 v[240:243], a[248:251], v[72:75], v[240:243]
    ds_read_b64_tr_b16 a[240:241], v18 offset:20480
    v_mfma_f32_16x16x32_bf16 v[248:251], a[248:251], v[76:79], v[248:251]
    ds_read_b64_tr_b16 a[242:243], v18 offset:22528
    v_mfma_f32_16x16x32_bf16 v[244:247], a[252:255], v[72:75], v[244:247]
    ds_read_b64_tr_b16 a[244:245], v19 offset:20480
    v_mfma_f32_16x16x32_bf16 v[252:255], a[252:255], v[76:79], v[252:255]
    ds_read_b64_tr_b16 a[246:247], v19 offset:22528
    s_waitcnt lgkmcnt(9)
    v_mfma_f32_16x16x32_bf16 v[224:227], a[224:227], v[80:83], v[224:227]
    ds_read_b64_tr_b16 a[248:249], v20 offset:20480
    v_mfma_f32_16x16x32_bf16 v[232:235], a[224:227], v[84:87], v[232:235]
    ds_read_b64_tr_b16 a[250:251], v20 offset:22528
    s_waitcnt lgkmcnt(6)
    v_cmp_ne_u32 vcc, 0, v1
    v_mfma_f32_16x16x32_bf16 v[228:231], a[228:231], v[80:83], v[228:231]
    ds_read_b64_tr_b16 a[252:253], v21 offset:20480
    ds_read_b64_tr_b16 a[254:255], v21 offset:22528
    v_mfma_f32_16x16x32_bf16 v[236:239], a[228:231], v[84:87], v[236:239]
    ds_write_b32 v2, v31
    v_mfma_f32_16x16x32_bf16 v[240:243], a[232:235], v[80:83], v[240:243]
    s_getpc_b64 s[62:63]
    s_cbranch_vccnz L_cslow
    v_mfma_f32_16x16x32_bf16 v[248:251], a[232:235], v[84:87], v[248:251]
    ds_read_b64_tr_b16 a[224:225], v18 offset:40960
    ds_read_b64_tr_b16 a[226:227], v18 offset:43008
    v_mfma_f32_16x16x32_bf16 v[244:247], a[236:239], v[80:83], v[244:247]
    ds_read_b64_tr_b16 a[228:229], v19 offset:40960
    ds_read_b64_tr_b16 a[230:231], v19 offset:43008
    v_mfma_f32_16x16x32_bf16 v[252:255], a[236:239], v[84:87], v[252:255]
    v_add_u32 v31, 4, v31
    s_waitcnt lgkmcnt(9)
    v_mfma_f32_16x16x32_bf16 v[224:227], a[240:243], v[88:91], v[224:227]
    ds_read_b64_tr_b16 a[232:233], v20 offset:40960
    v_mfma_f32_16x16x32_bf16 v[232:235], a[240:243], v[92:95], v[232:235]
    ds_read_b64_tr_b16 a[234:235], v20 offset:43008
    v_mfma_f32_16x16x32_bf16 v[228:231], a[244:247], v[88:91], v[228:231]
    ds_read_b64_tr_b16 a[236:237], v21 offset:40960
    v_mfma_f32_16x16x32_bf16 v[236:239], a[244:247], v[92:95], v[236:239]
    ds_read_b64_tr_b16 a[238:239], v21 offset:43008
    s_waitcnt lgkmcnt(9)
    v_mfma_f32_16x16x32_bf16 v[240:243], a[248:251], v[88:91], v[240:243]
    ds_read_b64_tr_b16 a[240:241], v18 offset:45056
    v_mfma_f32_16x16x32_bf16 v[248:251], a[248:251], v[92:95], v[248:251]
    ds_read_b64_tr_b16 a[242:243], v18 offset:47104
    v_mfma_f32_16x16x32_bf16 v[244:247], a[252:255], v[88:91], v[244:247]
    ds_read_b64_tr_b16 a[244:245], v19 offset:45056
    v_mfma_f32_16x16x32_bf16 v[252:255], a[252:255], v[92:95], v[252:255]
    ds_read_b64_tr_b16 a[246:247], v19 offset:47104
    s_waitcnt lgkmcnt(8)
    v_mfma_f32_16x16x32_bf16 v[224:227], a[224:227], v[96:99], v[224:227]
    ds_read_b64_tr_b16 a[248:249], v20 offset:45056
    v_mfma_f32_16x16x32_bf16 v[232:235], a[224:227], v[100:103], v[232:235]
    ds_read_b64_tr_b16 a[250:251], v20 offset:47104
    v_mfma_f32_16x16x32_bf16 v[228:231], a[228:231], v[96:99], v[228:231]
    ds_read_b64_tr_b16 a[252:253], v21 offset:45056
    v_mfma_f32_16x16x32_bf16 v[236:239], a[228:231], v[100:103], v[236:239]
    ds_read_b64_tr_b16 a[254:255], v21 offset:47104
    s_waitcnt lgkmcnt(8)
    v_mfma_f32_16x16x32_bf16 v[240:243], a[232:235], v[96:99], v[240:243]
    ds_read_b64_tr_b16 a[224:225], v14 offset:0
    v_mfma_f32_16x16x32_bf16 v[248:251], a[232:235], v[100:103], v[248:251]
    ds_read_b64_tr_b16 a[226:227], v14 offset:2048
    v_mfma_f32_16x16x32_bf16 v[244:247], a[236:239], v[96:99], v[244:247]
    ds_read_b64_tr_b16 a[228:229], v15 offset:0
    v_mfma_f32_16x16x32_bf16 v[252:255], a[236:239], v[100:103], v[252:255]
    ds_read_b64_tr_b16 a[230:231], v15 offset:2048
    s_waitcnt lgkmcnt(8)
    v_mfma_f32_16x16x32_bf16 v[224:227], a[240:243], v[104:107], v[224:227]
    ds_read_b64_tr_b16 a[232:233], v16 offset:0
    v_mfma_f32_16x16x32_bf16 v[232:235], a[240:243], v[108:111], v[232:235]
    ds_read_b64_tr_b16 a[234:235], v16 offset:2048
    v_mfma_f32_16x16x32_bf16 v[228:231], a[244:247], v[104:107], v[228:231]
    ds_read_b64_tr_b16 a[236:237], v17 offset:0
    ds_read_b64_tr_b16 a[238:239], v17 offset:2048
    v_mfma_f32_16x16x32_bf16 v[236:239], a[244:247], v[108:111], v[236:239]
    ds_read_b32 v1, v31 offset:4
    s_waitcnt lgkmcnt(9)
    v_mfma_f32_16x16x32_bf16 v[240:243], a[248:251], v[104:107], v[240:243]
    ds_read_b64_tr_b16 a[240:241], v14 offset:4096
    v_mfma_f32_16x16x32_bf16 v[248:251], a[248:251], v[108:111], v[248:251]
    ds_read_b64_tr_b16 a[242:243], v14 offset:6144
    v_mfma_f32_16x16x32_bf16 v[244:247], a[252:255], v[104:107], v[244:247]
    ds_read_b64_tr_b16 a[244:245], v15 offset:4096
    v_mfma_f32_16x16x32_bf16 v[252:255], a[252:255], v[108:111], v[252:255]
    ds_read_b64_tr_b16 a[246:247], v15 offset:6144
    s_waitcnt lgkmcnt(9)
    v_mfma_f32_16x16x32_bf16 v[224:227], a[224:227], v[112:115], v[224:227]
    ds_read_b64_tr_b16 a[248:249], v16 offset:4096
    v_mfma_f32_16x16x32_bf16 v[232:235], a[224:227], v[116:119], v[232:235]
    ds_read_b64_tr_b16 a[250:251], v16 offset:6144
    s_waitcnt lgkmcnt(6)
    v_cmp_ne_u32 vcc, 0, v1
    v_mfma_f32_16x16x32_bf16 v[228:231], a[228:231], v[112:115], v[228:231]
    ds_read_b64_tr_b16 a[252:253], v17 offset:4096
    ds_read_b64_tr_b16 a[254:255], v17 offset:6144
    v_mfma_f32_16x16x32_bf16 v[236:239], a[228:231], v[116:119], v[236:239]
    ds_write_b32 v2, v31
    v_mfma_f32_16x16x32_bf16 v[240:243], a[232:235], v[112:115], v[240:243]
    s_getpc_b64 s[62:63]
    s_cbranch_vccnz L_cslow
    v_mfma_f32_16x16x32_bf16 v[248:251], a[232:235], v[116:119], v[248:251]
    ds_read_b64_tr_b16 a[224:225], v14 offset:57344
    ds_read_b64_tr_b16 a[226:227], v14 offset:59392
    v_mfma_f32_16x16x32_bf16 v[244:247], a[236:239], v[112:115], v[244:247]
    ds_read_b64_tr_b16 a[228:229], v15 offset:57344
    ds_read_b64_tr_b16 a[230:231], v15 offset:59392
    v_mfma_f32_16x16x32_bf16 v[252:255], a[236:239], v[116:119], v[252:255]
    v_add_u32 v31, 4, v31
    s_waitcnt lgkmcnt(9)
    v_mfma_f32_16x16x32_bf16 v[224:227], a[240:243], v[120:123], v[224:227]
    ds_read_b64_tr_b16 a[232:233], v16 offset:57344
    v_mfma_f32_16x16x32_bf16 v[232:235], a[240:243], v[124:127], v[232:235]
    ds_read_b64_tr_b16 a[234:235], v16 offset:59392
    v_mfma_f32_16x16x32_bf16 v[228:231], a[244:247], v[120:123], v[228:231]
    ds_read_b64_tr_b16 a[236:237], v17 offset:57344
    v_mfma_f32_16x16x32_bf16 v[236:239], a[244:247], v[124:127], v[236:239]
    ds_read_b64_tr_b16 a[238:239], v17 offset:59392
    s_waitcnt lgkmcnt(9)
    v_mfma_f32_16x16x32_bf16 v[240:243], a[248:251], v[120:123], v[240:243]
    ds_read_b64_tr_b16 a[240:241], v14 offset:61440
    v_mfma_f32_16x16x32_bf16 v[248:251], a[248:251], v[124:127], v[248:251]
    ds_read_b64_tr_b16 a[242:243], v14 offset:63488
    v_mfma_f32_16x16x32_bf16 v[244:247], a[252:255], v[120:123], v[244:247]
    ds_read_b64_tr_b16 a[244:245], v15 offset:61440
    v_mfma_f32_16x16x32_bf16 v[252:255], a[252:255], v[124:127], v[252:255]
    ds_read_b64_tr_b16 a[246:247], v15 offset:63488
    s_waitcnt lgkmcnt(8)
    v_mfma_f32_16x16x32_bf16 v[224:227], a[224:227], v[128:131], v[224:227]
    ds_read_b64_tr_b16 a[248:249], v16 offset:61440
    v_mfma_f32_16x16x32_bf16 v[232:235], a[224:227], v[132:135], v[232:235]
    ds_read_b64_tr_b16 a[250:251], v16 offset:63488
    v_mfma_f32_16x16x32_bf16 v[228:231], a[228:231], v[128:131], v[228:231]
    ds_read_b64_tr_b16 a[252:253], v17 offset:61440
    v_mfma_f32_16x16x32_bf16 v[236:239], a[228:231], v[132:135], v[236:239]
    ds_read_b64_tr_b16 a[254:255], v17 offset:63488
    s_waitcnt lgkmcnt(8)
    v_mfma_f32_16x16x32_bf16 v[240:243], a[232:235], v[128:131], v[240:243]
    ds_read_b64_tr_b16 a[224:225], v14 offset:24576
    v_mfma_f32_16x16x32_bf16 v[248:251], a[232:235], v[132:135], v[248:251]
    ds_read_b64_tr_b16 a[226:227], v14 offset:26624
    v_mfma_f32_16x16x32_bf16 v[244:247], a[236:239], v[128:131], v[244:247]
    ds_read_b64_tr_b16 a[228:229], v15 offset:24576
    v_mfma_f32_16x16x32_bf16 v[252:255], a[236:239], v[132:135], v[252:255]
    ds_read_b64_tr_b16 a[230:231], v15 offset:26624
    s_waitcnt lgkmcnt(8)
    v_mfma_f32_16x16x32_bf16 v[224:227], a[240:243], v[136:139], v[224:227]
    ds_read_b64_tr_b16 a[232:233], v14 offset:28672
    v_mfma_f32_16x16x32_bf16 v[232:235], a[240:243], v[140:143], v[232:235]
    ds_read_b64_tr_b16 a[234:235], v14 offset:30720
    v_mfma_f32_16x16x32_bf16 v[228:231], a[244:247], v[136:139], v[228:231]
    ds_read_b64_tr_b16 a[236:237], v15 offset:28672
    ds_read_b64_tr_b16 a[238:239], v15 offset:30720
    v_mfma_f32_16x16x32_bf16 v[236:239], a[244:247], v[140:143], v[236:239]
    ds_read_b32 v1, v31 offset:4
    s_waitcnt lgkmcnt(9)
    v_mfma_f32_16x16x32_bf16 v[240:243], a[248:251], v[136:139], v[240:243]
    ds_read_b64_tr_b16 a[240:241], v16 offset:24576
    v_mfma_f32_16x16x32_bf16 v[248:251], a[248:251], v[140:143], v[248:251]
    ds_read_b64_tr_b16 a[242:243], v16 offset:26624
    v_mfma_f32_16x16x32_bf16 v[244:247], a[252:255], v[136:139], v[244:247]
    ds_read_b64_tr_b16 a[244:245], v17 offset:24576
    v_mfma_f32_16x16x32_bf16 v[252:255], a[252:255], v[140:143], v[252:255]
    ds_read_b64_tr_b16 a[246:247], v17 offset:26624
    s_waitcnt lgkmcnt(9)
    v_mfma_f32_16x16x32_bf16 v[224:227], a[224:227], v[144:147], v[224:227]
    ds_read_b64_tr_b16 a[248:249], v16 offset:28672
    v_mfma_f32_16x16x32_bf16 v[232:235], a[224:227], v[148:151], v[232:235]
    ds_read_b64_tr_b16 a[250:251], v16 offset:30720
    s_waitcnt lgkmcnt(6)
    v_cmp_ne_u32 vcc, 0, v1
    v_mfma_f32_16x16x32_bf16 v[228:231], a[228:231], v[144:147], v[228:231]
    ds_read_b64_tr_b16 a[252:253], v17 offset:28672
    ds_read_b64_tr_b16 a[254:255], v17 offset:30720
    v_mfma_f32_16x16x32_bf16 v[236:239], a[228:231], v[148:151], v[236:239]
    ds_write_b32 v2, v31
    v_mfma_f32_16x16x32_bf16 v[224:227], a[232:235], v[152:155], v[224:227]
    s_getpc_b64 s[62:63]
    s_cbranch_vccnz L_cslow
    v_mfma_f32_16x16x32_bf16 v[232:235], a[232:235], v[156:159], v[232:235]
    ds_read_b64_tr_b16 a[224:225], v22 offset:8192
    ds_read_b64_tr_b16 a[226:227], v22 offset:10240
    v_mfma_f32_16x16x32_bf16 v[228:231], a[236:239], v[152:155], v[228:231]
    ds_read_b64_tr_b16 a[228:229], v23 offset:8192
    ds_read_b64_tr_b16 a[230:231], v23 offset:10240
    v_mfma_f32_16x16x32_bf16 v[236:239], a[236:239], v[156:159], v[236:239]
    v_add_u32 v31, 4, v31
    s_waitcnt lgkmcnt(9)
    v_mfma_f32_16x16x32_bf16 v[240:243], a[240:243], v[144:147], v[240:243]
    ds_read_b64_tr_b16 a[232:233], v24 offset:8192
    v_mfma_f32_16x16x32_bf16 v[248:251], a[240:243], v[148:151], v[248:251]
    ds_read_b64_tr_b16 a[234:235], v24 offset:10240
    v_mfma_f32_16x16x32_bf16 v[244:247], a[244:247], v[144:147], v[244:247]
    ds_read_b64_tr_b16 a[236:237], v25 offset:8192
    v_mul_f32 v224, v26, v224
    v_mul_f32 v225, v26, v225
    v_mfma_f32_16x16x32_bf16 v[252:255], a[244:247], v[148:151], v[252:255]
    ds_read_b64_tr_b16 a[238:239], v25 offset:10240
    v_mul_f32 v226, v26, v226
    s_waitcnt lgkmcnt(9)
    v_mfma_f32_16x16x32_bf16 v[240:243], a[248:251], v[152:155], v[240:243]
    ds_read_b64_tr_b16 a[240:241], v22 offset:12288
    v_mul_f32 v227, v26, v227
    v_mul_f32 v228, v26, v228
    v_mfma_f32_16x16x32_bf16 v[248:251], a[248:251], v[156:159], v[248:251]
    ds_read_b64_tr_b16 a[242:243], v22 offset:14336
    v_mul_f32 v229, v26, v229
    v_mul_f32 v230, v26, v230
    v_mfma_f32_16x16x32_bf16 v[244:247], a[252:255], v[152:155], v[244:247]
    ds_read_b64_tr_b16 a[244:245], v23 offset:12288
    v_mul_f32 v231, v26, v231
    v_cvt_pk_bf16_f32 v224, v224, v225
    v_mfma_f32_16x16x32_bf16 v[252:255], a[252:255], v[156:159], v[252:255]
    ds_read_b64_tr_b16 a[246:247], v23 offset:14336
    v_cvt_pk_bf16_f32 v225, v226, v227
    s_waitcnt lgkmcnt(8)
    v_mfma_f32_16x16x32_bf16 a[112:115], a[224:227], v[160:163], a[112:115]
    ds_read_b64_tr_b16 a[248:249], v24 offset:12288
    v_cvt_pk_bf16_f32 v226, v228, v229
    v_cvt_pk_bf16_f32 v227, v230, v231
    v_mfma_f32_16x16x32_bf16 a[120:123], a[224:227], v[164:167], a[120:123]
    ds_read_b64_tr_b16 a[250:251], v24 offset:14336
    v_mul_f32 v232, v27, v232
    v_mul_f32 v233, v27, v233
    v_mfma_f32_16x16x32_bf16 a[116:119], a[228:231], v[160:163], a[116:119]
    ds_read_b64_tr_b16 a[252:253], v25 offset:12288
    v_mul_f32 v234, v27, v234
    v_mul_f32 v235, v27, v235
    v_mfma_f32_16x16x32_bf16 a[124:127], a[228:231], v[164:167], a[124:127]
    ds_read_b64_tr_b16 a[254:255], v25 offset:14336
    v_mul_f32 v236, v27, v236
    s_waitcnt lgkmcnt(8)
    v_mfma_f32_16x16x32_bf16 a[128:131], a[232:235], v[160:163], a[128:131]
    ds_read_b64_tr_b16 a[224:225], v18 offset:0
    v_mul_f32 v237, v27, v237
    v_mul_f32 v238, v27, v238
    v_mfma_f32_16x16x32_bf16 a[136:139], a[232:235], v[164:167], a[136:139]
    ds_read_b64_tr_b16 a[226:227], v18 offset:2048
    v_mul_f32 v239, v27, v239
    v_cvt_pk_bf16_f32 v228, v232, v233
    v_mfma_f32_16x16x32_bf16 a[132:135], a[236:239], v[160:163], a[132:135]
    ds_read_b64_tr_b16 a[228:229], v18 offset:4096
    v_cvt_pk_bf16_f32 v229, v234, v235
    v_cvt_pk_bf16_f32 v230, v236, v237
    v_mfma_f32_16x16x32_bf16 a[140:143], a[236:239], v[164:167], a[140:143]
    ds_read_b64_tr_b16 a[230:231], v18 offset:6144
    v_cvt_pk_bf16_f32 v231, v238, v239
    s_waitcnt lgkmcnt(8)
    v_mfma_f32_16x16x32_bf16 a[112:115], a[240:243], v[168:171], a[112:115]
    ds_read_b64_tr_b16 a[232:233], v19 offset:0
    v_mul_f32 v240, v26, v240
    v_mul_f32 v241, v26, v241
    v_mfma_f32_16x16x32_bf16 a[120:123], a[240:243], v[172:175], a[120:123]
    ds_read_b64_tr_b16 a[234:235], v19 offset:2048
    v_mul_f32 v242, v26, v242
    v_mul_f32 v243, v26, v243
    v_mfma_f32_16x16x32_bf16 a[116:119], a[244:247], v[168:171], a[116:119]
    ds_read_b64_tr_b16 a[236:237], v19 offset:4096
    ds_read_b64_tr_b16 a[238:239], v19 offset:6144
    v_mul_f32 v244, v26, v244
    v_mfma_f32_16x16x32_bf16 a[124:127], a[244:247], v[172:175], a[124:127]
    ds_read_b32 v1, v31 offset:4
    v_mul_f32 v245, v26, v245
    s_waitcnt lgkmcnt(9)
    v_mfma_f32_16x16x32_bf16 a[128:131], a[248:251], v[168:171], a[128:131]
    ds_read_b64_tr_b16 a[240:241], v20 offset:0
    v_mul_f32 v246, v26, v246
    v_mul_f32 v247, v26, v247
    v_mfma_f32_16x16x32_bf16 a[136:139], a[248:251], v[172:175], a[136:139]
    ds_read_b64_tr_b16 a[242:243], v20 offset:2048
    v_cvt_pk_bf16_f32 v232, v240, v241
    v_cvt_pk_bf16_f32 v233, v242, v243
    v_mfma_f32_16x16x32_bf16 a[132:135], a[252:255], v[168:171], a[132:135]
    ds_read_b64_tr_b16 a[244:245], v20 offset:4096
    v_cvt_pk_bf16_f32 v234, v244, v245
    v_cvt_pk_bf16_f32 v235, v246, v247
    v_mfma_f32_16x16x32_bf16 a[140:143], a[252:255], v[172:175], a[140:143]
    ds_read_b64_tr_b16 a[246:247], v20 offset:6144
    v_mul_f32 v248, v27, v248
    s_waitcnt lgkmcnt(9)
    v_mfma_f32_16x16x32_bf16 a[144:147], a[224:227], v[160:163], a[144:147]
    ds_read_b64_tr_b16 a[248:249], v21 offset:0
    v_mul_f32 v249, v27, v249
    v_mul_f32 v250, v27, v250
    v_mfma_f32_16x16x32_bf16 a[152:155], a[224:227], v[164:167], a[152:155]
    ds_read_b64_tr_b16 a[250:251], v21 offset:2048
    s_waitcnt lgkmcnt(6)
    v_cmp_ne_u32 vcc, 0, v1
    v_mul_f32 v251, v27, v251
    v_mfma_f32_16x16x32_bf16 a[144:147], a[228:231], v[168:171], a[144:147]
    ds_read_b64_tr_b16 a[252:253], v21 offset:4096
    ds_read_b64_tr_b16 a[254:255], v21 offset:6144
    v_mul_f32 v252, v27, v252
    v_mfma_f32_16x16x32_bf16 a[152:155], a[228:231], v[172:175], a[152:155]
    ds_write_b32 v2, v31
    v_mul_f32 v253, v27, v253
    v_mfma_f32_16x16x32_bf16 a[148:151], a[232:235], v[160:163], a[148:151]
    s_getpc_b64 s[62:63]
    s_cbranch_vccnz L_cslow
    v_mul_f32 v254, v27, v254
    v_mfma_f32_16x16x32_bf16 a[156:159], a[232:235], v[164:167], a[156:159]
    ds_read_b64_tr_b16 a[224:225], v14 offset:16384
    ds_read_b64_tr_b16 a[226:227], v14 offset:18432
    v_mul_f32 v255, v27, v255
    v_mfma_f32_16x16x32_bf16 a[148:151], a[236:239], v[168:171], a[148:151]
    ds_read_b64_tr_b16 a[228:229], v15 offset:16384
    ds_read_b64_tr_b16 a[230:231], v15 offset:18432
    v_cvt_pk_bf16_f32 v236, v248, v249
    v_mfma_f32_16x16x32_bf16 a[156:159], a[236:239], v[172:175], a[156:159]
    v_add_u32 v31, 4, v31
    v_cvt_pk_bf16_f32 v237, v250, v251
    s_waitcnt lgkmcnt(9)
    v_mfma_f32_16x16x32_bf16 a[160:163], a[240:243], v[160:163], a[160:163]
    ds_read_b64_tr_b16 a[232:233], v16 offset:16384
    v_cvt_pk_bf16_f32 v238, v252, v253
    v_cvt_pk_bf16_f32 v239, v254, v255
    v_mfma_f32_16x16x32_bf16 a[168:171], a[240:243], v[164:167], a[168:171]
    ds_read_b64_tr_b16 a[234:235], v16 offset:18432
    v_mfma_f32_16x16x32_bf16 a[160:163], a[244:247], v[168:171], a[160:163]
    ds_read_b64_tr_b16 a[236:237], v17 offset:16384
    v_mfma_f32_16x16x32_bf16 a[168:171], a[244:247], v[172:175], a[168:171]
    ds_read_b64_tr_b16 a[238:239], v17 offset:18432
    s_waitcnt lgkmcnt(9)
    v_mfma_f32_16x16x32_bf16 a[164:167], a[248:251], v[160:163], a[164:167]
    ds_read_b64_tr_b16 a[240:241], v14 offset:20480
    v_mfma_f32_16x16x32_bf16 a[172:175], a[248:251], v[164:167], a[172:175]
    ds_read_b64_tr_b16 a[242:243], v14 offset:22528
    v_mfma_f32_16x16x32_bf16 a[164:167], a[252:255], v[168:171], a[164:167]
    ds_read_b64_tr_b16 a[244:245], v15 offset:20480
    v_mfma_f32_16x16x32_bf16 a[172:175], a[252:255], v[172:175], a[172:175]
    ds_read_b64_tr_b16 a[246:247], v15 offset:22528
    s_waitcnt lgkmcnt(8)
    v_mfma_f32_16x16x32_bf16 a[112:115], a[224:227], v[224:227], a[112:115]
    ds_read_b64_tr_b16 a[248:249], v16 offset:20480
    v_mfma_f32_16x16x32_bf16 a[120:123], a[224:227], v[228:231], a[120:123]
    ds_read_b64_tr_b16 a[250:251], v16 offset:22528
    v_mfma_f32_16x16x32_bf16 a[116:119], a[228:231], v[224:227], a[116:119]
    ds_read_b64_tr_b16 a[252:253], v17 offset:20480
    v_mfma_f32_16x16x32_bf16 a[124:127], a[228:231], v[228:231], a[124:127]
    ds_read_b64_tr_b16 a[254:255], v17 offset:22528
    s_waitcnt lgkmcnt(8)
    v_mfma_f32_16x16x32_bf16 a[128:131], a[232:235], v[224:227], a[128:131]
    ds_read_b64_tr_b16 a[224:225], v18 offset:49152
    v_mfma_f32_16x16x32_bf16 a[136:139], a[232:235], v[228:231], a[136:139]
    ds_read_b64_tr_b16 a[226:227], v18 offset:51200
    v_mfma_f32_16x16x32_bf16 a[132:135], a[236:239], v[224:227], a[132:135]
    ds_read_b64_tr_b16 a[228:229], v18 offset:53248
    v_mfma_f32_16x16x32_bf16 a[140:143], a[236:239], v[228:231], a[140:143]
    ds_read_b64_tr_b16 a[230:231], v18 offset:55296
    s_waitcnt lgkmcnt(8)
    v_mfma_f32_16x16x32_bf16 a[112:115], a[240:243], v[232:235], a[112:115]
    ds_read_b64_tr_b16 a[232:233], v19 offset:49152
    v_mfma_f32_16x16x32_bf16 a[120:123], a[240:243], v[236:239], a[120:123]
    ds_read_b64_tr_b16 a[234:235], v19 offset:51200
    v_mfma_f32_16x16x32_bf16 a[116:119], a[244:247], v[232:235], a[116:119]
    ds_read_b64_tr_b16 a[236:237], v19 offset:53248
    ds_read_b64_tr_b16 a[238:239], v19 offset:55296
    v_mfma_f32_16x16x32_bf16 a[124:127], a[244:247], v[236:239], a[124:127]
    ds_read_b32 v1, v31 offset:4
    s_waitcnt lgkmcnt(9)
    v_mfma_f32_16x16x32_bf16 a[128:131], a[248:251], v[232:235], a[128:131]
    ds_read_b64_tr_b16 a[240:241], v20 offset:49152
    v_mfma_f32_16x16x32_bf16 a[136:139], a[248:251], v[236:239], a[136:139]
    ds_read_b64_tr_b16 a[242:243], v20 offset:51200
    v_mfma_f32_16x16x32_bf16 a[132:135], a[252:255], v[232:235], a[132:135]
    ds_read_b64_tr_b16 a[244:245], v20 offset:53248
    v_accvgpr_read_b32 v64, a112
    v_accvgpr_read_b32 v65, a113
    v_accvgpr_read_b32 v66, a114
    v_accvgpr_read_b32 v67, a115
    v_mfma_f32_16x16x32_bf16 a[140:143], a[252:255], v[236:239], a[140:143]
    ds_read_b64_tr_b16 a[246:247], v20 offset:55296
    v_accvgpr_read_b32 v68, a116
    v_accvgpr_read_b32 v69, a117
    v_accvgpr_read_b32 v70, a118
    s_waitcnt lgkmcnt(9)
    v_mfma_f32_16x16x32_bf16 a[176:179], a[224:227], v[160:163], a[176:179]
    ds_read_b64_tr_b16 a[248:249], v21 offset:49152
    v_accvgpr_read_b32 v71, a119
    v_cvt_pk_bf16_f32 v80, v64, v65
    v_cvt_pk_bf16_f32 v81, v66, v67
    v_cvt_pk_bf16_f32 v82, v68, v69
    v_mfma_f32_16x16x32_bf16 a[184:187], a[224:227], v[164:167], a[184:187]
    ds_read_b64_tr_b16 a[250:251], v21 offset:51200
    s_waitcnt lgkmcnt(6)
    v_cmp_ne_u32 vcc, 0, v1
    v_cvt_pk_bf16_f32 v83, v70, v71
    buffer_store_dwordx4 v[80:83], v30, s[52:55], s70 offen offset:0 sc1
    v_accvgpr_read_b32 v72, a120
    v_mfma_f32_16x16x32_bf16 a[176:179], a[228:231], v[168:171], a[176:179]
    ds_read_b64_tr_b16 a[252:253], v21 offset:53248
    ds_read_b64_tr_b16 a[254:255], v21 offset:55296
    v_accvgpr_read_b32 v73, a121
    v_accvgpr_read_b32 v74, a122
    v_accvgpr_read_b32 v75, a123
    v_mfma_f32_16x16x32_bf16 a[184:187], a[228:231], v[172:175], a[184:187]
    ds_write_b32 v2, v31
    v_accvgpr_read_b32 v76, a124
    v_accvgpr_read_b32 v77, a125
    v_accvgpr_read_b32 v78, a126
    v_mfma_f32_16x16x32_bf16 a[180:183], a[232:235], v[160:163], a[180:183]
    s_getpc_b64 s[62:63]
    s_cbranch_vccnz L_cslow
    v_accvgpr_read_b32 v79, a127
    v_cvt_pk_bf16_f32 v84, v72, v73
    v_cvt_pk_bf16_f32 v85, v74, v75
    v_mfma_f32_16x16x32_bf16 a[188:191], a[232:235], v[164:167], a[188:191]
    ds_read_b64_tr_b16 a[224:225], v14 offset:40960
    ds_read_b64_tr_b16 a[226:227], v14 offset:43008
    v_cvt_pk_bf16_f32 v86, v76, v77
    v_cvt_pk_bf16_f32 v87, v78, v79
    buffer_store_dwordx4 v[84:87], v8, s[52:55], s70 offen offset:0 sc1
    v_mfma_f32_16x16x32_bf16 a[180:183], a[236:239], v[168:171], a[180:183]
    ds_read_b64_tr_b16 a[228:229], v14 offset:45056
    ds_read_b64_tr_b16 a[230:231], v14 offset:47104
    v_accvgpr_read_b32 v96, a128
    v_accvgpr_read_b32 v97, a129
    v_accvgpr_read_b32 v98, a130
    v_mfma_f32_16x16x32_bf16 a[188:191], a[236:239], v[172:175], a[188:191]
    v_add_u32 v31, 4, v31
    v_accvgpr_read_b32 v99, a131
    v_accvgpr_read_b32 v100, a132
    v_accvgpr_read_b32 v101, a133
    s_waitcnt lgkmcnt(9)
    v_mfma_f32_16x16x32_bf16 a[192:195], a[240:243], v[160:163], a[192:195]
    ds_read_b64_tr_b16 a[232:233], v15 offset:40960
    v_accvgpr_read_b32 v102, a134
    v_accvgpr_read_b32 v103, a135
    v_cvt_pk_bf16_f32 v112, v96, v97
    v_cvt_pk_bf16_f32 v113, v98, v99
    v_mfma_f32_16x16x32_bf16 a[200:203], a[240:243], v[164:167], a[200:203]
    ds_read_b64_tr_b16 a[234:235], v15 offset:43008
    v_cvt_pk_bf16_f32 v114, v100, v101
    v_cvt_pk_bf16_f32 v115, v102, v103
    buffer_store_dwordx4 v[112:115], v30, s[52:55], s70 offen offset:1024 sc1
    v_accvgpr_read_b32 v104, a136
    v_mfma_f32_16x16x32_bf16 a[192:195], a[244:247], v[168:171], a[192:195]
    ds_read_b64_tr_b16 a[236:237], v15 offset:45056
    v_accvgpr_read_b32 v105, a137
    v_accvgpr_read_b32 v106, a138
    v_accvgpr_read_b32 v107, a139
    v_accvgpr_read_b32 v108, a140
    v_mfma_f32_16x16x32_bf16 a[200:203], a[244:247], v[172:175], a[200:203]
    ds_read_b64_tr_b16 a[238:239], v15 offset:47104
    v_accvgpr_read_b32 v109, a141
    v_accvgpr_read_b32 v110, a142
    v_accvgpr_read_b32 v111, a143
    s_waitcnt lgkmcnt(9)
    v_mfma_f32_16x16x32_bf16 a[196:199], a[248:251], v[160:163], a[196:199]
    ds_read_b64_tr_b16 a[240:241], v16 offset:40960
    v_cvt_pk_bf16_f32 v116, v104, v105
    v_cvt_pk_bf16_f32 v117, v106, v107
    v_cvt_pk_bf16_f32 v118, v108, v109
    v_cvt_pk_bf16_f32 v119, v110, v111
    v_mfma_f32_16x16x32_bf16 a[204:207], a[248:251], v[164:167], a[204:207]
    ds_read_b64_tr_b16 a[242:243], v16 offset:43008
    buffer_store_dwordx4 v[116:119], v8, s[52:55], s70 offen offset:1024 sc1
    v_mfma_f32_16x16x32_bf16 a[196:199], a[252:255], v[168:171], a[196:199]
    ds_read_b64_tr_b16 a[244:245], v16 offset:45056
    v_mfma_f32_16x16x32_bf16 a[204:207], a[252:255], v[172:175], a[204:207]
    ds_read_b64_tr_b16 a[246:247], v16 offset:47104
    s_waitcnt lgkmcnt(8)
    v_mfma_f32_16x16x32_bf16 a[144:147], a[224:227], v[224:227], a[144:147]
    ds_read_b64_tr_b16 a[248:249], v17 offset:40960
    v_mfma_f32_16x16x32_bf16 a[152:155], a[224:227], v[228:231], a[152:155]
    ds_read_b64_tr_b16 a[250:251], v17 offset:43008
    v_mfma_f32_16x16x32_bf16 a[144:147], a[228:231], v[232:235], a[144:147]
    ds_read_b64_tr_b16 a[252:253], v17 offset:45056
    v_mfma_f32_16x16x32_bf16 a[152:155], a[228:231], v[236:239], a[152:155]
    ds_read_b64_tr_b16 a[254:255], v17 offset:47104
    s_waitcnt lgkmcnt(8)
    v_mfma_f32_16x16x32_bf16 a[148:151], a[232:235], v[224:227], a[148:151]
    ds_read_b64_tr_b16 a[224:225], v18 offset:57344
    v_mfma_f32_16x16x32_bf16 a[156:159], a[232:235], v[228:231], a[156:159]
    ds_read_b64_tr_b16 a[226:227], v18 offset:59392
    v_mfma_f32_16x16x32_bf16 a[148:151], a[236:239], v[232:235], a[148:151]
    ds_read_b64_tr_b16 a[228:229], v18 offset:61440
    v_mfma_f32_16x16x32_bf16 a[156:159], a[236:239], v[236:239], a[156:159]
    ds_read_b64_tr_b16 a[230:231], v18 offset:63488
    s_waitcnt lgkmcnt(8)
    v_mfma_f32_16x16x32_bf16 a[160:163], a[240:243], v[224:227], a[160:163]
    ds_read_b64_tr_b16 a[232:233], v19 offset:57344
    v_mfma_f32_16x16x32_bf16 a[168:171], a[240:243], v[228:231], a[168:171]
    ds_read_b64_tr_b16 a[234:235], v19 offset:59392
    v_mfma_f32_16x16x32_bf16 a[160:163], a[244:247], v[232:235], a[160:163]
    ds_read_b64_tr_b16 a[236:237], v19 offset:61440
    ds_read_b64_tr_b16 a[238:239], v19 offset:63488
    v_accvgpr_read_b32 v128, a144
    v_accvgpr_read_b32 v129, a145
    v_accvgpr_read_b32 v130, a146
    v_mfma_f32_16x16x32_bf16 a[168:171], a[244:247], v[236:239], a[168:171]
    ds_read_b32 v1, v31 offset:4
    v_accvgpr_read_b32 v131, a147
    v_accvgpr_read_b32 v132, a148
    v_accvgpr_read_b32 v133, a149
    s_waitcnt lgkmcnt(9)
    v_mfma_f32_16x16x32_bf16 a[164:167], a[248:251], v[224:227], a[164:167]
    ds_read_b64_tr_b16 a[240:241], v20 offset:57344
    v_accvgpr_read_b32 v134, a150
    v_accvgpr_read_b32 v135, a151
    v_cvt_pk_bf16_f32 v144, v128, v129
    v_cvt_pk_bf16_f32 v145, v130, v131
    v_mfma_f32_16x16x32_bf16 a[172:175], a[248:251], v[228:231], a[172:175]
    ds_read_b64_tr_b16 a[242:243], v20 offset:59392
    v_cvt_pk_bf16_f32 v146, v132, v133
    v_cvt_pk_bf16_f32 v147, v134, v135
    buffer_store_dwordx4 v[144:147], v30, s[52:55], s71 offen offset:0 sc1
    v_accvgpr_read_b32 v136, a152
    v_mfma_f32_16x16x32_bf16 a[164:167], a[252:255], v[232:235], a[164:167]
    ds_read_b64_tr_b16 a[244:245], v20 offset:61440
    v_accvgpr_read_b32 v137, a153
    v_accvgpr_read_b32 v138, a154
    v_accvgpr_read_b32 v139, a155
    v_accvgpr_read_b32 v140, a156
    v_mfma_f32_16x16x32_bf16 a[172:175], a[252:255], v[236:239], a[172:175]
    ds_read_b64_tr_b16 a[246:247], v20 offset:63488
    v_accvgpr_read_b32 v141, a157
    v_accvgpr_read_b32 v142, a158
    v_accvgpr_read_b32 v143, a159
    s_waitcnt lgkmcnt(9)
    v_mfma_f32_16x16x32_bf16 a[208:211], a[224:227], v[160:163], a[208:211]
    ds_read_b64_tr_b16 a[248:249], v21 offset:57344
    v_cvt_pk_bf16_f32 v148, v136, v137
    v_cvt_pk_bf16_f32 v149, v138, v139
    v_cvt_pk_bf16_f32 v150, v140, v141
    v_cvt_pk_bf16_f32 v151, v142, v143
    v_mfma_f32_16x16x32_bf16 a[216:219], a[224:227], v[164:167], a[216:219]
    ds_read_b64_tr_b16 a[250:251], v21 offset:59392
    s_waitcnt lgkmcnt(6)
    v_cmp_ne_u32 vcc, 0, v1
    buffer_store_dwordx4 v[148:151], v8, s[52:55], s71 offen offset:0 sc1
    v_mfma_f32_16x16x32_bf16 a[208:211], a[228:231], v[168:171], a[208:211]
    ds_read_b64_tr_b16 a[252:253], v21 offset:61440
    ds_read_b64_tr_b16 a[254:255], v21 offset:63488
    v_accvgpr_read_b32 v64, a160
    v_accvgpr_read_b32 v65, a161
    v_accvgpr_read_b32 v66, a162
    v_mfma_f32_16x16x32_bf16 a[216:219], a[228:231], v[172:175], a[216:219]
    ds_write_b32 v2, v31
    v_accvgpr_read_b32 v67, a163
    v_accvgpr_read_b32 v68, a164
    v_accvgpr_read_b32 v69, a165
    v_mfma_f32_16x16x32_bf16 a[212:215], a[232:235], v[160:163], a[212:215]
    s_getpc_b64 s[62:63]
    s_cbranch_vccnz L_cslow
    v_accvgpr_read_b32 v70, a166
    v_accvgpr_read_b32 v71, a167
    v_cvt_pk_bf16_f32 v80, v64, v65
    v_mfma_f32_16x16x32_bf16 a[220:223], a[232:235], v[164:167], a[220:223]
    ds_read_b64_tr_b16 a[224:225], v14 offset:32768
    ds_read_b64_tr_b16 a[226:227], v14 offset:34816
    v_cvt_pk_bf16_f32 v81, v66, v67
    v_cvt_pk_bf16_f32 v82, v68, v69
    v_cvt_pk_bf16_f32 v83, v70, v71
    v_mfma_f32_16x16x32_bf16 a[212:215], a[236:239], v[168:171], a[212:215]
    ds_read_b64_tr_b16 a[228:229], v14 offset:36864
    ds_read_b64_tr_b16 a[230:231], v14 offset:38912
    buffer_store_dwordx4 v[80:83], v30, s[52:55], s71 offen offset:1024 sc1
    v_accvgpr_read_b32 v72, a168
    v_accvgpr_read_b32 v73, a169
    v_mfma_f32_16x16x32_bf16 a[220:223], a[236:239], v[172:175], a[220:223]
    v_add_u32 v31, 4, v31
    v_accvgpr_read_b32 v74, a170
    v_accvgpr_read_b32 v75, a171
    v_accvgpr_read_b32 v76, a172
    s_waitcnt lgkmcnt(9)
    v_mfma_f32_16x16x32_bf16 a[0:3], a[240:243], v[160:163], a[0:3]
    ds_read_b64_tr_b16 a[232:233], v15 offset:32768
    v_accvgpr_read_b32 v77, a173
    v_accvgpr_read_b32 v78, a174
    v_accvgpr_read_b32 v79, a175
    v_cvt_pk_bf16_f32 v84, v72, v73
    v_mfma_f32_16x16x32_bf16 a[8:11], a[240:243], v[164:167], a[8:11]
    ds_read_b64_tr_b16 a[234:235], v15 offset:34816
    v_cvt_pk_bf16_f32 v85, v74, v75
    v_cvt_pk_bf16_f32 v86, v76, v77
    v_cvt_pk_bf16_f32 v87, v78, v79
    buffer_store_dwordx4 v[84:87], v8, s[52:55], s71 offen offset:1024 sc1
    v_mfma_f32_16x16x32_bf16 a[0:3], a[244:247], v[168:171], a[0:3]
    ds_read_b64_tr_b16 a[236:237], v15 offset:36864
    v_mfma_f32_16x16x32_bf16 a[8:11], a[244:247], v[172:175], a[8:11]
    ds_read_b64_tr_b16 a[238:239], v15 offset:38912
    s_waitcnt lgkmcnt(9)
    v_mfma_f32_16x16x32_bf16 a[4:7], a[248:251], v[160:163], a[4:7]
    ds_read_b64_tr_b16 a[240:241], v16 offset:32768
    v_mfma_f32_16x16x32_bf16 a[12:15], a[248:251], v[164:167], a[12:15]
    ds_read_b64_tr_b16 a[242:243], v16 offset:34816
    v_mfma_f32_16x16x32_bf16 a[4:7], a[252:255], v[168:171], a[4:7]
    ds_read_b64_tr_b16 a[244:245], v16 offset:36864
    v_mfma_f32_16x16x32_bf16 a[12:15], a[252:255], v[172:175], a[12:15]
    ds_read_b64_tr_b16 a[246:247], v16 offset:38912
    s_waitcnt lgkmcnt(8)
    v_mfma_f32_16x16x32_bf16 a[176:179], a[224:227], v[224:227], a[176:179]
    ds_read_b64_tr_b16 a[248:249], v17 offset:32768
    v_mfma_f32_16x16x32_bf16 a[184:187], a[224:227], v[228:231], a[184:187]
    ds_read_b64_tr_b16 a[250:251], v17 offset:34816
    v_mfma_f32_16x16x32_bf16 a[176:179], a[228:231], v[232:235], a[176:179]
    ds_read_b64_tr_b16 a[252:253], v17 offset:36864
    v_mfma_f32_16x16x32_bf16 a[184:187], a[228:231], v[236:239], a[184:187]
    ds_read_b64_tr_b16 a[254:255], v17 offset:38912
    s_waitcnt lgkmcnt(8)
    v_mfma_f32_16x16x32_bf16 a[180:183], a[232:235], v[224:227], a[180:183]
    ds_read_b64_tr_b16 a[224:225], v22 offset:16384
    v_mfma_f32_16x16x32_bf16 a[188:191], a[232:235], v[228:231], a[188:191]
    ds_read_b64_tr_b16 a[226:227], v22 offset:18432
    v_mfma_f32_16x16x32_bf16 a[180:183], a[236:239], v[232:235], a[180:183]
    ds_read_b64_tr_b16 a[228:229], v22 offset:20480
    v_mfma_f32_16x16x32_bf16 a[188:191], a[236:239], v[236:239], a[188:191]
    ds_read_b64_tr_b16 a[230:231], v22 offset:22528
    s_waitcnt lgkmcnt(8)
    v_mfma_f32_16x16x32_bf16 a[192:195], a[240:243], v[224:227], a[192:195]
    ds_read_b64_tr_b16 a[232:233], v23 offset:16384
    v_mfma_f32_16x16x32_bf16 a[200:203], a[240:243], v[228:231], a[200:203]
    ds_read_b64_tr_b16 a[234:235], v23 offset:18432
    v_mfma_f32_16x16x32_bf16 a[192:195], a[244:247], v[232:235], a[192:195]
    ds_read_b64_tr_b16 a[236:237], v23 offset:20480
    ds_read_b64_tr_b16 a[238:239], v23 offset:22528
    v_accvgpr_read_b32 v96, a176
    v_accvgpr_read_b32 v97, a177
    v_accvgpr_read_b32 v98, a178
    v_mfma_f32_16x16x32_bf16 a[200:203], a[244:247], v[236:239], a[200:203]
    ds_read_b32 v1, v31 offset:4
    v_accvgpr_read_b32 v99, a179
    v_accvgpr_read_b32 v100, a180
    v_accvgpr_read_b32 v101, a181
    s_waitcnt lgkmcnt(9)
    v_mfma_f32_16x16x32_bf16 a[196:199], a[248:251], v[224:227], a[196:199]
    ds_read_b64_tr_b16 a[240:241], v24 offset:16384
    v_accvgpr_read_b32 v102, a182
    v_accvgpr_read_b32 v103, a183
    v_cvt_pk_bf16_f32 v112, v96, v97
    v_cvt_pk_bf16_f32 v113, v98, v99
    v_mfma_f32_16x16x32_bf16 a[204:207], a[248:251], v[228:231], a[204:207]
    ds_read_b64_tr_b16 a[242:243], v24 offset:18432
    v_cvt_pk_bf16_f32 v114, v100, v101
    v_cvt_pk_bf16_f32 v115, v102, v103
    buffer_store_dwordx4 v[112:115], v30, s[52:55], s72 offen offset:0 sc1
    v_accvgpr_read_b32 v104, a184
    v_mfma_f32_16x16x32_bf16 a[196:199], a[252:255], v[232:235], a[196:199]
    ds_read_b64_tr_b16 a[244:245], v24 offset:20480
    v_accvgpr_read_b32 v105, a185
    v_accvgpr_read_b32 v106, a186
    v_accvgpr_read_b32 v107, a187
    v_accvgpr_read_b32 v108, a188
    v_mfma_f32_16x16x32_bf16 a[204:207], a[252:255], v[236:239], a[204:207]
    ds_read_b64_tr_b16 a[246:247], v24 offset:22528
    v_accvgpr_read_b32 v109, a189
    v_accvgpr_read_b32 v110, a190
    v_accvgpr_read_b32 v111, a191
    s_waitcnt lgkmcnt(9)
    v_mfma_f32_16x16x32_bf16 a[16:19], a[224:227], v[160:163], a[16:19]
    ds_read_b64_tr_b16 a[248:249], v25 offset:16384
    v_cvt_pk_bf16_f32 v116, v104, v105
    v_cvt_pk_bf16_f32 v117, v106, v107
    v_cvt_pk_bf16_f32 v118, v108, v109
    v_cvt_pk_bf16_f32 v119, v110, v111
    v_mfma_f32_16x16x32_bf16 a[24:27], a[224:227], v[164:167], a[24:27]
    ds_read_b64_tr_b16 a[250:251], v25 offset:18432
    s_waitcnt lgkmcnt(6)
    v_cmp_ne_u32 vcc, 0, v1
    buffer_store_dwordx4 v[116:119], v8, s[52:55], s72 offen offset:0 sc1
    v_mfma_f32_16x16x32_bf16 a[16:19], a[228:231], v[168:171], a[16:19]
    ds_read_b64_tr_b16 a[252:253], v25 offset:20480
    ds_read_b64_tr_b16 a[254:255], v25 offset:22528
    v_accvgpr_read_b32 v128, a192
    v_accvgpr_read_b32 v129, a193
    v_accvgpr_read_b32 v130, a194
    v_mfma_f32_16x16x32_bf16 a[24:27], a[228:231], v[172:175], a[24:27]
    ds_write_b32 v2, v31
    v_accvgpr_read_b32 v131, a195
    v_accvgpr_read_b32 v132, a196
    v_accvgpr_read_b32 v133, a197
    v_mfma_f32_16x16x32_bf16 a[20:23], a[232:235], v[160:163], a[20:23]
    s_getpc_b64 s[62:63]
    s_cbranch_vccnz L_cslow
    v_accvgpr_read_b32 v134, a198
    v_accvgpr_read_b32 v135, a199
    v_cvt_pk_bf16_f32 v144, v128, v129
    v_mfma_f32_16x16x32_bf16 a[28:31], a[232:235], v[164:167], a[28:31]
    ds_read_b64_tr_b16 a[224:225], v18 offset:24576
    ds_read_b64_tr_b16 a[226:227], v18 offset:26624
    v_cvt_pk_bf16_f32 v145, v130, v131
    v_cvt_pk_bf16_f32 v146, v132, v133
    v_cvt_pk_bf16_f32 v147, v134, v135
    v_mfma_f32_16x16x32_bf16 a[20:23], a[236:239], v[168:171], a[20:23]
    ds_read_b64_tr_b16 a[228:229], v18 offset:28672
    ds_read_b64_tr_b16 a[230:231], v18 offset:30720
    buffer_store_dwordx4 v[144:147], v30, s[52:55], s72 offen offset:1024 sc1
    v_accvgpr_read_b32 v136, a200
    v_accvgpr_read_b32 v137, a201
    v_mfma_f32_16x16x32_bf16 a[28:31], a[236:239], v[172:175], a[28:31]
    v_add_u32 v31, 4, v31
    v_accvgpr_read_b32 v138, a202
    v_accvgpr_read_b32 v139, a203
    v_accvgpr_read_b32 v140, a204
    s_waitcnt lgkmcnt(9)
    v_mfma_f32_16x16x32_bf16 a[32:35], a[240:243], v[160:163], a[32:35]
    ds_read_b64_tr_b16 a[232:233], v19 offset:24576
    v_accvgpr_read_b32 v141, a205
    v_accvgpr_read_b32 v142, a206
    v_accvgpr_read_b32 v143, a207
    v_cvt_pk_bf16_f32 v148, v136, v137
    v_mfma_f32_16x16x32_bf16 a[40:43], a[240:243], v[164:167], a[40:43]
    ds_read_b64_tr_b16 a[234:235], v19 offset:26624
    v_cvt_pk_bf16_f32 v149, v138, v139
    v_cvt_pk_bf16_f32 v150, v140, v141
    v_cvt_pk_bf16_f32 v151, v142, v143
    buffer_store_dwordx4 v[148:151], v8, s[52:55], s72 offen offset:1024 sc1
    v_mfma_f32_16x16x32_bf16 a[32:35], a[244:247], v[168:171], a[32:35]
    ds_read_b64_tr_b16 a[236:237], v19 offset:28672
    v_mfma_f32_16x16x32_bf16 a[40:43], a[244:247], v[172:175], a[40:43]
    ds_read_b64_tr_b16 a[238:239], v19 offset:30720
    s_waitcnt lgkmcnt(9)
    v_mfma_f32_16x16x32_bf16 a[36:39], a[248:251], v[160:163], a[36:39]
    ds_read_b64_tr_b16 a[240:241], v20 offset:24576
    v_mfma_f32_16x16x32_bf16 a[44:47], a[248:251], v[164:167], a[44:47]
    ds_read_b64_tr_b16 a[242:243], v20 offset:26624
    v_mfma_f32_16x16x32_bf16 a[36:39], a[252:255], v[168:171], a[36:39]
    ds_read_b64_tr_b16 a[244:245], v20 offset:28672
    v_mfma_f32_16x16x32_bf16 a[44:47], a[252:255], v[172:175], a[44:47]
    ds_read_b64_tr_b16 a[246:247], v20 offset:30720
    s_waitcnt lgkmcnt(8)
    v_mfma_f32_16x16x32_bf16 a[208:211], a[224:227], v[224:227], a[208:211]
    ds_read_b64_tr_b16 a[248:249], v21 offset:24576
    v_mfma_f32_16x16x32_bf16 a[216:219], a[224:227], v[228:231], a[216:219]
    ds_read_b64_tr_b16 a[250:251], v21 offset:26624
    v_mfma_f32_16x16x32_bf16 a[208:211], a[228:231], v[232:235], a[208:211]
    ds_read_b64_tr_b16 a[252:253], v21 offset:28672
    v_mfma_f32_16x16x32_bf16 a[216:219], a[228:231], v[236:239], a[216:219]
    ds_read_b64_tr_b16 a[254:255], v21 offset:30720
    s_waitcnt lgkmcnt(8)
    v_mfma_f32_16x16x32_bf16 a[212:215], a[232:235], v[224:227], a[212:215]
    ds_read_b64_tr_b16 a[224:225], v18 offset:32768
    v_mfma_f32_16x16x32_bf16 a[220:223], a[232:235], v[228:231], a[220:223]
    ds_read_b64_tr_b16 a[226:227], v18 offset:34816
    v_mfma_f32_16x16x32_bf16 a[212:215], a[236:239], v[232:235], a[212:215]
    ds_read_b64_tr_b16 a[228:229], v18 offset:36864
    v_mfma_f32_16x16x32_bf16 a[220:223], a[236:239], v[236:239], a[220:223]
    ds_read_b64_tr_b16 a[230:231], v18 offset:38912
    s_waitcnt lgkmcnt(8)
    v_mfma_f32_16x16x32_bf16 a[0:3], a[240:243], v[224:227], a[0:3]
    ds_read_b64_tr_b16 a[232:233], v19 offset:32768
    v_mfma_f32_16x16x32_bf16 a[8:11], a[240:243], v[228:231], a[8:11]
    ds_read_b64_tr_b16 a[234:235], v19 offset:34816
    v_mfma_f32_16x16x32_bf16 a[0:3], a[244:247], v[232:235], a[0:3]
    ds_read_b64_tr_b16 a[236:237], v19 offset:36864
    ds_read_b64_tr_b16 a[238:239], v19 offset:38912
    v_accvgpr_read_b32 v64, a208
    v_accvgpr_read_b32 v65, a209
    v_accvgpr_read_b32 v66, a210
    v_mfma_f32_16x16x32_bf16 a[8:11], a[244:247], v[236:239], a[8:11]
    ds_read_b32 v1, v31 offset:4
    v_accvgpr_read_b32 v67, a211
    v_accvgpr_read_b32 v68, a212
    v_accvgpr_read_b32 v69, a213
    s_waitcnt lgkmcnt(9)
    v_mfma_f32_16x16x32_bf16 a[4:7], a[248:251], v[224:227], a[4:7]
    ds_read_b64_tr_b16 a[240:241], v20 offset:32768
    v_accvgpr_read_b32 v70, a214
    v_accvgpr_read_b32 v71, a215
    v_cvt_pk_bf16_f32 v80, v64, v65
    v_cvt_pk_bf16_f32 v81, v66, v67
    v_mfma_f32_16x16x32_bf16 a[12:15], a[248:251], v[228:231], a[12:15]
    ds_read_b64_tr_b16 a[242:243], v20 offset:34816
    v_cvt_pk_bf16_f32 v82, v68, v69
    v_cvt_pk_bf16_f32 v83, v70, v71
    buffer_store_dwordx4 v[80:83], v30, s[52:55], s73 offen offset:0 sc1
    v_accvgpr_read_b32 v72, a216
    v_mfma_f32_16x16x32_bf16 a[4:7], a[252:255], v[232:235], a[4:7]
    ds_read_b64_tr_b16 a[244:245], v20 offset:36864
    v_accvgpr_read_b32 v73, a217
    v_accvgpr_read_b32 v74, a218
    v_accvgpr_read_b32 v75, a219
    v_accvgpr_read_b32 v76, a220
    v_mfma_f32_16x16x32_bf16 a[12:15], a[252:255], v[236:239], a[12:15]
    ds_read_b64_tr_b16 a[246:247], v20 offset:38912
    v_accvgpr_read_b32 v77, a221
    v_accvgpr_read_b32 v78, a222
    v_accvgpr_read_b32 v79, a223
    s_waitcnt lgkmcnt(9)
    v_mfma_f32_16x16x32_bf16 a[48:51], a[224:227], v[160:163], a[48:51]
    ds_read_b64_tr_b16 a[248:249], v21 offset:32768
    v_cvt_pk_bf16_f32 v84, v72, v73
    v_cvt_pk_bf16_f32 v85, v74, v75
    v_cvt_pk_bf16_f32 v86, v76, v77
    v_cvt_pk_bf16_f32 v87, v78, v79
    v_mfma_f32_16x16x32_bf16 a[56:59], a[224:227], v[164:167], a[56:59]
    ds_read_b64_tr_b16 a[250:251], v21 offset:34816
    s_waitcnt lgkmcnt(6)
    v_cmp_ne_u32 vcc, 0, v1
    buffer_store_dwordx4 v[84:87], v8, s[52:55], s73 offen offset:0 sc1
    v_mfma_f32_16x16x32_bf16 a[48:51], a[228:231], v[168:171], a[48:51]
    ds_read_b64_tr_b16 a[252:253], v21 offset:36864
    ds_read_b64_tr_b16 a[254:255], v21 offset:38912
    v_accvgpr_read_b32 v96, a0
    v_accvgpr_read_b32 v97, a1
    v_accvgpr_read_b32 v98, a2
    v_mfma_f32_16x16x32_bf16 a[56:59], a[228:231], v[172:175], a[56:59]
    ds_write_b32 v2, v31
    v_accvgpr_read_b32 v99, a3
    v_accvgpr_read_b32 v100, a4
    v_accvgpr_read_b32 v101, a5
    v_mfma_f32_16x16x32_bf16 a[52:55], a[232:235], v[160:163], a[52:55]
    s_getpc_b64 s[62:63]
    s_cbranch_vccnz L_cslow
    v_accvgpr_read_b32 v102, a6
    v_accvgpr_read_b32 v103, a7
    v_cvt_pk_bf16_f32 v112, v96, v97
    v_mfma_f32_16x16x32_bf16 a[60:63], a[232:235], v[164:167], a[60:63]
    ds_read_b64_tr_b16 a[224:225], v18 offset:8192
    ds_read_b64_tr_b16 a[226:227], v18 offset:10240
    v_cvt_pk_bf16_f32 v113, v98, v99
    v_cvt_pk_bf16_f32 v114, v100, v101
    v_cvt_pk_bf16_f32 v115, v102, v103
    v_mfma_f32_16x16x32_bf16 a[52:55], a[236:239], v[168:171], a[52:55]
    ds_read_b64_tr_b16 a[228:229], v18 offset:12288
    ds_read_b64_tr_b16 a[230:231], v18 offset:14336
    buffer_store_dwordx4 v[112:115], v30, s[52:55], s73 offen offset:1024 sc1
    v_accvgpr_read_b32 v104, a8
    v_accvgpr_read_b32 v105, a9
    v_mfma_f32_16x16x32_bf16 a[60:63], a[236:239], v[172:175], a[60:63]
    v_add_u32 v31, 4, v31
    v_accvgpr_read_b32 v106, a10
    v_accvgpr_read_b32 v107, a11
    v_accvgpr_read_b32 v108, a12
    s_waitcnt lgkmcnt(9)
    v_mfma_f32_16x16x32_bf16 a[64:67], a[240:243], v[160:163], a[64:67]
    ds_read_b64_tr_b16 a[232:233], v19 offset:8192
    v_accvgpr_read_b32 v109, a13
    v_accvgpr_read_b32 v110, a14
    v_accvgpr_read_b32 v111, a15
    v_cvt_pk_bf16_f32 v116, v104, v105
    v_mfma_f32_16x16x32_bf16 a[72:75], a[240:243], v[164:167], a[72:75]
    ds_read_b64_tr_b16 a[234:235], v19 offset:10240
    v_cvt_pk_bf16_f32 v117, v106, v107
    v_cvt_pk_bf16_f32 v118, v108, v109
    v_cvt_pk_bf16_f32 v119, v110, v111
    buffer_store_dwordx4 v[116:119], v8, s[52:55], s73 offen offset:1024 sc1
    v_mfma_f32_16x16x32_bf16 a[64:67], a[244:247], v[168:171], a[64:67]
    ds_read_b64_tr_b16 a[236:237], v19 offset:12288
    v_mfma_f32_16x16x32_bf16 a[72:75], a[244:247], v[172:175], a[72:75]
    ds_read_b64_tr_b16 a[238:239], v19 offset:14336
    s_waitcnt lgkmcnt(9)
    v_mfma_f32_16x16x32_bf16 a[68:71], a[248:251], v[160:163], a[68:71]
    ds_read_b64_tr_b16 a[240:241], v20 offset:8192
    v_mfma_f32_16x16x32_bf16 a[76:79], a[248:251], v[164:167], a[76:79]
    ds_read_b64_tr_b16 a[242:243], v20 offset:10240
    v_mfma_f32_16x16x32_bf16 a[68:71], a[252:255], v[168:171], a[68:71]
    ds_read_b64_tr_b16 a[244:245], v20 offset:12288
    v_mfma_f32_16x16x32_bf16 a[76:79], a[252:255], v[172:175], a[76:79]
    ds_read_b64_tr_b16 a[246:247], v20 offset:14336
    s_waitcnt lgkmcnt(8)
    v_mfma_f32_16x16x32_bf16 a[16:19], a[224:227], v[224:227], a[16:19]
    ds_read_b64_tr_b16 a[248:249], v21 offset:8192
    v_mfma_f32_16x16x32_bf16 a[24:27], a[224:227], v[228:231], a[24:27]
    ds_read_b64_tr_b16 a[250:251], v21 offset:10240
    v_mfma_f32_16x16x32_bf16 a[16:19], a[228:231], v[232:235], a[16:19]
    ds_read_b64_tr_b16 a[252:253], v21 offset:12288
    v_mfma_f32_16x16x32_bf16 a[24:27], a[228:231], v[236:239], a[24:27]
    ds_read_b64_tr_b16 a[254:255], v21 offset:14336
    s_waitcnt lgkmcnt(8)
    v_mfma_f32_16x16x32_bf16 a[20:23], a[232:235], v[224:227], a[20:23]
    ds_read_b64_tr_b16 a[224:225], v22 offset:0
    v_mfma_f32_16x16x32_bf16 a[28:31], a[232:235], v[228:231], a[28:31]
    ds_read_b64_tr_b16 a[226:227], v22 offset:2048
    v_mfma_f32_16x16x32_bf16 a[20:23], a[236:239], v[232:235], a[20:23]
    ds_read_b64_tr_b16 a[228:229], v22 offset:4096
    v_mfma_f32_16x16x32_bf16 a[28:31], a[236:239], v[236:239], a[28:31]
    ds_read_b64_tr_b16 a[230:231], v22 offset:6144
    s_waitcnt lgkmcnt(8)
    v_mfma_f32_16x16x32_bf16 a[32:35], a[240:243], v[224:227], a[32:35]
    ds_read_b64_tr_b16 a[232:233], v23 offset:0
    v_mfma_f32_16x16x32_bf16 a[40:43], a[240:243], v[228:231], a[40:43]
    ds_read_b64_tr_b16 a[234:235], v23 offset:2048
    v_mfma_f32_16x16x32_bf16 a[32:35], a[244:247], v[232:235], a[32:35]
    ds_read_b64_tr_b16 a[236:237], v23 offset:4096
    ds_read_b64_tr_b16 a[238:239], v23 offset:6144
    v_accvgpr_read_b32 v128, a16
    v_accvgpr_read_b32 v129, a17
    v_accvgpr_read_b32 v130, a18
    v_mfma_f32_16x16x32_bf16 a[40:43], a[244:247], v[236:239], a[40:43]
    ds_read_b32 v1, v31 offset:4
    v_accvgpr_read_b32 v131, a19
    v_accvgpr_read_b32 v132, a20
    v_accvgpr_read_b32 v133, a21
    s_waitcnt lgkmcnt(9)
    v_mfma_f32_16x16x32_bf16 a[36:39], a[248:251], v[224:227], a[36:39]
    ds_read_b64_tr_b16 a[240:241], v24 offset:0
    v_accvgpr_read_b32 v134, a22
    v_accvgpr_read_b32 v135, a23
    v_cvt_pk_bf16_f32 v144, v128, v129
    v_cvt_pk_bf16_f32 v145, v130, v131
    v_mfma_f32_16x16x32_bf16 a[44:47], a[248:251], v[228:231], a[44:47]
    ds_read_b64_tr_b16 a[242:243], v24 offset:2048
    v_cvt_pk_bf16_f32 v146, v132, v133
    v_cvt_pk_bf16_f32 v147, v134, v135
    buffer_store_dwordx4 v[144:147], v30, s[52:55], s74 offen offset:0 sc1
    v_accvgpr_read_b32 v136, a24
    v_mfma_f32_16x16x32_bf16 a[36:39], a[252:255], v[232:235], a[36:39]
    ds_read_b64_tr_b16 a[244:245], v24 offset:4096
    v_accvgpr_read_b32 v137, a25
    v_accvgpr_read_b32 v138, a26
    v_accvgpr_read_b32 v139, a27
    v_accvgpr_read_b32 v140, a28
    v_mfma_f32_16x16x32_bf16 a[44:47], a[252:255], v[236:239], a[44:47]
    ds_read_b64_tr_b16 a[246:247], v24 offset:6144
    v_accvgpr_read_b32 v141, a29
    v_accvgpr_read_b32 v142, a30
    v_accvgpr_read_b32 v143, a31
    s_waitcnt lgkmcnt(9)
    v_mfma_f32_16x16x32_bf16 a[80:83], a[224:227], v[160:163], a[80:83]
    ds_read_b64_tr_b16 a[248:249], v25 offset:0
    v_cvt_pk_bf16_f32 v148, v136, v137
    v_cvt_pk_bf16_f32 v149, v138, v139
    v_cvt_pk_bf16_f32 v150, v140, v141
    v_cvt_pk_bf16_f32 v151, v142, v143
    v_mfma_f32_16x16x32_bf16 a[88:91], a[224:227], v[164:167], a[88:91]
    ds_read_b64_tr_b16 a[250:251], v25 offset:2048
    s_waitcnt lgkmcnt(6)
    v_cmp_ne_u32 vcc, 0, v1
    buffer_store_dwordx4 v[148:151], v8, s[52:55], s74 offen offset:0 sc1
    v_mfma_f32_16x16x32_bf16 a[80:83], a[228:231], v[168:171], a[80:83]
    ds_read_b64_tr_b16 a[252:253], v25 offset:4096
    ds_read_b64_tr_b16 a[254:255], v25 offset:6144
    v_accvgpr_read_b32 v64, a32
    v_accvgpr_read_b32 v65, a33
    v_accvgpr_read_b32 v66, a34
    v_mfma_f32_16x16x32_bf16 a[88:91], a[228:231], v[172:175], a[88:91]
    ds_write_b32 v2, v31
    v_accvgpr_read_b32 v67, a35
    v_accvgpr_read_b32 v68, a36
    v_accvgpr_read_b32 v69, a37
    v_mfma_f32_16x16x32_bf16 a[84:87], a[232:235], v[160:163], a[84:87]
    s_getpc_b64 s[62:63]
    s_cbranch_vccnz L_cslow
    v_accvgpr_read_b32 v70, a38
    v_accvgpr_read_b32 v71, a39
    v_cvt_pk_bf16_f32 v80, v64, v65
    v_mfma_f32_16x16x32_bf16 a[92:95], a[232:235], v[164:167], a[92:95]
    ds_read_b64_tr_b16 a[224:225], v14 offset:8192
    ds_read_b64_tr_b16 a[226:227], v14 offset:10240
    v_cvt_pk_bf16_f32 v81, v66, v67
    v_cvt_pk_bf16_f32 v82, v68, v69
    v_cvt_pk_bf16_f32 v83, v70, v71
    v_mfma_f32_16x16x32_bf16 a[84:87], a[236:239], v[168:171], a[84:87]
    ds_read_b64_tr_b16 a[228:229], v14 offset:12288
    buffer_store_dwordx4 v[80:83], v30, s[52:55], s74 offen offset:1024 sc1
    v_accvgpr_read_b32 v72, a40
    v_accvgpr_read_b32 v73, a41
    v_accvgpr_read_b32 v74, a42
    v_mfma_f32_16x16x32_bf16 a[92:95], a[236:239], v[172:175], a[92:95]
    ds_read_b64_tr_b16 a[230:231], v14 offset:14336
    v_accvgpr_read_b32 v75, a43
    v_accvgpr_read_b32 v76, a44
    v_accvgpr_read_b32 v77, a45
    s_waitcnt lgkmcnt(9)
    v_mfma_f32_16x16x32_bf16 a[96:99], a[240:243], v[160:163], a[96:99]
    ds_read_b64_tr_b16 a[232:233], v15 offset:8192
    v_accvgpr_read_b32 v78, a46
    v_accvgpr_read_b32 v79, a47
    v_cvt_pk_bf16_f32 v84, v72, v73
    v_cvt_pk_bf16_f32 v85, v74, v75
    v_mfma_f32_16x16x32_bf16 a[104:107], a[240:243], v[164:167], a[104:107]
    ds_read_b64_tr_b16 a[234:235], v15 offset:10240
    v_cvt_pk_bf16_f32 v86, v76, v77
    v_cvt_pk_bf16_f32 v87, v78, v79
    buffer_store_dwordx4 v[84:87], v8, s[52:55], s74 offen offset:1024 sc1
    v_mfma_f32_16x16x32_bf16 a[96:99], a[244:247], v[168:171], a[96:99]
    ds_read_b64_tr_b16 a[236:237], v15 offset:12288
    v_mfma_f32_16x16x32_bf16 a[104:107], a[244:247], v[172:175], a[104:107]
    ds_read_b64_tr_b16 a[238:239], v15 offset:14336
    s_waitcnt lgkmcnt(9)
    v_mfma_f32_16x16x32_bf16 a[100:103], a[248:251], v[160:163], a[100:103]
    ds_read_b64_tr_b16 a[240:241], v16 offset:8192
    v_mfma_f32_16x16x32_bf16 a[108:111], a[248:251], v[164:167], a[108:111]
    ds_read_b64_tr_b16 a[242:243], v16 offset:10240
    v_mfma_f32_16x16x32_bf16 a[100:103], a[252:255], v[168:171], a[100:103]
    ds_read_b64_tr_b16 a[244:245], v16 offset:12288
    v_mfma_f32_16x16x32_bf16 a[108:111], a[252:255], v[172:175], a[108:111]
    ds_read_b64_tr_b16 a[246:247], v16 offset:14336
    s_waitcnt lgkmcnt(8)
    v_mfma_f32_16x16x32_bf16 a[48:51], a[224:227], v[224:227], a[48:51]
    ds_read_b64_tr_b16 a[248:249], v17 offset:8192
    v_mfma_f32_16x16x32_bf16 a[56:59], a[224:227], v[228:231], a[56:59]
    ds_read_b64_tr_b16 a[250:251], v17 offset:10240
    v_mfma_f32_16x16x32_bf16 a[48:51], a[228:231], v[232:235], a[48:51]
    ds_read_b64_tr_b16 a[252:253], v17 offset:12288
    v_mfma_f32_16x16x32_bf16 a[56:59], a[228:231], v[236:239], a[56:59]
    ds_read_b64_tr_b16 a[254:255], v17 offset:14336
    s_waitcnt lgkmcnt(8)
    v_mfma_f32_16x16x32_bf16 a[52:55], a[232:235], v[224:227], a[52:55]
    ds_read_b64_tr_b16 a[224:225], v14 offset:49152
    v_mfma_f32_16x16x32_bf16 a[60:63], a[232:235], v[228:231], a[60:63]
    ds_read_b64_tr_b16 a[226:227], v14 offset:51200
    v_mfma_f32_16x16x32_bf16 a[52:55], a[236:239], v[232:235], a[52:55]
    ds_read_b64_tr_b16 a[228:229], v14 offset:53248
    v_mfma_f32_16x16x32_bf16 a[60:63], a[236:239], v[236:239], a[60:63]
    ds_read_b64_tr_b16 a[230:231], v14 offset:55296
    s_waitcnt lgkmcnt(8)
    v_mfma_f32_16x16x32_bf16 a[64:67], a[240:243], v[224:227], a[64:67]
    ds_read_b64_tr_b16 a[232:233], v15 offset:49152
    v_mfma_f32_16x16x32_bf16 a[72:75], a[240:243], v[228:231], a[72:75]
    ds_read_b64_tr_b16 a[234:235], v15 offset:51200
    v_mfma_f32_16x16x32_bf16 a[64:67], a[244:247], v[232:235], a[64:67]
    ds_read_b64_tr_b16 a[236:237], v15 offset:53248
    v_accvgpr_read_b32 v96, a48
    v_accvgpr_read_b32 v97, a49
    v_accvgpr_read_b32 v98, a50
    v_accvgpr_read_b32 v99, a51
    v_mfma_f32_16x16x32_bf16 a[72:75], a[244:247], v[236:239], a[72:75]
    ds_read_b64_tr_b16 a[238:239], v15 offset:55296
    v_accvgpr_read_b32 v100, a52
    v_accvgpr_read_b32 v101, a53
    v_accvgpr_read_b32 v102, a54
    s_waitcnt lgkmcnt(8)
    v_mfma_f32_16x16x32_bf16 a[68:71], a[248:251], v[224:227], a[68:71]
    ds_read_b64_tr_b16 a[240:241], v16 offset:49152
    v_accvgpr_read_b32 v103, a55
    v_cvt_pk_bf16_f32 v112, v96, v97
    v_cvt_pk_bf16_f32 v113, v98, v99
    v_cvt_pk_bf16_f32 v114, v100, v101
    v_mfma_f32_16x16x32_bf16 a[76:79], a[248:251], v[228:231], a[76:79]
    ds_read_b64_tr_b16 a[242:243], v16 offset:51200
    v_cvt_pk_bf16_f32 v115, v102, v103
    buffer_store_dwordx4 v[112:115], v30, s[52:55], s75 offen offset:0 sc1
    v_accvgpr_read_b32 v104, a56
    v_accvgpr_read_b32 v105, a57
    v_mfma_f32_16x16x32_bf16 a[68:71], a[252:255], v[232:235], a[68:71]
    ds_read_b64_tr_b16 a[244:245], v16 offset:53248
    v_accvgpr_read_b32 v106, a58
    v_accvgpr_read_b32 v107, a59
    v_accvgpr_read_b32 v108, a60
    v_accvgpr_read_b32 v109, a61
    v_mfma_f32_16x16x32_bf16 a[76:79], a[252:255], v[236:239], a[76:79]
    ds_read_b64_tr_b16 a[246:247], v16 offset:55296
    v_accvgpr_read_b32 v110, a62
    v_accvgpr_read_b32 v111, a63
    v_cvt_pk_bf16_f32 v116, v104, v105
    s_waitcnt lgkmcnt(8)
    v_mfma_f32_16x16x32_bf16 a[80:83], a[224:227], v[224:227], a[80:83]
    ds_read_b64_tr_b16 a[248:249], v17 offset:49152
    v_cvt_pk_bf16_f32 v117, v106, v107
    v_cvt_pk_bf16_f32 v118, v108, v109
    v_cvt_pk_bf16_f32 v119, v110, v111
    buffer_store_dwordx4 v[116:119], v8, s[52:55], s75 offen offset:0 sc1
    v_mfma_f32_16x16x32_bf16 a[88:91], a[224:227], v[228:231], a[88:91]
    ds_read_b64_tr_b16 a[250:251], v17 offset:51200
    v_mfma_f32_16x16x32_bf16 a[80:83], a[228:231], v[232:235], a[80:83]
    ds_read_b64_tr_b16 a[252:253], v17 offset:53248
    v_accvgpr_read_b32 v128, a64
    v_accvgpr_read_b32 v129, a65
    v_accvgpr_read_b32 v130, a66
    v_accvgpr_read_b32 v131, a67
    v_mfma_f32_16x16x32_bf16 a[88:91], a[228:231], v[236:239], a[88:91]
    ds_read_b64_tr_b16 a[254:255], v17 offset:55296
    v_accvgpr_read_b32 v132, a68
    v_accvgpr_read_b32 v133, a69
    v_accvgpr_read_b32 v134, a70
    s_waitcnt lgkmcnt(8)
    v_mfma_f32_16x16x32_bf16 a[84:87], a[232:235], v[224:227], a[84:87]
    v_accvgpr_read_b32 v135, a71
    v_cvt_pk_bf16_f32 v144, v128, v129
    v_cvt_pk_bf16_f32 v145, v130, v131
    v_cvt_pk_bf16_f32 v146, v132, v133
    v_mfma_f32_16x16x32_bf16 a[92:95], a[232:235], v[228:231], a[92:95]
    v_cvt_pk_bf16_f32 v147, v134, v135
    buffer_store_dwordx4 v[144:147], v30, s[52:55], s75 offen offset:1024 sc1
    v_accvgpr_read_b32 v136, a72
    v_accvgpr_read_b32 v137, a73
    v_mfma_f32_16x16x32_bf16 a[84:87], a[236:239], v[232:235], a[84:87]
    v_accvgpr_read_b32 v138, a74
    v_accvgpr_read_b32 v139, a75
    v_accvgpr_read_b32 v140, a76
    v_accvgpr_read_b32 v141, a77
    v_mfma_f32_16x16x32_bf16 a[92:95], a[236:239], v[236:239], a[92:95]
    v_accvgpr_read_b32 v142, a78
    v_accvgpr_read_b32 v143, a79
    v_cvt_pk_bf16_f32 v148, v136, v137
    v_cvt_pk_bf16_f32 v149, v138, v139
    s_waitcnt lgkmcnt(4)
    v_mfma_f32_16x16x32_bf16 a[96:99], a[240:243], v[224:227], a[96:99]
    v_cvt_pk_bf16_f32 v150, v140, v141
    v_cvt_pk_bf16_f32 v151, v142, v143
    buffer_store_dwordx4 v[148:151], v8, s[52:55], s75 offen offset:1024 sc1
    v_mfma_f32_16x16x32_bf16 a[104:107], a[240:243], v[228:231], a[104:107]
    v_mfma_f32_16x16x32_bf16 a[96:99], a[244:247], v[232:235], a[96:99]
    v_accvgpr_read_b32 v64, a80
    v_accvgpr_read_b32 v65, a81
    v_accvgpr_read_b32 v66, a82
    v_accvgpr_read_b32 v67, a83
    v_mfma_f32_16x16x32_bf16 a[104:107], a[244:247], v[236:239], a[104:107]
    v_accvgpr_read_b32 v68, a84
    v_accvgpr_read_b32 v69, a85
    v_accvgpr_read_b32 v70, a86
    v_accvgpr_read_b32 v71, a87
    s_waitcnt lgkmcnt(0)
    v_mfma_f32_16x16x32_bf16 a[100:103], a[248:251], v[224:227], a[100:103]
    v_cvt_pk_bf16_f32 v80, v64, v65
    v_cvt_pk_bf16_f32 v81, v66, v67
    v_cvt_pk_bf16_f32 v82, v68, v69
    v_cvt_pk_bf16_f32 v83, v70, v71
    v_mfma_f32_16x16x32_bf16 a[108:111], a[248:251], v[228:231], a[108:111]
    buffer_store_dwordx4 v[80:83], v30, s[52:55], s76 offen offset:0 sc1
    v_accvgpr_read_b32 v72, a88
    v_accvgpr_read_b32 v73, a89
    v_accvgpr_read_b32 v74, a90
    v_mfma_f32_16x16x32_bf16 a[100:103], a[252:255], v[232:235], a[100:103]
    v_accvgpr_read_b32 v75, a91
    v_accvgpr_read_b32 v76, a92
    v_accvgpr_read_b32 v77, a93
    v_accvgpr_read_b32 v78, a94
    v_mfma_f32_16x16x32_bf16 a[108:111], a[252:255], v[236:239], a[108:111]
    v_accvgpr_read_b32 v79, a95
    v_cvt_pk_bf16_f32 v84, v72, v73
    v_cvt_pk_bf16_f32 v85, v74, v75
    v_cvt_pk_bf16_f32 v86, v76, v77
    v_cvt_pk_bf16_f32 v87, v78, v79
    buffer_store_dwordx4 v[84:87], v8, s[52:55], s76 offen offset:0 sc1
    v_accvgpr_read_b32 v96, a96
    v_accvgpr_read_b32 v97, a97
    v_accvgpr_read_b32 v98, a98
    v_accvgpr_read_b32 v99, a99
    v_accvgpr_read_b32 v100, a100
    v_accvgpr_read_b32 v101, a101
    v_accvgpr_read_b32 v102, a102
    v_accvgpr_read_b32 v103, a103
    v_cvt_pk_bf16_f32 v112, v96, v97
    v_cvt_pk_bf16_f32 v113, v98, v99
    v_cvt_pk_bf16_f32 v114, v100, v101
    v_cvt_pk_bf16_f32 v115, v102, v103
    buffer_store_dwordx4 v[112:115], v30, s[52:55], s76 offen offset:1024 sc1
    v_accvgpr_read_b32 v104, a104
    v_accvgpr_read_b32 v105, a105
    v_accvgpr_read_b32 v106, a106
    v_accvgpr_read_b32 v107, a107
    v_accvgpr_read_b32 v108, a108
    v_accvgpr_read_b32 v109, a109
    v_accvgpr_read_b32 v110, a110
    v_accvgpr_read_b32 v111, a111
    v_cvt_pk_bf16_f32 v116, v104, v105
    v_cvt_pk_bf16_f32 v117, v106, v107
    v_cvt_pk_bf16_f32 v118, v108, v109
    v_cvt_pk_bf16_f32 v119, v110, v111
    buffer_store_dwordx4 v[116:119], v8, s[52:55], s76 offen offset:1024 sc1
    v_add_u32 v232, v2, v30
    v_mov_b32 v31, 159980
    ds_read_b32 v230, v232 offset:1792
    v_mul_u32_u24 v236, 256, v0
    s_lshl_b32 s36, s36, 1
    s_lshl_b32 s51, s30, 2
    s_add_u32 s51, s51, 1376256
    s_mov_b32 s68, 0
    s_call_b64 s[46:47], L_setup
    s_lshl_b64 exec, 1, s27
    s_waitcnt vmcnt(0) lgkmcnt(0)
    buffer_store_dword v230, v236, s[8:11], s51 offen sc1
    ds_write_b32 v2, v31
    s_mov_b64 exec, -1
    s_call_b64 s[46:47], L_red
    s_endpgm
L_red:
    s_lshr_b32 s50, s36, 5
    s_lshr_b32 s31, s36, 4
    s_mul_i32 s38, s31, 14336
    s_bfe_u32 s31, s36, 0x10003
    s_lshl_b32 s31, s31, 7
    s_add_u32 s38, s38, s31
    s_bfe_u32 s31, s36, 0x20001
    s_mul_i32 s31, s31, 7
    v_add_u32 v229, s31, v240
    s_lshl_b32 s31, s31, 9
    s_add_u32 s38, s38, s31
    s_lshr_b32 s31, s36, 3
    s_mul_i32 s39, s31, 14336
    s_add_u32 s39, s39, s37
    s_mov_b64 s[44:45], 0
    v_lshrrev_b32 v239, 1, v229
    v_and_b32 v229, 1, v229
    v_lshl_add_u32 v229, v229, 4, v241
    v_lshl_add_u32 v229, v239, 6, v229
    v_or_b32 v239, v229, v242
L_h0:
    s_bitcmp1_b64 s[44:45], 0
    s_cbranch_scc1 L_g0
    s_call_b64 s[62:63], L_more
    s_branch L_h0
L_g0:
    v_mfma_f32_32x32x16_bf16 v[160:175], v[224:227], a[0:3], 0
    v_mfma_f32_32x32x16_bf16 v[176:191], v[224:227], a[4:7], 0
L_h1:
    s_bitcmp1_b64 s[44:45], 4
    s_cbranch_scc1 L_g1
    s_call_b64 s[62:63], L_more
    s_branch L_h1
L_g1:
    v_mfma_f32_32x32x16_bf16 v[160:175], v[224:227], a[8:11], v[160:175]
    v_mfma_f32_32x32x16_bf16 v[176:191], v[224:227], a[12:15], v[176:191]
L_h2:
    s_bitcmp1_b64 s[44:45], 8
    s_cbranch_scc1 L_g2
    s_call_b64 s[62:63], L_more
    s_branch L_h2
L_g2:
    v_mfma_f32_32x32x16_bf16 v[160:175], v[224:227], a[16:19], v[160:175]
    v_mfma_f32_32x32x16_bf16 v[176:191], v[224:227], a[20:23], v[176:191]
L_h3:
    s_bitcmp1_b64 s[44:45], 12
    s_cbranch_scc1 L_g3
    s_call_b64 s[62:63], L_more
    s_branch L_h3
L_g3:
    v_mfma_f32_32x32x16_bf16 v[160:175], v[224:227], a[24:27], v[160:175]
    v_mfma_f32_32x32x16_bf16 v[176:191], v[224:227], a[28:31], v[176:191]
L_h4:
    s_bitcmp1_b64 s[44:45], 16
    s_cbranch_scc1 L_g4
    s_call_b64 s[62:63], L_more
    s_branch L_h4
L_g4:
    v_mfma_f32_32x32x16_bf16 v[160:175], v[224:227], a[32:35], v[160:175]
    v_mfma_f32_32x32x16_bf16 v[176:191], v[224:227], a[36:39], v[176:191]
L_h5:
    s_bitcmp1_b64 s[44:45], 20
    s_cbranch_scc1 L_g5
    s_call_b64 s[62:63], L_more
    s_branch L_h5
L_g5:
    v_mfma_f32_32x32x16_bf16 v[160:175], v[224:227], a[40:43], v[160:175]
    v_mfma_f32_32x32x16_bf16 v[176:191], v[224:227], a[44:47], v[176:191]
L_h6:
    s_bitcmp1_b64 s[44:45], 24
    s_cbranch_scc1 L_g6
    s_call_b64 s[62:63], L_more
    s_branch L_h6
L_g6:
    v_mfma_f32_32x32x16_bf16 v[160:175], v[224:227], a[48:51], v[160:175]
    v_mfma_f32_32x32x16_bf16 v[176:191], v[224:227], a[52:55], v[176:191]
L_h7:
    s_bitcmp1_b64 s[44:45], 28
    s_cbranch_scc1 L_g7
    s_call_b64 s[62:63], L_more
    s_branch L_h7
L_g7:
    v_mfma_f32_32x32x16_bf16 v[160:175], v[224:227], a[56:59], v[160:175]
    v_mfma_f32_32x32x16_bf16 v[176:191], v[224:227], a[60:63], v[176:191]
L_h8:
    s_bitcmp1_b64 s[44:45], 32
    s_cbranch_scc1 L_g8
    s_call_b64 s[62:63], L_more
    s_branch L_h8
L_g8:
    v_mfma_f32_32x32x16_bf16 v[160:175], v[224:227], a[64:67], v[160:175]
    v_mfma_f32_32x32x16_bf16 v[176:191], v[224:227], a[68:71], v[176:191]
L_h9:
    s_bitcmp1_b64 s[44:45], 36
    s_cbranch_scc1 L_g9
    s_call_b64 s[62:63], L_more
    s_branch L_h9
L_g9:
    v_mfma_f32_32x32x16_bf16 v[160:175], v[224:227], a[72:75], v[160:175]
    v_mfma_f32_32x32x16_bf16 v[176:191], v[224:227], a[76:79], v[176:191]
L_h10:
    s_bitcmp1_b64 s[44:45], 40
    s_cbranch_scc1 L_g10
    s_call_b64 s[62:63], L_more
    s_branch L_h10
L_g10:
    v_mfma_f32_32x32x16_bf16 v[160:175], v[224:227], a[80:83], v[160:175]
    v_mfma_f32_32x32x16_bf16 v[176:191], v[224:227], a[84:87], v[176:191]
L_h11:
    s_bitcmp1_b64 s[44:45], 44
    s_cbranch_scc1 L_g11
    s_call_b64 s[62:63], L_more
    s_branch L_h11
L_g11:
    v_mfma_f32_32x32x16_bf16 v[160:175], v[224:227], a[88:91], v[160:175]
    v_mfma_f32_32x32x16_bf16 v[176:191], v[224:227], a[92:95], v[176:191]
L_h12:
    s_bitcmp1_b64 s[44:45], 48
    s_cbranch_scc1 L_g12
    s_call_b64 s[62:63], L_more
    s_branch L_h12
L_g12:
    v_mfma_f32_32x32x16_bf16 v[160:175], v[224:227], a[96:99], v[160:175]
    v_mfma_f32_32x32x16_bf16 v[176:191], v[224:227], a[100:103], v[176:191]
L_h13:
    s_bitcmp1_b64 s[44:45], 52
    s_cbranch_scc1 L_g13
    s_call_b64 s[62:63], L_more
    s_branch L_h13
L_g13:
    v_mfma_f32_32x32x16_bf16 v[160:175], v[224:227], a[104:107], v[160:175]
    v_mfma_f32_32x32x16_bf16 v[176:191], v[224:227], a[108:111], v[176:191]
L_h14:
    s_bitcmp1_b64 s[44:45], 56
    s_cbranch_scc1 L_g14
    s_call_b64 s[62:63], L_more
    s_branch L_h14
L_g14:
    v_mfma_f32_32x32x16_bf16 v[160:175], v[224:227], a[112:115], v[160:175]
    v_mfma_f32_32x32x16_bf16 v[176:191], v[224:227], a[116:119], v[176:191]
L_h15:
    s_bitcmp1_b64 s[44:45], 60
    s_cbranch_scc1 L_g15
    s_call_b64 s[62:63], L_more
    s_branch L_h15
L_g15:
    v_mfma_f32_32x32x16_bf16 v[160:175], v[224:227], a[120:123], v[160:175]
    v_mfma_f32_32x32x16_bf16 v[176:191], v[224:227], a[124:127], v[176:191]
    s_nop 4
    v_cvt_pk_bf16_f32 v168, v160, v161
    v_cvt_pk_bf16_f32 v169, v162, v163
    v_cvt_pk_bf16_f32 v170, v164, v165
    v_cvt_pk_bf16_f32 v171, v166, v167
    buffer_store_dwordx4 v[168:171], v229, s[12:15], s39 offen offset:0
    s_nop 1
    v_cvt_pk_bf16_f32 v184, v176, v177
    v_cvt_pk_bf16_f32 v185, v178, v179
    v_cvt_pk_bf16_f32 v186, v180, v181
    v_cvt_pk_bf16_f32 v187, v182, v183
    buffer_store_dwordx4 v[184:187], v239, s[12:15], s39 offen offset:128
L_ret:
    s_setpc_b64 s[46:47]
L_more:
    ds_read_b64 v[232:233], v231 offset:272
    s_add_u32 s68, s68, 1
    s_cmp_gt_u32 s68, 4194304
    s_cbranch_scc1 L_done
    s_waitcnt lgkmcnt(0)
    v_readfirstlane_b32 s40, v232
    v_readfirstlane_b32 s41, v233
    s_bitcmp1_b32 s41, 31
    s_cbranch_scc1 L_done
    s_lshr_b64 s[40:41], s[40:41], s50
    s_andn2_b64 s[42:43], s[40:41], s[44:45]
    s_or_b64 s[44:45], s[44:45], s[40:41]
    s_and_b64 s[42:43], s[42:43], s[48:49]
    s_cbranch_scc0 L_m16
L_m0:
    s_and_b32 s31, s42, 0xffff
    s_cbranch_scc0 L_m4
    s_bitcmp1_b32 s42, 0
    s_cbranch_scc0 L_m1
    s_add_u32 s31, s38, 0
    buffer_load_dwordx4 a[0:3], v228, s[8:11], s31 offen sc1
    buffer_load_dwordx4 a[4:7], v238, s[8:11], s31 offen offset:2048 sc1
L_m1:
    s_bitcmp1_b32 s42, 4
    s_cbranch_scc0 L_m2
    s_add_u32 s31, s38, 86016
    buffer_load_dwordx4 a[8:11], v228, s[8:11], s31 offen sc1
    buffer_load_dwordx4 a[12:15], v238, s[8:11], s31 offen offset:2048 sc1
L_m2:
    s_bitcmp1_b32 s42, 8
    s_cbranch_scc0 L_m3
    s_add_u32 s31, s38, 172032
    buffer_load_dwordx4 a[16:19], v228, s[8:11], s31 offen sc1
    buffer_load_dwordx4 a[20:23], v238, s[8:11], s31 offen offset:2048 sc1
L_m3:
    s_bitcmp1_b32 s42, 12
    s_cbranch_scc0 L_m4
    s_add_u32 s31, s38, 258048
    buffer_load_dwordx4 a[24:27], v228, s[8:11], s31 offen sc1
    buffer_load_dwordx4 a[28:31], v238, s[8:11], s31 offen offset:2048 sc1
L_m4:
    s_and_b32 s31, s42, 0xffff0000
    s_cbranch_scc0 L_m8
    s_bitcmp1_b32 s42, 16
    s_cbranch_scc0 L_m5
    s_add_u32 s31, s38, 344064
    buffer_load_dwordx4 a[32:35], v228, s[8:11], s31 offen sc1
    buffer_load_dwordx4 a[36:39], v238, s[8:11], s31 offen offset:2048 sc1
L_m5:
    s_bitcmp1_b32 s42, 20
    s_cbranch_scc0 L_m6
    s_add_u32 s31, s38, 430080
    buffer_load_dwordx4 a[40:43], v228, s[8:11], s31 offen sc1
    buffer_load_dwordx4 a[44:47], v238, s[8:11], s31 offen offset:2048 sc1
L_m6:
    s_bitcmp1_b32 s42, 24
    s_cbranch_scc0 L_m7
    s_add_u32 s31, s38, 516096
    buffer_load_dwordx4 a[48:51], v228, s[8:11], s31 offen sc1
    buffer_load_dwordx4 a[52:55], v238, s[8:11], s31 offen offset:2048 sc1
L_m7:
    s_bitcmp1_b32 s42, 28
    s_cbranch_scc0 L_m8
    s_add_u32 s31, s38, 602112
    buffer_load_dwordx4 a[56:59], v228, s[8:11], s31 offen sc1
    buffer_load_dwordx4 a[60:63], v238, s[8:11], s31 offen offset:2048 sc1
L_m8:
    s_and_b32 s31, s43, 0xffff
    s_cbranch_scc0 L_m12
    s_bitcmp1_b32 s43, 0
    s_cbranch_scc0 L_m9
    s_add_u32 s31, s38, 688128
    buffer_load_dwordx4 a[64:67], v228, s[8:11], s31 offen sc1
    buffer_load_dwordx4 a[68:71], v238, s[8:11], s31 offen offset:2048 sc1
L_m9:
    s_bitcmp1_b32 s43, 4
    s_cbranch_scc0 L_m10
    s_add_u32 s31, s38, 774144
    buffer_load_dwordx4 a[72:75], v228, s[8:11], s31 offen sc1
    buffer_load_dwordx4 a[76:79], v238, s[8:11], s31 offen offset:2048 sc1
L_m10:
    s_bitcmp1_b32 s43, 8
    s_cbranch_scc0 L_m11
    s_add_u32 s31, s38, 860160
    buffer_load_dwordx4 a[80:83], v228, s[8:11], s31 offen sc1
    buffer_load_dwordx4 a[84:87], v238, s[8:11], s31 offen offset:2048 sc1
L_m11:
    s_bitcmp1_b32 s43, 12
    s_cbranch_scc0 L_m12
    s_add_u32 s31, s38, 946176
    buffer_load_dwordx4 a[88:91], v228, s[8:11], s31 offen sc1
    buffer_load_dwordx4 a[92:95], v238, s[8:11], s31 offen offset:2048 sc1
L_m12:
    s_and_b32 s31, s43, 0xffff0000
    s_cbranch_scc0 L_m16
    s_bitcmp1_b32 s43, 16
    s_cbranch_scc0 L_m13
    s_add_u32 s31, s38, 1032192
    buffer_load_dwordx4 a[96:99], v228, s[8:11], s31 offen sc1
    buffer_load_dwordx4 a[100:103], v238, s[8:11], s31 offen offset:2048 sc1
L_m13:
    s_bitcmp1_b32 s43, 20
    s_cbranch_scc0 L_m14
    s_add_u32 s31, s38, 1118208
    buffer_load_dwordx4 a[104:107], v228, s[8:11], s31 offen sc1
    buffer_load_dwordx4 a[108:111], v238, s[8:11], s31 offen offset:2048 sc1
L_m14:
    s_bitcmp1_b32 s43, 24
    s_cbranch_scc0 L_m15
    s_add_u32 s31, s38, 1204224
    buffer_load_dwordx4 a[112:115], v228, s[8:11], s31 offen sc1
    buffer_load_dwordx4 a[116:119], v238, s[8:11], s31 offen offset:2048 sc1
L_m15:
    s_bitcmp1_b32 s43, 28
    s_cbranch_scc0 L_m16
    s_add_u32 s31, s38, 1290240
    buffer_load_dwordx4 a[120:123], v228, s[8:11], s31 offen sc1
    buffer_load_dwordx4 a[124:127], v238, s[8:11], s31 offen offset:2048 sc1
L_m16:
    s_waitcnt vmcnt(0)
    ds_write_b32 v2, v237
    s_setpc_b64 s[62:63]
L_setup:
    s_mov_b32 s12, s18
    s_mov_b32 s13, s19
    s_mov_b32 s14, 1376256
    s_mov_b32 s15, 0x20000
    s_mul_i32 s37, s28, 172032
    s_mul_i32 s31, s4, 896
    s_add_u32 s37, s37, s31
    s_mov_b32 s48, 0x11111111
    s_mov_b32 s49, 0x11111111
    v_mov_b32 v231, 159744
    v_mov_b32 v237, 159984
    v_bfe_u32 v240, v0, 3, 2
    v_and_b32 v234, 7, v0
    v_and_b32 v233, 32, v0
    v_lshlrev_b32 v228, 9, v240
    v_lshl_add_u32 v228, v234, 4, v228
    v_lshl_add_u32 v228, v233, 3, v228
    v_mul_u32_u24 v241, 1792, v234
    v_add_u32 v241, v241, v233
    v_bfrev_b32 v233, 1
    v_cmp_eq_u32 vcc, 3, v240
    s_nop 1
    v_cndmask_b32 v242, 0, v233, vcc
    v_or_b32 v238, v228, v242
    v_lshrrev_b32 v233, 5, v0
    v_xor_b32 v233, v233, v240
    v_bfe_u32 v234, v0, 1, 2
    v_lshl_add_u32 v233, v233, 2, v234
    v_and_b32 v234, 1, v0
    v_lshlrev_b32 v234, 4, v234
    v_mov_b32 v235, 0x3f80
    v_lshlrev_b32 v234, v234, v235
    v_cmp_eq_u32 vcc, 0, v233
    s_nop 1
    v_cndmask_b32 v224, 0, v234, vcc
    v_cmp_eq_u32 vcc, 1, v233
    s_nop 1
    v_cndmask_b32 v225, 0, v234, vcc
    v_cmp_eq_u32 vcc, 2, v233
    s_nop 1
    v_cndmask_b32 v226, 0, v234, vcc
    v_cmp_eq_u32 vcc, 3, v233
    s_nop 1
    v_cndmask_b32 v227, 0, v234, vcc
    s_setpc_b64 s[46:47]
L_end:
.section .rodata,"a"
.p2align 6
.amdhsa_kernel concat_heads__mha_block_cached__gqa_block_cached__near_ridge_kernel
  .amdhsa_next_free_vgpr 512
  .amdhsa_next_free_sgpr 102
  .amdhsa_accum_offset 256
  .amdhsa_group_segment_fixed_size 0
  .amdhsa_kernarg_size 104
  .amdhsa_user_sgpr_count 2
  .amdhsa_user_sgpr_kernarg_segment_ptr 1
  .amdhsa_system_sgpr_workgroup_id_x 1
.end_amdhsa_kernel
```
